```python
import torch

def _softmax(x, axis=-1):
    return torch.softmax(x, dim=axis)
def _gelu(x):
    return torch.nn.functional.gelu(x, approximate="tanh")
def _silu(x):
    return torch.nn.functional.silu(x)
def _sigmoid(x):
    return torch.sigmoid(x)
def _layernorm(x, axis=-1, eps=1e-5):
    m = x.mean(dim=axis, keepdim=True)
    v = x.var(dim=axis, keepdim=True, unbiased=False)
    return (x - m) / torch.sqrt(v + eps)
def _scatter_add(tgt, idx, src, axis=0):
    return tgt.clone().index_add_(axis, idx, src)
def _segment_sum(src, seg, n):
    out = torch.zeros((n,) + src.shape[1:], dtype=src.dtype)
    return out.index_add_(0, seg, src)
def _pad(x, pw):
    flat = tuple(v for pair in reversed(pw) for v in pair)
    return torch.nn.functional.pad(x, flat)

kernel_name = 'standalone__seq2seq_rnn_t_joint__speech'

def setup_inputs():

    _w = (lambda a: (lambda t: t.to(torch.bfloat16) if t.is_floating_point() else t)(torch.as_tensor(a)))
    B, T, D, K = 2, 4000, 512, 3
    U = 8
    sc = (1.0 / (K * D)) ** 0.5
    sd = (1.0 / D) ** 0.5
    return {
        "x": _w((lambda *s: torch.randn(*s, dtype=torch.bfloat16) * 0.2)(B, T, D) * 0.5),
        "w1": _w((lambda *s: torch.randn(*s, dtype=torch.bfloat16) * 3.2)(K, D, D) * sc),
        "w2": _w((lambda *s: torch.randn(*s, dtype=torch.bfloat16) * 3.2)(K, D, D) * sc),
        "g": _w((lambda *s: torch.randn(*s, dtype=torch.bfloat16) * 3.2)(B, U, D) * 0.5),
        "w_f": _w((lambda *s: torch.randn(*s, dtype=torch.bfloat16) * 3.2)(D, D) * sd),
        "w_g": _w((lambda *s: torch.randn(*s, dtype=torch.bfloat16) * 3.2)(D, D) * sd),
        "w_o": _w((lambda *s: torch.randn(*s, dtype=torch.bfloat16) * 3.2)(D, D) * sd),
    }

def reference(x, w1, w2, g, w_f, w_g, w_o):
    B, T, D = x.shape
    K = w1.shape[0]
    pad = K // 2
    xp = _pad(x, ((0,0),(pad,pad),(0,0)))
    h = torch.zeros_like(x)
    for i in range(K):
        h = h + torch.einsum("btc,cd->btd", xp[:, i:i+T, :], w1[i])
    h = _gelu(h)[:, ::2, :]
    T1 = h.shape[1]
    hp = _pad(h, ((0,0),(pad,pad),(0,0)))
    f = torch.zeros_like(h)
    for i in range(K):
        f = f + torch.einsum("btc,cd->btd", hp[:, i:i+T1, :], w2[i])
    f = _gelu(f)[:, ::2, :]
    fe = torch.einsum("btd,de->bte", f, w_f)
    ge = torch.einsum("bud,de->bue", g, w_g)
    j = torch.tanh(fe[:, :, None, :] + ge[:, None, :, :])
    return torch.einsum("btud,dv->btuv", j, w_o)
```

```asm
; @launch grid=(256,1,1) block=(512,1,1) lds=163840
.amdgcn_target "amdgcn-amd-amdhsa--gfx950"
.text

.globl standalone__seq2seq_rnn_t_joint__speech_kernel
.p2align 8
.type standalone__seq2seq_rnn_t_joint__speech_kernel,@function
standalone__seq2seq_rnn_t_joint__speech_kernel:

    s_cmp_ge_u32 s2, 256
    s_cbranch_scc1 L_end

    s_load_dwordx16 s[64:79], s[0:1], 0
    s_load_dwordx4 s[80:83], s[0:1], 64
    v_lshrrev_b32 v1, 6, v0
    v_and_b32 v0, 63, v0
    v_readfirstlane_b32 s4, v1
    s_and_b32 s3, s2, 7
    s_lshr_b32 s52, s2, 3
    s_and_b32 s5, s52, 7
    s_lshr_b32 s6, s52, 3
    s_lshl_b32 s7, s3, 2
    s_add_u32 s7, s7, s6
    s_lshr_b32 s49, s7, 4
    s_and_b32 s48, s7, 15
    s_and_b32 s51, s5, 6
s_add_u32 s51, s51, s3
L_pc:
    s_cmp_lt_u32 s4, 4
    s_cbranch_scc1 L_compute
s_and_b32 s50, s4, 3
    s_lshl_b32 s98, s50, 12
    v_lshrrev_b32 v1, 3, v0
    v_and_b32 v2, 7, v0
    v_and_b32 v3, 6, v1
    v_xor_b32 v4, v2, v3
    v_lshlrev_b32 v4, 4, v4
    s_mul_i32 s3, s48, 252
    s_lshl_b32 s52, s50, 6
    s_add_u32 s3, s3, s52
    s_sub_u32 s3, s3, 3
    v_lshl_add_u32 v6, v1, 1, s3
    v_lshl_add_u32 v8, v6, 10, v4
    v_add_u32 v9, 15360, v8
    v_add_u32 v10, 30720, v8
    v_add_u32 v11, 46080, v8
    v_add_u32 v12, 1024, v8
    v_add_u32 v13, 1024, v9
    v_add_u32 v14, 1024, v10
    v_add_u32 v15, 1024, v11
    v_bfrev_b32 v29, 1
    v_cmp_gt_i32 vcc, 0, v8
    v_cmp_gt_i32 s[84:85], 0, v12
    v_and_b32 v28, 2, v1
    v_xor_b32 v28, v28, v2
    v_cndmask_b32 v8, v8, v29, vcc
    v_cndmask_b32 v12, v12, v29, s[84:85]
    v_lshlrev_b32 v28, 4, v28
    v_lshl_add_u32 v28, v1, 10, v28
    s_lshl_b32 s3, s5, 7
    v_add_u32 v16, s3, v28
    v_xor_b32 v5, 64, v16
    v_add_u32 v17, 7168, v5
    v_add_u32 v18, 14336, v16
    v_add_u32 v19, 21504, v5
    s_lshr_b32 s3, s50, 1
    s_lshl_b32 s3, s3, 20
    s_and_b32 s52, s50, 1
    s_lshl_b32 s52, s52, 15
    s_add_u32 s55, s3, s52
    s_lshl_b32 s56, s50, 14
    s_lshl_b32 s97, s50, 11
s_waitcnt lgkmcnt(0)
    s_mul_i32 s3, s49, 4096000
    s_add_u32 s8, s64, s3
    s_addc_u32 s9, s65, 0
    s_mov_b32 s10, 4096000
    s_mov_b32 s11, 0x20000
    s_mov_b32 s12, s66
    s_mov_b32 s13, s67
    s_mov_b32 s14, 1572864
    s_mov_b32 s15, 0x20000
s_add_u32 s53, s51, 0
s_and_b32 s53, s53, 7
s_add_u32 m0, s98, 0
s_lshl_b32 s3, s53, 7
buffer_load_dwordx4 v8, s[8:11], s3 offen  lds
buffer_load_dwordx4 v9, s[8:11], s3 offen offset:1024  lds
buffer_load_dwordx4 v10, s[8:11], s3 offen offset:2048  lds
buffer_load_dwordx4 v11, s[8:11], s3 offen offset:3072  lds
s_lshl_b32 s3, s53, 16
s_add_u32 m0, s98, 16384
s_add_u32 s3, s3, s55
buffer_load_dwordx4 v16, s[12:15], s3 offen  lds
buffer_load_dwordx4 v17, s[12:15], s3 offen offset:1024  lds
buffer_load_dwordx4 v18, s[12:15], s3 offen offset:2048  lds
buffer_load_dwordx4 v19, s[12:15], s3 offen offset:3072  lds
s_add_u32 s53, s51, 0
s_and_b32 s53, s53, 7
s_lshl_b32 s3, s53, 16
s_add_u32 m0, s97, 49152
s_add_u32 s3, s3, s56
s_add_u32 s3, s3, 524288
buffer_load_dwordx4 v16, s[12:15], s3 offen  lds
buffer_load_dwordx4 v17, s[12:15], s3 offen offset:1024  lds
s_add_u32 m0, s98, 32768
s_lshl_b32 s3, s53, 7
buffer_load_dwordx4 v12, s[8:11], s3 offen  lds
buffer_load_dwordx4 v13, s[8:11], s3 offen offset:1024  lds
buffer_load_dwordx4 v14, s[8:11], s3 offen offset:2048  lds
buffer_load_dwordx4 v15, s[8:11], s3 offen offset:3072  lds
s_mov_b32 s16, s68
s_mov_b32 s17, s69
s_mov_b32 s18, 1572864
s_mov_b32 s19, 0x20000
s_mov_b32 s20, s72
s_mov_b32 s21, s73
s_mov_b32 s22, 524288
s_mov_b32 s23, 0x20000
s_mov_b32 s24, s74
s_mov_b32 s25, s75
s_mov_b32 s26, 524288
s_mov_b32 s27, 0x20000
s_mov_b32 s28, s76
s_mov_b32 s29, s77
s_mov_b32 s30, 524288
s_mov_b32 s31, 0x20000
s_mov_b32 s32, s70
s_mov_b32 s33, s71
s_mov_b32 s34, 16384
s_mov_b32 s35, 0x20000
s_mov_b32 s44, s80
s_mov_b32 s45, s81
s_mov_b32 s46, 256
s_mov_b32 s47, 0x20000
s_mul_i32 s3, s49, 1000
    s_mul_i32 s52, s48, 63
    s_add_u32 s3, s3, s52
    s_lshl_b32 s3, s3, 13
    s_add_u32 s36, s78, s3
    s_addc_u32 s37, s79, 0
    s_mov_b32 s38, 516096
    s_cmp_eq_u32 s48, 15
    s_cselect_b32 s38, 450560, s38
    s_mov_b32 s39, 0x20000
    s_lshl_b32 s3, s7, 19
    s_add_u32 s40, s82, s3
    s_addc_u32 s41, s83, 0
    s_mov_b32 s42, 0x80000
    s_mov_b32 s43, 0x20000
    s_add_u32 s92, s82, 0x1000000
    s_addc_u32 s93, s83, 0
    s_mov_b32 s94, 0xc0000
    s_mov_b32 s95, 0x20000
    s_mov_b32 s100, s5
    s_mov_b32 s60, 0xbdd2d3e8
    s_mov_b32 s61, 0xbdd2d3e8
    s_mov_b32 s62, 0x4038aa3b
v_lshlrev_b32 v6, 4, v0
    v_add_u32 v20, s98, v6
    s_lshr_b32 s96, s50, 1
    s_lshl_b32 s96, s96, 12
    s_and_b32 s3, s50, 1
    s_lshl_b32 s3, s3, 10
    s_add_u32 s96, s96, s3
    v_add_u32 v24, s96, v6
    s_add_u32 s3, s5, 2
s_and_b32 s3, s3, 7
s_lshl_b32 s3, s3, 7
    v_add_u32 v25, s3, v28
    v_xor_b32 v26, 64, v25
    v_add_u32 v26, 7168, v26
    s_sub_u32 s3, s5, s6
s_add_u32 s3, s3, 7
s_and_b32 s3, s3, 7
s_lshl_b32 s3, s3, 7
    v_add_u32 v21, s3, v28
    v_xor_b32 v22, 64, v21
    v_add_u32 v22, 7168, v22
    v_and_b32 v28, 31, v0
    v_lshlrev_b32 v28, 2, v28
    v_add_u32 v28, 294912, v28
    v_lshlrev_b32 v3, 7, v0
    s_lshl_b32 s3, s5, 14
    s_lshl_b32 s52, s50, 13
    s_add_u32 s3, s3, s52
    s_sub_u32 s52, s5, s6
s_add_u32 s52, s52, 7
s_and_b32 s52, s52, 7
s_lshl_b32 s52, s52, 13
    s_add_u32 s52, s52, 131072
    s_cmp_eq_u32 s50, 2
    s_cselect_b32 s3, s52, s3
    v_add_u32 v30, s3, v3
    s_cmp_lg_u32 s50, 3
    s_cbranch_scc1 L_tv
    v_and_b32 v30, 15, v0
    v_lshlrev_b32 v30, 7, v30
    v_lshrrev_b32 v29, 4, v0
    v_lshl_add_u32 v30, v29, 14, v30
    s_lshl_b32 s52, s5, 11
    s_add_u32 s52, s52, 262144
    v_add_u32 v30, s52, v30
    v_cmp_lt_u32 vcc, 31, v0
    v_add_u32 v29, 290816, v3
    s_nop 0
    v_cndmask_b32 v30, v30, v29, vcc
L_tv:
    v_lshlrev_b32 v1, 2, v0
s_add_u32 s53, s51, 1
s_and_b32 s53, s53, 7
s_add_u32 m0, s98, 57344
s_lshl_b32 s3, s53, 7
buffer_load_dwordx4 v8, s[8:11], s3 offen  lds
buffer_load_dwordx4 v9, s[8:11], s3 offen offset:1024  lds
buffer_load_dwordx4 v10, s[8:11], s3 offen offset:2048  lds
buffer_load_dwordx4 v11, s[8:11], s3 offen offset:3072  lds
s_lshl_b32 s3, s53, 16
s_add_u32 m0, s98, 73728
s_add_u32 s3, s3, s55
buffer_load_dwordx4 v16, s[12:15], s3 offen  lds
buffer_load_dwordx4 v17, s[12:15], s3 offen offset:1024  lds
buffer_load_dwordx4 v18, s[12:15], s3 offen offset:2048  lds
buffer_load_dwordx4 v19, s[12:15], s3 offen offset:3072  lds
s_add_u32 s53, s51, 1
s_and_b32 s53, s53, 7
s_lshl_b32 s3, s53, 16
s_add_u32 m0, s97, 106496
s_add_u32 s3, s3, s56
s_add_u32 s3, s3, 524288
buffer_load_dwordx4 v16, s[12:15], s3 offen  lds
buffer_load_dwordx4 v17, s[12:15], s3 offen offset:1024  lds
s_add_u32 m0, s98, 90112
s_lshl_b32 s3, s53, 7
buffer_load_dwordx4 v12, s[8:11], s3 offen  lds
buffer_load_dwordx4 v13, s[8:11], s3 offen offset:1024  lds
buffer_load_dwordx4 v14, s[8:11], s3 offen offset:2048  lds
buffer_load_dwordx4 v15, s[8:11], s3 offen offset:3072  lds
s_waitcnt vmcnt(20)
s_barrier
s_waitcnt vmcnt(14)
s_barrier
s_add_u32 s53, s51, 2
s_and_b32 s53, s53, 7
s_add_u32 m0, s98, 0
s_lshl_b32 s3, s53, 7
buffer_load_dwordx4 v8, s[8:11], s3 offen  lds
buffer_load_dwordx4 v9, s[8:11], s3 offen offset:1024  lds
buffer_load_dwordx4 v10, s[8:11], s3 offen offset:2048  lds
buffer_load_dwordx4 v11, s[8:11], s3 offen offset:3072  lds
s_lshl_b32 s3, s53, 16
s_add_u32 m0, s98, 16384
s_add_u32 s3, s3, s55
buffer_load_dwordx4 v16, s[12:15], s3 offen  lds
buffer_load_dwordx4 v17, s[12:15], s3 offen offset:1024  lds
buffer_load_dwordx4 v18, s[12:15], s3 offen offset:2048  lds
buffer_load_dwordx4 v19, s[12:15], s3 offen offset:3072  lds
s_waitcnt vmcnt(14)
s_barrier
s_add_u32 s53, s51, 2
s_and_b32 s53, s53, 7
s_lshl_b32 s3, s53, 16
s_add_u32 m0, s97, 49152
s_add_u32 s3, s3, s56
s_add_u32 s3, s3, 524288
buffer_load_dwordx4 v16, s[12:15], s3 offen  lds
buffer_load_dwordx4 v17, s[12:15], s3 offen offset:1024  lds
s_add_u32 m0, s98, 32768
s_lshl_b32 s3, s53, 7
buffer_load_dwordx4 v12, s[8:11], s3 offen  lds
buffer_load_dwordx4 v13, s[8:11], s3 offen offset:1024  lds
buffer_load_dwordx4 v14, s[8:11], s3 offen offset:2048  lds
buffer_load_dwordx4 v15, s[8:11], s3 offen offset:3072  lds
s_waitcnt vmcnt(14)
s_barrier
s_add_u32 s53, s51, 3
s_and_b32 s53, s53, 7
s_add_u32 m0, s98, 57344
s_lshl_b32 s3, s53, 7
buffer_load_dwordx4 v8, s[8:11], s3 offen  lds
buffer_load_dwordx4 v9, s[8:11], s3 offen offset:1024  lds
buffer_load_dwordx4 v10, s[8:11], s3 offen offset:2048  lds
buffer_load_dwordx4 v11, s[8:11], s3 offen offset:3072  lds
s_lshl_b32 s3, s53, 16
s_add_u32 m0, s98, 73728
s_add_u32 s3, s3, s55
buffer_load_dwordx4 v16, s[12:15], s3 offen  lds
buffer_load_dwordx4 v17, s[12:15], s3 offen offset:1024  lds
buffer_load_dwordx4 v18, s[12:15], s3 offen offset:2048  lds
buffer_load_dwordx4 v19, s[12:15], s3 offen offset:3072  lds
s_waitcnt vmcnt(14)
s_barrier
s_add_u32 s53, s51, 3
s_and_b32 s53, s53, 7
s_lshl_b32 s3, s53, 16
s_add_u32 m0, s97, 106496
s_add_u32 s3, s3, s56
s_add_u32 s3, s3, 524288
buffer_load_dwordx4 v16, s[12:15], s3 offen  lds
buffer_load_dwordx4 v17, s[12:15], s3 offen offset:1024  lds
s_add_u32 m0, s98, 90112
s_lshl_b32 s3, s53, 7
buffer_load_dwordx4 v12, s[8:11], s3 offen  lds
buffer_load_dwordx4 v13, s[8:11], s3 offen offset:1024  lds
buffer_load_dwordx4 v14, s[8:11], s3 offen offset:2048  lds
buffer_load_dwordx4 v15, s[8:11], s3 offen offset:3072  lds
s_waitcnt vmcnt(14)
s_barrier
s_add_u32 s53, s51, 4
s_and_b32 s53, s53, 7
s_add_u32 m0, s98, 0
s_lshl_b32 s3, s53, 7
buffer_load_dwordx4 v8, s[8:11], s3 offen  lds
buffer_load_dwordx4 v9, s[8:11], s3 offen offset:1024  lds
buffer_load_dwordx4 v10, s[8:11], s3 offen offset:2048  lds
buffer_load_dwordx4 v11, s[8:11], s3 offen offset:3072  lds
s_lshl_b32 s3, s53, 16
s_add_u32 m0, s98, 16384
s_add_u32 s3, s3, s55
buffer_load_dwordx4 v16, s[12:15], s3 offen  lds
buffer_load_dwordx4 v17, s[12:15], s3 offen offset:1024  lds
buffer_load_dwordx4 v18, s[12:15], s3 offen offset:2048  lds
buffer_load_dwordx4 v19, s[12:15], s3 offen offset:3072  lds
s_waitcnt vmcnt(14)
s_barrier
s_add_u32 s53, s51, 4
s_and_b32 s53, s53, 7
s_lshl_b32 s3, s53, 16
s_add_u32 m0, s97, 49152
s_add_u32 s3, s3, s56
s_add_u32 s3, s3, 524288
buffer_load_dwordx4 v16, s[12:15], s3 offen  lds
buffer_load_dwordx4 v17, s[12:15], s3 offen offset:1024  lds
s_add_u32 m0, s98, 32768
s_lshl_b32 s3, s53, 7
buffer_load_dwordx4 v12, s[8:11], s3 offen  lds
buffer_load_dwordx4 v13, s[8:11], s3 offen offset:1024  lds
buffer_load_dwordx4 v14, s[8:11], s3 offen offset:2048  lds
buffer_load_dwordx4 v15, s[8:11], s3 offen offset:3072  lds
s_waitcnt vmcnt(14)
s_barrier
s_add_u32 s53, s51, 5
s_and_b32 s53, s53, 7
s_add_u32 m0, s98, 57344
s_lshl_b32 s3, s53, 7
buffer_load_dwordx4 v8, s[8:11], s3 offen  lds
buffer_load_dwordx4 v9, s[8:11], s3 offen offset:1024  lds
buffer_load_dwordx4 v10, s[8:11], s3 offen offset:2048  lds
buffer_load_dwordx4 v11, s[8:11], s3 offen offset:3072  lds
s_lshl_b32 s3, s53, 16
s_add_u32 m0, s98, 73728
s_add_u32 s3, s3, s55
buffer_load_dwordx4 v16, s[12:15], s3 offen  lds
buffer_load_dwordx4 v17, s[12:15], s3 offen offset:1024  lds
buffer_load_dwordx4 v18, s[12:15], s3 offen offset:2048  lds
buffer_load_dwordx4 v19, s[12:15], s3 offen offset:3072  lds
s_waitcnt vmcnt(14)
s_barrier
s_add_u32 s53, s51, 5
s_and_b32 s53, s53, 7
s_lshl_b32 s3, s53, 16
s_add_u32 m0, s97, 106496
s_add_u32 s3, s3, s56
s_add_u32 s3, s3, 524288
buffer_load_dwordx4 v16, s[12:15], s3 offen  lds
buffer_load_dwordx4 v17, s[12:15], s3 offen offset:1024  lds
s_add_u32 m0, s98, 90112
s_lshl_b32 s3, s53, 7
buffer_load_dwordx4 v12, s[8:11], s3 offen  lds
buffer_load_dwordx4 v13, s[8:11], s3 offen offset:1024  lds
buffer_load_dwordx4 v14, s[8:11], s3 offen offset:2048  lds
buffer_load_dwordx4 v15, s[8:11], s3 offen offset:3072  lds
s_waitcnt vmcnt(14)
s_barrier
s_add_u32 s53, s51, 6
s_and_b32 s53, s53, 7
s_add_u32 m0, s98, 0
s_lshl_b32 s3, s53, 7
buffer_load_dwordx4 v8, s[8:11], s3 offen  lds
buffer_load_dwordx4 v9, s[8:11], s3 offen offset:1024  lds
buffer_load_dwordx4 v10, s[8:11], s3 offen offset:2048  lds
buffer_load_dwordx4 v11, s[8:11], s3 offen offset:3072  lds
s_lshl_b32 s3, s53, 16
s_add_u32 m0, s98, 16384
s_add_u32 s3, s3, s55
buffer_load_dwordx4 v16, s[12:15], s3 offen  lds
buffer_load_dwordx4 v17, s[12:15], s3 offen offset:1024  lds
buffer_load_dwordx4 v18, s[12:15], s3 offen offset:2048  lds
buffer_load_dwordx4 v19, s[12:15], s3 offen offset:3072  lds
s_waitcnt vmcnt(14)
s_barrier
s_waitcnt vmcnt(8)
s_barrier
buffer_load_dword v2, v1, s[44:47], 0 offen sc1
s_add_u32 s53, s51, 6
s_and_b32 s53, s53, 7
s_lshl_b32 s3, s53, 16
s_add_u32 m0, s97, 49152
s_add_u32 s3, s3, s56
s_add_u32 s3, s3, 524288
buffer_load_dwordx4 v16, s[12:15], s3 offen  lds
buffer_load_dwordx4 v17, s[12:15], s3 offen offset:1024  lds
s_add_u32 m0, s98, 32768
s_lshl_b32 s3, s53, 7
buffer_load_dwordx4 v12, s[8:11], s3 offen  lds
buffer_load_dwordx4 v13, s[8:11], s3 offen offset:1024  lds
buffer_load_dwordx4 v14, s[8:11], s3 offen offset:2048  lds
buffer_load_dwordx4 v15, s[8:11], s3 offen offset:3072  lds
s_waitcnt vmcnt(7)
s_barrier
s_add_u32 s53, s51, 7
s_and_b32 s53, s53, 7
s_add_u32 m0, s98, 57344
s_lshl_b32 s3, s53, 7
buffer_load_dwordx4 v8, s[8:11], s3 offen  lds
buffer_load_dwordx4 v9, s[8:11], s3 offen offset:1024  lds
buffer_load_dwordx4 v10, s[8:11], s3 offen offset:2048  lds
buffer_load_dwordx4 v11, s[8:11], s3 offen offset:3072  lds
s_lshl_b32 s3, s53, 16
s_add_u32 m0, s98, 73728
s_add_u32 s3, s3, s55
buffer_load_dwordx4 v16, s[12:15], s3 offen  lds
buffer_load_dwordx4 v17, s[12:15], s3 offen offset:1024  lds
buffer_load_dwordx4 v18, s[12:15], s3 offen offset:2048  lds
buffer_load_dwordx4 v19, s[12:15], s3 offen offset:3072  lds
s_waitcnt vmcnt(8)
s_barrier
s_mov_b32 s57, 0
s_lshl_b32 s53, s7, 1
s_add_u32 s54, s53, 1
s_branch L_pube_3
L_pub_1:
    s_waitcnt vmcnt(0)
L_pube_3:
    v_and_b32 v4, 0x80808080, v2
    v_cmp_ne_u32 vcc, 0x80808080, v4
    s_cbranch_vccz L_pubd_2
    s_add_u32 s57, s57, 1
    s_cmp_gt_u32 s57, 200000
    s_cbranch_scc1 L_pubd_2
    buffer_load_dword v2, v1, s[44:47], 0 offen sc1
    s_branch L_pub_1
L_pubd_2:
    v_readlane_b32 s3, v2, s53
    v_readlane_b32 s52, v2, s54
    s_and_b32 s53, s3, 0xff
    s_mul_i32 s53, s53, 0x01010101
    s_xor_b32 s3, s3, s53
    s_xor_b32 s52, s52, s53
    s_or_b32 s3, s3, s52
    s_cmp_eq_u32 s3, 0
    s_cselect_b32 s63, 1, 0
    s_cmp_eq_u32 s63, 0
    s_cselect_b32 s99, 327680, 0
s_add_u32 s53, s51, 7
s_and_b32 s53, s53, 7
s_lshl_b32 s3, s53, 16
s_add_u32 m0, s97, 106496
s_add_u32 s3, s3, s56
s_add_u32 s3, s3, 524288
buffer_load_dwordx4 v16, s[12:15], s3 offen  lds
buffer_load_dwordx4 v17, s[12:15], s3 offen offset:1024  lds
s_add_u32 m0, s98, 90112
s_lshl_b32 s3, s53, 7
buffer_load_dwordx4 v12, s[8:11], s3 offen  lds
buffer_load_dwordx4 v13, s[8:11], s3 offen offset:1024  lds
buffer_load_dwordx4 v14, s[8:11], s3 offen offset:2048  lds
buffer_load_dwordx4 v15, s[8:11], s3 offen offset:3072  lds
s_waitcnt vmcnt(6)
s_barrier
s_cmp_eq_u32 s50, 3
s_cselect_b32 exec_hi, 0x3f, exec_hi
s_cselect_b32 exec_lo, 65535, exec_lo
buffer_load_dword v31, v30, s[40:43], 0 offen sc1
s_mov_b64 exec, -1
s_waitcnt vmcnt(1)
s_barrier
s_add_u32 s53, s100, 0
s_and_b32 s53, s53, 7
s_lshl_b32 s3, s53, 16
s_add_u32 s3, s3, s56
s_add_u32 m0, s97, 114688
s_nop 0
s_waitcnt vmcnt(5)
buffer_load_dwordx4 v21, s[16:19], s3 offen  lds
s_waitcnt vmcnt(5)
buffer_load_dwordx4 v22, s[16:19], s3 offen offset:1024  lds
s_add_u32 m0, s97, 122880
s_add_u32 s3, s3, 524288
s_waitcnt vmcnt(5)
buffer_load_dwordx4 v21, s[16:19], s3 offen  lds
s_waitcnt vmcnt(5)
buffer_load_dwordx4 v22, s[16:19], s3 offen offset:1024  lds
s_add_u32 m0, s97, 131072
s_add_u32 s3, s3, 524288
s_waitcnt vmcnt(5)
buffer_load_dwordx4 v21, s[16:19], s3 offen  lds
s_waitcnt vmcnt(5)
buffer_load_dwordx4 v22, s[16:19], s3 offen offset:1024  lds
s_add_u32 s53, s100, 1
s_and_b32 s53, s53, 7
s_lshl_b32 s3, s53, 16
s_add_u32 s3, s3, s56
s_add_u32 m0, s97, 139264
s_nop 0
s_waitcnt vmcnt(5)
buffer_load_dwordx4 v21, s[16:19], s3 offen  lds
s_waitcnt vmcnt(5)
buffer_load_dwordx4 v22, s[16:19], s3 offen offset:1024  lds
s_add_u32 m0, s97, 147456
s_add_u32 s3, s3, 524288
s_waitcnt vmcnt(5)
buffer_load_dwordx4 v21, s[16:19], s3 offen  lds
s_waitcnt vmcnt(5)
buffer_load_dwordx4 v22, s[16:19], s3 offen offset:1024  lds
s_add_u32 m0, s97, 155648
s_add_u32 s3, s3, 524288
s_waitcnt vmcnt(5)
buffer_load_dwordx4 v21, s[16:19], s3 offen  lds
s_waitcnt vmcnt(5)
buffer_load_dwordx4 v22, s[16:19], s3 offen offset:1024  lds
s_add_u32 s53, s100, 2
s_and_b32 s53, s53, 7
s_lshl_b32 s3, s53, 16
s_add_u32 s3, s3, s56
s_add_u32 m0, s97, 0
s_nop 0
s_waitcnt vmcnt(5)
buffer_load_dwordx4 v21, s[16:19], s3 offen  lds
s_waitcnt vmcnt(5)
buffer_load_dwordx4 v22, s[16:19], s3 offen offset:1024  lds
s_add_u32 m0, s97, 8192
s_add_u32 s3, s3, 524288
s_waitcnt vmcnt(5)
buffer_load_dwordx4 v21, s[16:19], s3 offen  lds
s_waitcnt vmcnt(5)
buffer_load_dwordx4 v22, s[16:19], s3 offen offset:1024  lds
s_add_u32 m0, s97, 16384
s_add_u32 s3, s3, 524288
s_waitcnt vmcnt(5)
buffer_load_dwordx4 v21, s[16:19], s3 offen  lds
s_waitcnt vmcnt(5)
buffer_load_dwordx4 v22, s[16:19], s3 offen offset:1024  lds
s_add_u32 s53, s100, 3
s_and_b32 s53, s53, 7
s_lshl_b32 s3, s53, 16
s_add_u32 s3, s3, s56
s_add_u32 m0, s97, 24576
s_nop 0
s_waitcnt vmcnt(5)
buffer_load_dwordx4 v21, s[16:19], s3 offen  lds
s_waitcnt vmcnt(5)
buffer_load_dwordx4 v22, s[16:19], s3 offen offset:1024  lds
s_add_u32 m0, s97, 32768
s_add_u32 s3, s3, 524288
s_waitcnt vmcnt(5)
buffer_load_dwordx4 v21, s[16:19], s3 offen  lds
s_waitcnt vmcnt(5)
buffer_load_dwordx4 v22, s[16:19], s3 offen offset:1024  lds
s_add_u32 m0, s97, 40960
s_add_u32 s3, s3, 524288
s_waitcnt vmcnt(5)
buffer_load_dwordx4 v21, s[16:19], s3 offen  lds
s_waitcnt vmcnt(5)
buffer_load_dwordx4 v22, s[16:19], s3 offen offset:1024  lds
s_waitcnt vmcnt(6)
s_barrier
s_mov_b32 s57, 0
L_poll_4:
    buffer_load_dword v4, v28, s[40:43], 0 offen offset:0 sc1
    s_add_u32 s57, s57, 1
    s_cmp_gt_u32 s57, 200000
    s_cbranch_scc1 L_got_5
    s_waitcnt vmcnt(0)
    v_cmp_eq_u32 vcc, 0, v4
    s_cbranch_vccnz L_poll_4
L_got_5:
    s_waitcnt vmcnt(0)
s_add_u32 s53, s100, 1
s_and_b32 s53, s53, 7
s_add_u32 m0, s98, 90112
s_lshl_b32 s3, s53, 14
buffer_load_dwordx4 v20, s[40:43], s3 offen sc1 lds
buffer_load_dwordx4 v20, s[40:43], s3 offen offset:1024 sc1 lds
buffer_load_dwordx4 v20, s[40:43], s3 offen offset:2048 sc1 lds
buffer_load_dwordx4 v20, s[40:43], s3 offen offset:3072 sc1 lds
s_add_u32 s53, s100, 2
s_and_b32 s53, s53, 7
s_add_u32 m0, s98, 49152
s_lshl_b32 s3, s53, 14
buffer_load_dwordx4 v20, s[40:43], s3 offen sc1 lds
buffer_load_dwordx4 v20, s[40:43], s3 offen offset:1024 sc1 lds
buffer_load_dwordx4 v20, s[40:43], s3 offen offset:2048 sc1 lds
buffer_load_dwordx4 v20, s[40:43], s3 offen offset:3072 sc1 lds
s_waitcnt vmcnt(4)
s_barrier
s_add_u32 s53, s100, 3
s_and_b32 s53, s53, 7
s_add_u32 m0, s98, 106496
s_lshl_b32 s3, s53, 14
buffer_load_dwordx4 v20, s[40:43], s3 offen sc1 lds
buffer_load_dwordx4 v20, s[40:43], s3 offen offset:1024 sc1 lds
buffer_load_dwordx4 v20, s[40:43], s3 offen offset:2048 sc1 lds
buffer_load_dwordx4 v20, s[40:43], s3 offen offset:3072 sc1 lds
s_add_u32 s53, s100, 4
s_and_b32 s53, s53, 7
s_lshl_b32 s3, s53, 16
s_add_u32 s3, s3, s56
s_add_u32 m0, s97, 139264
s_nop 0
buffer_load_dwordx4 v21, s[16:19], s3 offen  lds
buffer_load_dwordx4 v22, s[16:19], s3 offen offset:1024  lds
s_add_u32 m0, s97, 147456
s_add_u32 s3, s3, 524288
buffer_load_dwordx4 v21, s[16:19], s3 offen  lds
buffer_load_dwordx4 v22, s[16:19], s3 offen offset:1024  lds
s_add_u32 m0, s97, 155648
s_add_u32 s3, s3, 524288
buffer_load_dwordx4 v21, s[16:19], s3 offen  lds
buffer_load_dwordx4 v22, s[16:19], s3 offen offset:1024  lds
s_waitcnt vmcnt(10)
s_barrier
s_add_u32 s53, s100, 4
s_and_b32 s53, s53, 7
s_add_u32 m0, s98, 122880
s_lshl_b32 s3, s53, 14
buffer_load_dwordx4 v20, s[40:43], s3 offen sc1 lds
buffer_load_dwordx4 v20, s[40:43], s3 offen offset:1024 sc1 lds
buffer_load_dwordx4 v20, s[40:43], s3 offen offset:2048 sc1 lds
buffer_load_dwordx4 v20, s[40:43], s3 offen offset:3072 sc1 lds
s_add_u32 s53, s100, 5
s_and_b32 s53, s53, 7
s_lshl_b32 s3, s53, 16
s_add_u32 s3, s3, s56
s_add_u32 m0, s97, 0
s_nop 0
buffer_load_dwordx4 v21, s[16:19], s3 offen  lds
buffer_load_dwordx4 v22, s[16:19], s3 offen offset:1024  lds
s_add_u32 m0, s97, 8192
s_add_u32 s3, s3, 524288
buffer_load_dwordx4 v21, s[16:19], s3 offen  lds
buffer_load_dwordx4 v22, s[16:19], s3 offen offset:1024  lds
s_add_u32 m0, s97, 16384
s_add_u32 s3, s3, 524288
buffer_load_dwordx4 v21, s[16:19], s3 offen  lds
buffer_load_dwordx4 v22, s[16:19], s3 offen offset:1024  lds
s_waitcnt vmcnt(16)
s_barrier
s_add_u32 s53, s100, 5
s_and_b32 s53, s53, 7
s_add_u32 m0, s98, 73728
s_lshl_b32 s3, s53, 14
buffer_load_dwordx4 v20, s[40:43], s3 offen sc1 lds
buffer_load_dwordx4 v20, s[40:43], s3 offen offset:1024 sc1 lds
buffer_load_dwordx4 v20, s[40:43], s3 offen offset:2048 sc1 lds
buffer_load_dwordx4 v20, s[40:43], s3 offen offset:3072 sc1 lds
v_mov_b32 v15, v2
    v_and_b32 v1, 31, v0
    v_mul_u32_u24 v1, 1040, v1
    v_lshrrev_b32 v2, 5, v0
    v_lshl_add_u32 v1, v2, 4, v1
    s_and_b32 s53, s5, 1
    s_lshl_b32 s3, s53, 3
    s_add_u32 s3, s3, s4
    s_lshl_b32 s3, s3, 15
    v_lshlrev_b32 v12, 4, v0
    v_add_u32 v12, s3, v12
    s_lshl_b32 s53, s53, 9
    v_mov_b32 v11, 8320
    v_lshrrev_b32 v8, 4, v0
    v_and_b32 v9, 15, v0
    s_lshl_b32 s3, s4, 7
    v_lshl_add_u32 v10, v9, 3, s3
    s_lshl_b32 s52, s4, 11
    v_lshl_add_u32 v13, v9, 4, s52
    s_lshl_b32 s61, s6, 2
    s_lshr_b32 s52, s5, 1
    s_add_u32 s61, s61, s52
    s_and_b32 s61, s61, 14
    s_lshl_b32 s54, s61, 6
    v_subrev_u32 v2, s54, v10
    v_and_b32 v2, 1023, v2
    v_mad_u32_u24 v2, v8, v11, v2
    s_lshl_b32 s54, s52, 9
    s_lshl_b32 s3, s4, 14
    s_add_u32 s54, s54, s3
    v_lshlrev_b32 v3, 3, v9
    v_lshl_add_u32 v3, v8, 7, v3
    v_add_u32 v3, s54, v3
    v_lshlrev_b32 v5, 10, v9
    v_lshl_add_u32 v5, v8, 4, v5
    s_lshl_b32 s52, s52, 15
    s_add_u32 s52, s52, s53
    s_lshl_b32 s53, s4, 6
    s_add_u32 s52, s52, s53
    v_add_u32 v5, s52, v5
    s_lshl_b32 s61, s61, 11
    v_lshlrev_b32 v7, 2, v0
    v_add_u32 v7, 294912, v7
    v_and_b32 v28, 31, v0
    v_lshlrev_b32 v28, 2, v28
    v_add_u32 v28, 294912, v28
s_waitcnt vmcnt(10)
s_barrier
s_add_u32 s53, s100, 6
s_and_b32 s53, s53, 7
s_add_u32 m0, s98, 90112
s_lshl_b32 s3, s53, 14
buffer_load_dwordx4 v20, s[40:43], s3 offen sc1 lds
buffer_load_dwordx4 v20, s[40:43], s3 offen offset:1024 sc1 lds
buffer_load_dwordx4 v20, s[40:43], s3 offen offset:2048 sc1 lds
buffer_load_dwordx4 v20, s[40:43], s3 offen offset:3072 sc1 lds
s_add_u32 s53, s100, 6
s_and_b32 s53, s53, 7
s_lshl_b32 s3, s53, 16
s_add_u32 s3, s3, s56
s_add_u32 m0, s97, 49152
s_nop 0
buffer_load_dwordx4 v21, s[16:19], s3 offen  lds
buffer_load_dwordx4 v22, s[16:19], s3 offen offset:1024  lds
s_add_u32 m0, s97, 57344
s_add_u32 s3, s3, 524288
buffer_load_dwordx4 v21, s[16:19], s3 offen  lds
buffer_load_dwordx4 v22, s[16:19], s3 offen offset:1024  lds
s_add_u32 m0, s97, 65536
s_add_u32 s3, s3, 524288
buffer_load_dwordx4 v21, s[16:19], s3 offen  lds
buffer_load_dwordx4 v22, s[16:19], s3 offen offset:1024  lds
s_waitcnt vmcnt(10)
s_barrier
s_add_u32 s53, s100, 7
s_and_b32 s53, s53, 7
s_add_u32 m0, s98, 106496
s_lshl_b32 s3, s53, 14
buffer_load_dwordx4 v20, s[40:43], s3 offen sc1 lds
buffer_load_dwordx4 v20, s[40:43], s3 offen offset:1024 sc1 lds
buffer_load_dwordx4 v20, s[40:43], s3 offen offset:2048 sc1 lds
buffer_load_dwordx4 v20, s[40:43], s3 offen offset:3072 sc1 lds
s_add_u32 s53, s100, 7
s_and_b32 s53, s53, 7
s_lshl_b32 s3, s53, 16
s_add_u32 s3, s3, s56
s_add_u32 m0, s97, 24576
s_nop 0
buffer_load_dwordx4 v21, s[16:19], s3 offen  lds
buffer_load_dwordx4 v22, s[16:19], s3 offen offset:1024  lds
s_add_u32 m0, s97, 32768
s_add_u32 s3, s3, 524288
buffer_load_dwordx4 v21, s[16:19], s3 offen  lds
buffer_load_dwordx4 v22, s[16:19], s3 offen offset:1024  lds
s_add_u32 m0, s97, 40960
s_add_u32 s3, s3, 524288
buffer_load_dwordx4 v21, s[16:19], s3 offen  lds
buffer_load_dwordx4 v22, s[16:19], s3 offen offset:1024  lds
s_waitcnt vmcnt(10)
s_barrier
s_sub_u32 s100, s5, s6
s_add_u32 s100, s100, 7
s_and_b32 s100, s100, 7
s_add_u32 s53, s100, 0
s_and_b32 s53, s53, 7
s_add_u32 m0, s97, 139264
s_lshl_b32 s3, s53, 16
s_add_u32 s3, s3, s56
buffer_load_dwordx4 v25, s[20:23], s3 offen  lds
buffer_load_dwordx4 v26, s[20:23], s3 offen offset:1024  lds
s_add_u32 s53, s100, 1
s_and_b32 s53, s53, 7
s_add_u32 m0, s97, 147456
s_lshl_b32 s3, s53, 16
s_add_u32 s3, s3, s56
buffer_load_dwordx4 v25, s[20:23], s3 offen  lds
buffer_load_dwordx4 v26, s[20:23], s3 offen offset:1024  lds
s_add_u32 s53, s100, 2
s_and_b32 s53, s53, 7
s_add_u32 m0, s97, 155648
s_lshl_b32 s3, s53, 16
s_add_u32 s3, s3, s56
buffer_load_dwordx4 v25, s[20:23], s3 offen  lds
buffer_load_dwordx4 v26, s[20:23], s3 offen offset:1024  lds
s_waitcnt vmcnt(6)
s_barrier
s_add_u32 s53, s100, 3
s_and_b32 s53, s53, 7
s_add_u32 m0, s97, 122880
s_lshl_b32 s3, s53, 16
s_add_u32 s3, s3, s56
s_waitcnt vmcnt(5)
buffer_load_dwordx4 v25, s[20:23], s3 offen  lds
s_waitcnt vmcnt(5)
buffer_load_dwordx4 v26, s[20:23], s3 offen offset:1024  lds
s_add_u32 s53, s100, 4
s_and_b32 s53, s53, 7
s_add_u32 m0, s97, 131072
s_lshl_b32 s3, s53, 16
s_add_u32 s3, s3, s56
s_waitcnt vmcnt(5)
buffer_load_dwordx4 v25, s[20:23], s3 offen  lds
s_waitcnt vmcnt(5)
buffer_load_dwordx4 v26, s[20:23], s3 offen offset:1024  lds
s_add_u32 s53, s100, 5
s_and_b32 s53, s53, 7
s_add_u32 m0, s97, 0
s_lshl_b32 s3, s53, 16
s_add_u32 s3, s3, s56
s_waitcnt vmcnt(5)
buffer_load_dwordx4 v25, s[20:23], s3 offen  lds
s_waitcnt vmcnt(5)
buffer_load_dwordx4 v26, s[20:23], s3 offen offset:1024  lds
s_add_u32 s53, s100, 6
s_and_b32 s53, s53, 7
s_add_u32 m0, s97, 8192
s_lshl_b32 s3, s53, 16
s_add_u32 s3, s3, s56
s_waitcnt vmcnt(5)
buffer_load_dwordx4 v25, s[20:23], s3 offen  lds
s_waitcnt vmcnt(5)
buffer_load_dwordx4 v26, s[20:23], s3 offen offset:1024  lds
s_add_u32 s53, s100, 7
s_and_b32 s53, s53, 7
s_add_u32 m0, s97, 16384
s_lshl_b32 s3, s53, 16
s_add_u32 s3, s3, s56
s_waitcnt vmcnt(5)
buffer_load_dwordx4 v25, s[20:23], s3 offen  lds
s_waitcnt vmcnt(5)
buffer_load_dwordx4 v26, s[20:23], s3 offen offset:1024  lds
s_waitcnt vmcnt(5)
buffer_load_dwordx4 a[0:3], v12, s[92:95], s61 offen offset:0 sc1
s_waitcnt vmcnt(5)
buffer_load_dwordx4 a[4:7], v12, s[92:95], s61 offen offset:1024 sc1
s_waitcnt vmcnt(5)
buffer_load_dwordx4 a[8:11], v12, s[92:95], s61 offen offset:2048 sc1
s_waitcnt vmcnt(5)
buffer_load_dwordx4 a[12:15], v12, s[92:95], s61 offen offset:3072 sc1
s_add_u32 s61, s61, 4096
s_and_b32 s61, s61, 0x7fff
s_waitcnt vmcnt(5)
buffer_load_dwordx4 a[16:19], v12, s[92:95], s61 offen offset:0 sc1
s_waitcnt vmcnt(5)
buffer_load_dwordx4 a[20:23], v12, s[92:95], s61 offen offset:1024 sc1
s_waitcnt vmcnt(6)
s_barrier
s_mov_b32 s57, 0
L_poll_6:
    buffer_load_dword v4, v28, s[40:43], 0 offen offset:128 sc1
    s_add_u32 s57, s57, 1
    s_cmp_gt_u32 s57, 200000
    s_cbranch_scc1 L_got_7
    s_waitcnt vmcnt(0)
    v_cmp_eq_u32 vcc, 0, v4
    s_cbranch_vccnz L_poll_6
L_got_7:
    s_waitcnt vmcnt(0)
s_add_u32 s53, s100, 1
s_and_b32 s53, s53, 7
s_add_u32 m0, s96, 24576
s_lshl_b32 s3, s53, 13
s_add_u32 s3, s3, 131072
buffer_load_dwordx4 v24, s[40:43], s3 offen sc1 lds
s_add_u32 s53, s100, 2
s_and_b32 s53, s53, 7
s_add_u32 m0, s96, 32768
s_lshl_b32 s3, s53, 13
s_add_u32 s3, s3, 131072
buffer_load_dwordx4 v24, s[40:43], s3 offen sc1 lds
s_add_u32 s53, s100, 3
s_and_b32 s53, s53, 7
s_add_u32 m0, s96, 40960
s_lshl_b32 s3, s53, 13
s_add_u32 s3, s3, 131072
buffer_load_dwordx4 v24, s[40:43], s3 offen sc1 lds
buffer_load_dword v4, v28, s[40:43], 0 offen offset:512 sc1
s_add_u32 s53, s100, 4
s_and_b32 s53, s53, 7
s_add_u32 m0, s96, 49152
s_lshl_b32 s3, s53, 13
s_add_u32 s3, s3, 131072
buffer_load_dwordx4 v24, s[40:43], s3 offen sc1 lds
s_add_u32 s53, s100, 5
s_and_b32 s53, s53, 7
s_add_u32 m0, s96, 57344
s_lshl_b32 s3, s53, 13
s_add_u32 s3, s3, 131072
buffer_load_dwordx4 v24, s[40:43], s3 offen sc1 lds
s_add_u32 s53, s100, 6
s_and_b32 s53, s53, 7
s_add_u32 m0, s96, 65536
s_lshl_b32 s3, s53, 13
s_add_u32 s3, s3, 131072
buffer_load_dwordx4 v24, s[40:43], s3 offen sc1 lds
s_add_u32 s53, s100, 7
s_and_b32 s53, s53, 7
s_add_u32 m0, s96, 90112
s_lshl_b32 s3, s53, 13
s_add_u32 s3, s3, 131072
buffer_load_dwordx4 v24, s[40:43], s3 offen sc1 lds
s_waitcnt vmcnt(4)
s_barrier
v_cmp_eq_u32 vcc, 0, v4
s_cbranch_vccnz L_fb_late
s_add_u32 s53, s100, 1
s_and_b32 s53, s53, 7
s_add_u32 m0, s96, 24576
s_lshl_b32 s3, s53, 13
s_add_u32 s3, s3, 131072
buffer_load_dwordx4 v24, s[40:43], s3 offen offset:2048 sc1 lds
s_add_u32 s53, s100, 2
s_and_b32 s53, s53, 7
s_add_u32 m0, s96, 32768
s_lshl_b32 s3, s53, 13
s_add_u32 s3, s3, 131072
buffer_load_dwordx4 v24, s[40:43], s3 offen offset:2048 sc1 lds
s_add_u32 s53, s100, 3
s_and_b32 s53, s53, 7
s_add_u32 m0, s96, 40960
s_lshl_b32 s3, s53, 13
s_add_u32 s3, s3, 131072
buffer_load_dwordx4 v24, s[40:43], s3 offen offset:2048 sc1 lds
s_add_u32 s53, s100, 4
s_and_b32 s53, s53, 7
s_add_u32 m0, s96, 49152
s_lshl_b32 s3, s53, 13
s_add_u32 s3, s3, 131072
buffer_load_dwordx4 v24, s[40:43], s3 offen offset:2048 sc1 lds
s_add_u32 s53, s100, 5
s_and_b32 s53, s53, 7
s_add_u32 m0, s96, 57344
s_lshl_b32 s3, s53, 13
s_add_u32 s3, s3, 131072
buffer_load_dwordx4 v24, s[40:43], s3 offen offset:2048 sc1 lds
s_add_u32 s53, s100, 6
s_and_b32 s53, s53, 7
s_add_u32 m0, s96, 65536
s_lshl_b32 s3, s53, 13
s_add_u32 s3, s3, 131072
buffer_load_dwordx4 v24, s[40:43], s3 offen offset:2048 sc1 lds
s_add_u32 s53, s100, 7
s_and_b32 s53, s53, 7
s_add_u32 m0, s96, 90112
s_lshl_b32 s3, s53, 13
s_add_u32 s3, s3, 131072
buffer_load_dwordx4 v24, s[40:43], s3 offen offset:2048 sc1 lds
s_waitcnt vmcnt(7)
s_barrier
L_fb_join:
buffer_load_dwordx4 a[24:27], v12, s[92:95], s61 offen offset:2048 sc1
buffer_load_dwordx4 a[28:31], v12, s[92:95], s61 offen offset:3072 sc1
s_add_u32 s61, s61, 4096
s_and_b32 s61, s61, 0x7fff
buffer_load_dwordx4 a[32:35], v12, s[92:95], s61 offen offset:0 sc1
buffer_load_dwordx4 a[36:39], v12, s[92:95], s61 offen offset:1024 sc1
s_waitcnt vmcnt(4)
s_barrier
s_mov_b32 s57, 0
L_poll_8:
    buffer_load_dword v4, v28, s[40:43], 0 offen offset:384 sc1
    s_add_u32 s57, s57, 1
    s_cmp_gt_u32 s57, 200000
    s_cbranch_scc1 L_got_9
    s_waitcnt vmcnt(0)
    v_cmp_eq_u32 vcc, 0, v4
    s_cbranch_vccnz L_poll_8
L_got_9:
    s_waitcnt vmcnt(0)
v_lshlrev_b32 v29, 4, v0
s_add_u32 m0, s98, 106496
s_add_u32 s3, s98, 262144
buffer_load_dwordx4 v29, s[40:43], s3 offen sc1 lds
buffer_load_dwordx4 v29, s[40:43], s3 offen offset:1024 sc1 lds
buffer_load_dwordx4 v29, s[40:43], s3 offen offset:2048 sc1 lds
buffer_load_dwordx4 v29, s[40:43], s3 offen offset:3072 sc1 lds
buffer_load_dwordx4 a[40:43], v12, s[92:95], s61 offen offset:2048 sc1
s_waitcnt vmcnt(4)
buffer_load_dwordx4 a[44:47], v12, s[92:95], s61 offen offset:3072 sc1
s_add_u32 s61, s61, 4096
s_and_b32 s61, s61, 0x7fff
s_waitcnt vmcnt(4)
buffer_load_dwordx4 a[48:51], v12, s[92:95], s61 offen offset:0 sc1
s_waitcnt vmcnt(4)
buffer_load_dwordx4 a[52:55], v12, s[92:95], s61 offen offset:1024 sc1
s_branch L_joint_l
L_compute:
s_waitcnt lgkmcnt(0)
    s_mul_i32 s3, s49, 4096000
    s_add_u32 s8, s64, s3
    s_addc_u32 s9, s65, 0
    s_mov_b32 s10, 4096000
    s_mov_b32 s11, 0x20000
    s_mov_b32 s12, s66
    s_mov_b32 s13, s67
    s_mov_b32 s14, 1572864
    s_mov_b32 s15, 0x20000
s_mov_b32 s16, s68
s_mov_b32 s17, s69
s_mov_b32 s18, 1572864
s_mov_b32 s19, 0x20000
s_mov_b32 s20, s72
s_mov_b32 s21, s73
s_mov_b32 s22, 524288
s_mov_b32 s23, 0x20000
s_mov_b32 s24, s74
s_mov_b32 s25, s75
s_mov_b32 s26, 524288
s_mov_b32 s27, 0x20000
s_mov_b32 s28, s76
s_mov_b32 s29, s77
s_mov_b32 s30, 524288
s_mov_b32 s31, 0x20000
s_mov_b32 s32, s70
s_mov_b32 s33, s71
s_mov_b32 s34, 16384
s_mov_b32 s35, 0x20000
s_mov_b32 s44, s80
s_mov_b32 s45, s81
s_mov_b32 s46, 256
s_mov_b32 s47, 0x20000
s_mul_i32 s3, s49, 1000
    s_mul_i32 s52, s48, 63
    s_add_u32 s3, s3, s52
    s_lshl_b32 s3, s3, 13
    s_add_u32 s36, s78, s3
    s_addc_u32 s37, s79, 0
    s_mov_b32 s38, 516096
    s_cmp_eq_u32 s48, 15
    s_cselect_b32 s38, 450560, s38
    s_mov_b32 s39, 0x20000
    s_lshl_b32 s3, s7, 19
    s_add_u32 s40, s82, s3
    s_addc_u32 s41, s83, 0
    s_mov_b32 s42, 0x80000
    s_mov_b32 s43, 0x20000
    s_add_u32 s92, s82, 0x1000000
    s_addc_u32 s93, s83, 0
    s_mov_b32 s94, 0xc0000
    s_mov_b32 s95, 0x20000
    s_mov_b32 s100, s5
    s_mov_b32 s60, 0xbdd2d3e8
    s_mov_b32 s61, 0xbdd2d3e8
    s_mov_b32 s62, 0x4038aa3b

    s_lshl_b32 s3, s5, 2
    s_add_u32 s3, s3, s4
    s_lshl_b32 s3, s3, 2
    s_add_u32 s3, s3, 294912
    v_mov_b32 v2, s3
    v_mov_b32 v3, 1
    s_getreg_b32 s52, hwreg(HW_REG_XCC_ID, 0, 4)
    s_or_b32 s52, s52, 0x80
    v_mov_b32 v120, s52
    s_lshl_b32 s52, s7, 3
    s_add_u32 s52, s52, s5
    v_mov_b32 v121, s52
    s_cmp_lg_u32 s4, 0
    s_cbranch_scc1 L_noclear
    v_lshrrev_b32 v4, 2, v0
    v_lshlrev_b32 v4, 7, v4
    v_and_b32 v5, 3, v0
    v_lshl_add_u32 v4, v5, 2, v4
    v_add_u32 v4, s3, v4
    v_mov_b32 v5, 0
    s_mov_b64 exec, 0xffffff
    buffer_store_dword v5, v4, s[40:43], 0 offen sc1
    s_mov_b64 exec, -1
    v_lshrrev_b32 v26, 3, v0
    v_and_b32 v27, 7, v0
    v_bfe_u32 v28, v0, 4, 1
    v_lshlrev_b32 v28, 2, v28
    v_xor_b32 v28, v28, v27
    v_lshlrev_b32 v28, 4, v28
    v_lshl_add_u32 v28, v26, 10, v28
    s_and_b32 s52, s2, 7
    s_lshl_b32 s52, s52, 7
    v_add_u32 v28, s52, v28
    v_add_u32 v29, 7168, v28
    s_mov_b32 m0, 114688
    s_lshr_b32 s52, s2, 3
    s_lshl_b32 s52, s52, 14
    buffer_load_dwordx4 v28, s[28:31], s52 offen lds
    buffer_load_dwordx4 v29, s[28:31], s52 offen offset:1024 lds
    s_lshr_b32 s52, s2, 3
    s_and_b32 s53, s52, 3
    s_and_b32 s54, s2, 7
    s_lshl_b32 s54, s54, 2
    s_add_u32 s53, s53, s54
    s_lshr_b32 s52, s52, 2
    s_lshl_b32 s55, s53, 3
    s_add_u32 s55, s55, s52
    s_lshl_b32 s55, s55, 10
    s_add_u32 s55, s55, 524288
    v_lshrrev_b32 v28, 1, v0
    v_and_b32 v29, 1, v0
    v_lshlrev_b32 v29, 4, v29
    v_lshl_add_u32 v28, v28, 10, v29
    v_add_u32 v29, 31744, v28
    s_mov_b32 m0, 116736
    s_lshl_b32 s54, s52, 16
    s_lshl_b32 s53, s53, 5
    s_add_u32 s54, s54, s53
    buffer_load_dwordx4 v28, s[24:27], s54 offen lds
    buffer_load_dwordx4 v29, s[24:27], s54 offen offset:1024 lds
    v_lshlrev_b32 v27, 4, v27
    v_lshl_add_u32 v28, v26, 10, v27
    v_add_u32 v29, 7168, v28
    s_mov_b32 m0, 118784
    s_lshl_b32 s54, s52, 7
    buffer_load_dwordx4 v28, s[32:35], s54 offen lds
    buffer_load_dwordx4 v29, s[32:35], s54 offen offset:1024 lds
L_noclear:
    v_lshlrev_b32 v7, 2, v0
    s_cmp_lg_u32 s4, 1
    s_cbranch_scc1 L_notouch
    s_getpc_b64 s[58:59]
L_pc0:
    s_sub_u32 s58, s58, L_pc0-L_pc
    s_subb_u32 s59, s59, 0
    s_lshr_b32 s52, s2, 3
    s_mul_i32 s52, s52, 1408
    v_lshlrev_b32 v26, 7, v0
    v_add_u32 v26, s52, v26
    v_cmp_gt_u32 vcc, L_end-L_pc, v26
    s_and_b32 vcc_lo, vcc_lo, 2047
    s_mov_b32 vcc_hi, 0
    v_mov_b32 v27, s59
    s_and_saveexec_b64 s[84:85], vcc
    s_cbranch_execz L_notouch2
    v_add_co_u32 v26, vcc, s58, v26
    s_nop 1
    v_addc_co_u32 v27, vcc, 0, v27, vcc
    global_load_dword v31, v[26:27], off
L_notouch2:
    s_mov_b64 exec, -1
L_notouch:
    s_and_b32 s3, s4, 1
    s_lshr_b32 s52, s4, 1
    v_lshrrev_b32 v27, 4, v0
    v_bfe_u32 v26, v0, 2, 2
    v_lshl_add_u32 v28, v27, 3, v26
    v_lshlrev_b32 v28, 7, v28
    v_lshrrev_b32 v26, 1, v26
    v_and_b32 v29, 1, v27
    v_lshl_add_u32 v26, v29, 1, v26
    s_lshl_b32 s53, s3, 1
    v_xor_b32 v26, s53, v26
    v_lshl_add_u32 v28, v26, 5, v28
    v_and_b32 v26, 3, v0
    v_lshl_add_u32 v16, v26, 3, v28
    v_xor_b32 v17, 32, v16
    v_add_u32 v18, 57344, v16
    v_add_u32 v19, 57344, v17
    v_and_b32 v26, 15, v0
    v_lshrrev_b32 v28, 1, v27
    v_lshl_add_u32 v27, v29, 1, v28
    s_lshl_b32 s53, s3, 2
    v_add_u32 v27, s53, v27
    v_lshrrev_b32 v29, 1, v26
    v_and_b32 v28, 6, v29
    v_xor_b32 v28, v28, v27
    v_lshlrev_b32 v28, 4, v28
    v_lshl_add_u32 v28, v29, 7, v28
    v_and_b32 v30, 1, v26
    v_lshl_add_u32 v28, v30, 13, v28
    s_lshl_b32 s53, s5, 14
    v_add_u32 v5, s53, v28
    v_lshlrev_b32 v28, 4, v27
    v_lshl_add_u32 v28, v26, 7, v28
    s_add_u32 s53, s5, 2
s_and_b32 s53, s53, 7
s_lshl_b32 s53, s53, 14
    v_add_u32 v23, s53, v28
    v_and_b32 v28, 6, v26
    v_xor_b32 v28, v28, v27
    v_lshlrev_b32 v28, 4, v28
    v_lshl_add_u32 v28, v26, 7, v28
    s_sub_u32 s53, s5, s6
s_add_u32 s53, s53, 7
s_and_b32 s53, s53, 7
s_lshl_b32 s53, s53, 13
    v_add_u32 v22, s53, v28
    s_or_b32 s53, s48, s52
    s_cmp_eq_u32 s53, 0
    s_cselect_b32 s58, 0x00010001, 0
    s_mov_b32 s59, s58
    s_lshl_b32 s53, s52, 13
    v_mov_b32 v24, 0xc0135761
    v_mov_b32 v25, 0xc0135761
v_and_b32 v26, 15, v0
v_and_b32 v27, 6, v26
    v_lshrrev_b32 v30, 4, v0
    v_xor_b32 v27, v27, v30
    v_lshlrev_b32 v27, 4, v27
    v_lshl_add_u32 v27, v26, 7, v27
    v_add_u32 v8, s53, v27
v_xor_b32 v9, 64, v8
v_and_b32 v26, 15, v0
v_add_u32 v26, 1, v26
v_and_b32 v27, 6, v26
    v_lshrrev_b32 v30, 4, v0
    v_xor_b32 v27, v27, v30
    v_lshlrev_b32 v27, 4, v27
    v_lshl_add_u32 v27, v26, 7, v27
    v_add_u32 v10, s53, v27
v_xor_b32 v11, 64, v10
v_add_u32 v12, 57344, v8
v_add_u32 v13, 57344, v9
v_add_u32 v14, 57344, v10
v_add_u32 v15, 57344, v11
s_cmp_lg_u32 s4, 0
    s_cbranch_scc1 L_noprep
    v_bfe_u32 v26, v0, 2, 2
    v_lshrrev_b32 v27, 5, v0
    v_lshl_add_u32 v27, v27, 3, v26
    v_lshlrev_b32 v27, 7, v27
    v_and_b32 v28, 1, v0
    v_lshlrev_b32 v28, 1, v28
    v_bfe_u32 v29, v0, 4, 1
    v_add_u32 v28, v28, v29
    v_bfe_u32 v29, v0, 3, 1
    v_lshlrev_b32 v29, 2, v29
    v_xor_b32 v28, v28, v29
    v_lshl_add_u32 v27, v28, 4, v27
    v_bfe_u32 v29, v0, 1, 1
    v_lshl_add_u32 v26, v29, 3, v27
    v_add_u32 v26, 114688, v26
    v_xor_b32 v27, 64, v26
    s_and_b32 s3, s2, 7
    s_lshl_b32 s3, s3, 16
    s_lshr_b32 s52, s2, 3
    s_lshl_b32 s52, s52, 10
    s_add_u32 s3, s3, s52
    s_add_u32 s52, s3, 32768
    v_lshlrev_b32 v30, 4, v0
    v_lshrrev_b32 v28, 4, v0
    v_bfe_u32 v29, v0, 2, 2
    v_lshl_add_u32 v29, v28, 3, v29
    v_lshlrev_b32 v29, 5, v29
    v_and_b32 v31, 3, v0
    v_lshl_add_u32 v29, v31, 3, v29
    v_add_u32 v29, 116736, v29
    v_and_b32 v31, 15, v0
    v_lshlrev_b32 v31, 7, v31
    v_lshl_add_u32 v28, v28, 4, v31
    v_add_u32 v28, 118784, v28
    s_waitcnt vmcnt(0)
    ds_read_b64_tr_b16 v[40:41], v29
    ds_read_b64_tr_b16 v[42:43], v29 offset:128
    ds_read_b128 v[44:47], v28
    ds_read_b64_tr_b16 v[48:49], v29 offset:1024
    ds_read_b64_tr_b16 v[50:51], v29 offset:1152
    ds_read_b128 v[52:55], v28 offset:64
    ds_read_b64_tr_b16 v[32:33], v26
    ds_read_b64_tr_b16 v[34:35], v26 offset:512
    ds_read_b64_tr_b16 v[36:37], v27
    ds_read_b64_tr_b16 v[38:39], v27 offset:512
    s_waitcnt lgkmcnt(0)
    v_mfma_f32_16x16x32_bf16 v[56:59], v[40:43], v[44:47], 0
    v_mfma_f32_16x16x32_bf16 v[56:59], v[48:51], v[52:55], v[56:59]
    buffer_store_dwordx4 v[32:35], v30, s[92:95], s3 offen sc1
    buffer_store_dwordx4 v[36:39], v30, s[92:95], s52 offen sc1
    s_nop 7
    buffer_store_dwordx4 v[56:59], v30, s[92:95], s55 offen sc1
L_noprep:
s_barrier
ds_read_b64_tr_b16 v[96:97], v16 offset:16384
ds_read_b64_tr_b16 v[98:99], v16 offset:16896
ds_read_b64_tr_b16 v[100:101], v17 offset:16384
ds_read_b64_tr_b16 v[102:103], v17 offset:16896
ds_read_b128 v[64:67], v8 offset:0
ds_read_b128 v[68:71], v8 offset:2048
ds_read_b128 v[72:75], v8 offset:4096
ds_read_b128 v[76:79], v8 offset:6144
s_waitcnt lgkmcnt(3)
v_mfma_f32_16x16x32_bf16 v[32:35], v[96:99], v[64:67], 0
ds_read_b64_tr_b16 v[104:105], v16 offset:20480
ds_read_b64_tr_b16 v[106:107], v16 offset:20992
v_mfma_f32_16x16x32_bf16 v[36:39], v[100:103], v[64:67], 0
ds_read_b64_tr_b16 v[108:109], v17 offset:20480
s_waitcnt lgkmcnt(5)
v_mfma_f32_16x16x32_bf16 v[40:43], v[96:99], v[68:71], 0
ds_read_b64_tr_b16 v[110:111], v17 offset:20992
ds_read_b128 v[80:83], v9 offset:0
v_mfma_f32_16x16x32_bf16 v[44:47], v[100:103], v[68:71], 0
ds_read_b128 v[84:87], v9 offset:2048
s_waitcnt lgkmcnt(7)
v_mfma_f32_16x16x32_bf16 v[48:51], v[96:99], v[72:75], 0
ds_read_b128 v[64:67], v9 offset:4096
v_mfma_f32_16x16x32_bf16 v[52:55], v[100:103], v[72:75], 0
s_waitcnt lgkmcnt(7)
v_mfma_f32_16x16x32_bf16 v[56:59], v[96:99], v[76:79], 0
ds_read_b128 v[68:71], v9 offset:6144
v_mfma_f32_16x16x32_bf16 v[60:63], v[100:103], v[76:79], 0
s_waitcnt lgkmcnt(3)
v_mfma_f32_16x16x32_bf16 v[32:35], v[104:107], v[80:83], v[32:35]
ds_read_b64_tr_b16 v[112:113], v16 offset:24576
ds_read_b64_tr_b16 v[114:115], v16 offset:25088
v_mfma_f32_16x16x32_bf16 v[36:39], v[108:111], v[80:83], v[36:39]
ds_read_b64_tr_b16 v[116:117], v17 offset:24576
s_waitcnt lgkmcnt(5)
v_mfma_f32_16x16x32_bf16 v[40:43], v[104:107], v[84:87], v[40:43]
ds_read_b64_tr_b16 v[118:119], v17 offset:25088
ds_read_b128 v[72:75], v10 offset:0
v_mfma_f32_16x16x32_bf16 v[44:47], v[108:111], v[84:87], v[44:47]
ds_read_b128 v[76:79], v10 offset:2048
s_waitcnt lgkmcnt(7)
v_mfma_f32_16x16x32_bf16 v[48:51], v[104:107], v[64:67], v[48:51]
ds_read_b128 v[80:83], v10 offset:4096
v_mfma_f32_16x16x32_bf16 v[52:55], v[108:111], v[64:67], v[52:55]
s_waitcnt lgkmcnt(7)
v_mfma_f32_16x16x32_bf16 v[56:59], v[104:107], v[68:71], v[56:59]
ds_read_b128 v[84:87], v10 offset:6144
v_mfma_f32_16x16x32_bf16 v[60:63], v[108:111], v[68:71], v[60:63]
s_waitcnt lgkmcnt(3)
v_mfma_f32_16x16x32_bf16 v[32:35], v[112:115], v[72:75], v[32:35]
ds_read_b64_tr_b16 v[96:97], v16 offset:28672
ds_read_b64_tr_b16 v[98:99], v16 offset:29184
v_mfma_f32_16x16x32_bf16 v[36:39], v[116:119], v[72:75], v[36:39]
ds_read_b64_tr_b16 v[100:101], v17 offset:28672
s_waitcnt lgkmcnt(5)
v_mfma_f32_16x16x32_bf16 v[40:43], v[112:115], v[76:79], v[40:43]
ds_read_b64_tr_b16 v[102:103], v17 offset:29184
ds_read_b128 v[64:67], v11 offset:0
v_mfma_f32_16x16x32_bf16 v[44:47], v[116:119], v[76:79], v[44:47]
ds_read_b128 v[68:71], v11 offset:2048
s_waitcnt lgkmcnt(7)
v_mfma_f32_16x16x32_bf16 v[48:51], v[112:115], v[80:83], v[48:51]
ds_read_b128 v[72:75], v11 offset:4096
v_mfma_f32_16x16x32_bf16 v[52:55], v[116:119], v[80:83], v[52:55]
s_waitcnt lgkmcnt(7)
v_mfma_f32_16x16x32_bf16 v[56:59], v[112:115], v[84:87], v[56:59]
ds_read_b128 v[76:79], v11 offset:6144
v_mfma_f32_16x16x32_bf16 v[60:63], v[116:119], v[84:87], v[60:63]
s_waitcnt lgkmcnt(3)
v_mfma_f32_16x16x32_bf16 v[32:35], v[96:99], v[64:67], v[32:35]
s_waitcnt lgkmcnt(0)
s_barrier
s_cmp_lg_u32 s4, 0
s_cbranch_scc1 L_pb_10
s_mov_b64 exec, 1
s_waitcnt vmcnt(0)
buffer_store_byte v120, v121, s[44:47], 0 offen sc1
s_mov_b64 exec, -1
L_pb_10:
s_cmp_lg_u32 s4, 1
    s_cbranch_scc1 L_tc_11
    s_cmp_eq_u32 s5, 3
    s_cbranch_scc1 L_tc_11
    s_mul_i32 s3, s7, 7
    s_add_u32 s3, s3, s5
    s_cmp_gt_u32 s5, 3
    s_subb_u32 s3, s3, 0
    s_mul_i32 s3, s3, 7040
    v_lshlrev_b32 v30, 7, v0
    s_mov_b32 exec_lo, 0xffffffff
    s_mov_b32 exec_hi, 0x7fffff
    buffer_load_dword v31, v30, s[16:19], s3 offen offset:0
    s_mov_b64 exec, -1
L_tc_11:
s_cmp_lg_u32 s4, 2
    s_cbranch_scc1 L_tc_12
    s_cmp_eq_u32 s5, 3
    s_cbranch_scc1 L_tc_12
    s_mul_i32 s3, s7, 7
    s_add_u32 s3, s3, s5
    s_cmp_gt_u32 s5, 3
    s_subb_u32 s3, s3, 0
    s_mul_i32 s3, s3, 2432
    v_lshlrev_b32 v30, 7, v0
    s_mov_b32 exec_lo, 0x7ffff
    s_mov_b32 exec_hi, 0x0
    buffer_load_dword v31, v30, s[20:23], s3 offen offset:0
    s_mov_b64 exec, -1
L_tc_12:
s_cmp_lg_u32 s4, 1
    s_cbranch_scc1 L_tc_13
    s_cmp_eq_u32 s5, 3
    s_cbranch_scc1 L_tc_13
    s_mul_i32 s3, s6, 7
    s_add_u32 s3, s3, s5
    s_cmp_gt_u32 s5, 3
    s_subb_u32 s3, s3, 0
    s_mul_i32 s3, s3, 56320
    v_lshlrev_b32 v30, 10, v0
    s_mov_b32 exec_lo, 0xffffffff
    s_mov_b32 exec_hi, 0x7fffff
    buffer_load_dword v31, v30, s[16:19], s3 offen offset:384
    s_mov_b64 exec, -1
L_tc_13:
s_cmp_lg_u32 s4, 3
    s_cbranch_scc1 L_tc_14
    s_cmp_eq_u32 s5, 3
    s_cbranch_scc1 L_tc_14
    s_mul_i32 s3, s6, 7
    s_add_u32 s3, s3, s5
    s_cmp_gt_u32 s5, 3
    s_subb_u32 s3, s3, 0
    s_mul_i32 s3, s3, 19456
    v_lshlrev_b32 v30, 10, v0
    s_mov_b32 exec_lo, 0x7ffff
    s_mov_b32 exec_hi, 0x0
    buffer_load_dword v31, v30, s[20:23], s3 offen offset:384
    s_mov_b64 exec, -1
L_tc_14:
ds_read_b64_tr_b16 v[104:105], v16 offset:49152
ds_read_b64_tr_b16 v[106:107], v16 offset:49664
v_mfma_f32_16x16x32_bf16 v[36:39], v[100:103], v[64:67], v[36:39]
ds_read_b64_tr_b16 v[108:109], v17 offset:49152
s_waitcnt lgkmcnt(5)
v_mfma_f32_16x16x32_bf16 v[40:43], v[96:99], v[68:71], v[40:43]
ds_read_b64_tr_b16 v[110:111], v17 offset:49664
ds_read_b128 v[80:83], v8 offset:32768
v_mfma_f32_16x16x32_bf16 v[44:47], v[100:103], v[68:71], v[44:47]
ds_read_b128 v[84:87], v8 offset:34816
s_waitcnt lgkmcnt(7)
v_mfma_f32_16x16x32_bf16 v[48:51], v[96:99], v[72:75], v[48:51]
ds_read_b128 v[64:67], v8 offset:36864
v_mfma_f32_16x16x32_bf16 v[52:55], v[100:103], v[72:75], v[52:55]
s_waitcnt lgkmcnt(7)
v_mfma_f32_16x16x32_bf16 v[56:59], v[96:99], v[76:79], v[56:59]
ds_read_b128 v[68:71], v8 offset:38912
v_mfma_f32_16x16x32_bf16 v[60:63], v[100:103], v[76:79], v[60:63]
s_waitcnt lgkmcnt(3)
v_mfma_f32_16x16x32_bf16 v[32:35], v[104:107], v[80:83], v[32:35]
ds_read_b64_tr_b16 v[112:113], v16 offset:53248
ds_read_b64_tr_b16 v[114:115], v16 offset:53760
v_mfma_f32_16x16x32_bf16 v[36:39], v[108:111], v[80:83], v[36:39]
ds_read_b64_tr_b16 v[116:117], v17 offset:53248
s_waitcnt lgkmcnt(5)
v_mfma_f32_16x16x32_bf16 v[40:43], v[104:107], v[84:87], v[40:43]
ds_read_b64_tr_b16 v[118:119], v17 offset:53760
ds_read_b128 v[72:75], v9 offset:32768
v_mfma_f32_16x16x32_bf16 v[44:47], v[108:111], v[84:87], v[44:47]
ds_read_b128 v[76:79], v9 offset:34816
s_waitcnt lgkmcnt(7)
v_mfma_f32_16x16x32_bf16 v[48:51], v[104:107], v[64:67], v[48:51]
ds_read_b128 v[80:83], v9 offset:36864
v_mfma_f32_16x16x32_bf16 v[52:55], v[108:111], v[64:67], v[52:55]
s_waitcnt lgkmcnt(7)
v_mfma_f32_16x16x32_bf16 v[56:59], v[104:107], v[68:71], v[56:59]
ds_read_b128 v[84:87], v9 offset:38912
v_mfma_f32_16x16x32_bf16 v[60:63], v[108:111], v[68:71], v[60:63]
s_waitcnt lgkmcnt(3)
v_mfma_f32_16x16x32_bf16 v[32:35], v[112:115], v[72:75], v[32:35]
s_waitcnt lgkmcnt(0)
s_barrier
ds_read_b64_tr_b16 v[96:97], v18 offset:16384
ds_read_b64_tr_b16 v[98:99], v18 offset:16896
v_mfma_f32_16x16x32_bf16 v[36:39], v[116:119], v[72:75], v[36:39]
ds_read_b64_tr_b16 v[100:101], v19 offset:16384
s_waitcnt lgkmcnt(5)
v_mfma_f32_16x16x32_bf16 v[40:43], v[112:115], v[76:79], v[40:43]
ds_read_b64_tr_b16 v[102:103], v19 offset:16896
ds_read_b128 v[64:67], v12 offset:0
v_mfma_f32_16x16x32_bf16 v[44:47], v[116:119], v[76:79], v[44:47]
ds_read_b128 v[68:71], v12 offset:2048
s_waitcnt lgkmcnt(7)
v_mfma_f32_16x16x32_bf16 v[48:51], v[112:115], v[80:83], v[48:51]
ds_read_b128 v[72:75], v12 offset:4096
v_mfma_f32_16x16x32_bf16 v[52:55], v[116:119], v[80:83], v[52:55]
s_waitcnt lgkmcnt(7)
v_mfma_f32_16x16x32_bf16 v[56:59], v[112:115], v[84:87], v[56:59]
ds_read_b128 v[76:79], v12 offset:6144
v_mfma_f32_16x16x32_bf16 v[60:63], v[116:119], v[84:87], v[60:63]
s_waitcnt lgkmcnt(3)
v_mfma_f32_16x16x32_bf16 v[32:35], v[96:99], v[64:67], v[32:35]
ds_read_b64_tr_b16 v[104:105], v18 offset:20480
ds_read_b64_tr_b16 v[106:107], v18 offset:20992
v_mfma_f32_16x16x32_bf16 v[36:39], v[100:103], v[64:67], v[36:39]
ds_read_b64_tr_b16 v[108:109], v19 offset:20480
s_waitcnt lgkmcnt(5)
v_mfma_f32_16x16x32_bf16 v[40:43], v[96:99], v[68:71], v[40:43]
ds_read_b64_tr_b16 v[110:111], v19 offset:20992
ds_read_b128 v[80:83], v13 offset:0
v_mfma_f32_16x16x32_bf16 v[44:47], v[100:103], v[68:71], v[44:47]
ds_read_b128 v[84:87], v13 offset:2048
s_waitcnt lgkmcnt(7)
v_mfma_f32_16x16x32_bf16 v[48:51], v[96:99], v[72:75], v[48:51]
ds_read_b128 v[64:67], v13 offset:4096
v_mfma_f32_16x16x32_bf16 v[52:55], v[100:103], v[72:75], v[52:55]
s_waitcnt lgkmcnt(7)
v_mfma_f32_16x16x32_bf16 v[56:59], v[96:99], v[76:79], v[56:59]
ds_read_b128 v[68:71], v13 offset:6144
v_mfma_f32_16x16x32_bf16 v[60:63], v[100:103], v[76:79], v[60:63]
s_waitcnt lgkmcnt(3)
v_mfma_f32_16x16x32_bf16 v[32:35], v[104:107], v[80:83], v[32:35]
ds_read_b64_tr_b16 v[112:113], v18 offset:24576
ds_read_b64_tr_b16 v[114:115], v18 offset:25088
v_mfma_f32_16x16x32_bf16 v[36:39], v[108:111], v[80:83], v[36:39]
ds_read_b64_tr_b16 v[116:117], v19 offset:24576
s_waitcnt lgkmcnt(5)
v_mfma_f32_16x16x32_bf16 v[40:43], v[104:107], v[84:87], v[40:43]
ds_read_b64_tr_b16 v[118:119], v19 offset:25088
ds_read_b128 v[72:75], v14 offset:0
v_mfma_f32_16x16x32_bf16 v[44:47], v[108:111], v[84:87], v[44:47]
ds_read_b128 v[76:79], v14 offset:2048
s_waitcnt lgkmcnt(7)
v_mfma_f32_16x16x32_bf16 v[48:51], v[104:107], v[64:67], v[48:51]
ds_read_b128 v[80:83], v14 offset:4096
v_mfma_f32_16x16x32_bf16 v[52:55], v[108:111], v[64:67], v[52:55]
s_waitcnt lgkmcnt(7)
v_mfma_f32_16x16x32_bf16 v[56:59], v[104:107], v[68:71], v[56:59]
ds_read_b128 v[84:87], v14 offset:6144
v_mfma_f32_16x16x32_bf16 v[60:63], v[108:111], v[68:71], v[60:63]
s_waitcnt lgkmcnt(3)
v_mfma_f32_16x16x32_bf16 v[32:35], v[112:115], v[72:75], v[32:35]
ds_read_b64_tr_b16 v[96:97], v18 offset:28672
ds_read_b64_tr_b16 v[98:99], v18 offset:29184
v_mfma_f32_16x16x32_bf16 v[36:39], v[116:119], v[72:75], v[36:39]
ds_read_b64_tr_b16 v[100:101], v19 offset:28672
s_waitcnt lgkmcnt(5)
v_mfma_f32_16x16x32_bf16 v[40:43], v[112:115], v[76:79], v[40:43]
ds_read_b64_tr_b16 v[102:103], v19 offset:29184
ds_read_b128 v[64:67], v15 offset:0
v_mfma_f32_16x16x32_bf16 v[44:47], v[116:119], v[76:79], v[44:47]
ds_read_b128 v[68:71], v15 offset:2048
s_waitcnt lgkmcnt(7)
v_mfma_f32_16x16x32_bf16 v[48:51], v[112:115], v[80:83], v[48:51]
ds_read_b128 v[72:75], v15 offset:4096
v_mfma_f32_16x16x32_bf16 v[52:55], v[116:119], v[80:83], v[52:55]
s_waitcnt lgkmcnt(7)
v_mfma_f32_16x16x32_bf16 v[56:59], v[112:115], v[84:87], v[56:59]
ds_read_b128 v[76:79], v15 offset:6144
v_mfma_f32_16x16x32_bf16 v[60:63], v[116:119], v[84:87], v[60:63]
s_waitcnt lgkmcnt(3)
v_mfma_f32_16x16x32_bf16 v[32:35], v[96:99], v[64:67], v[32:35]
s_waitcnt lgkmcnt(0)
s_barrier
ds_read_b64_tr_b16 v[104:105], v18 offset:49152
ds_read_b64_tr_b16 v[106:107], v18 offset:49664
v_mfma_f32_16x16x32_bf16 v[36:39], v[100:103], v[64:67], v[36:39]
ds_read_b64_tr_b16 v[108:109], v19 offset:49152
s_waitcnt lgkmcnt(5)
v_mfma_f32_16x16x32_bf16 v[40:43], v[96:99], v[68:71], v[40:43]
ds_read_b64_tr_b16 v[110:111], v19 offset:49664
ds_read_b128 v[80:83], v12 offset:32768
v_mfma_f32_16x16x32_bf16 v[44:47], v[100:103], v[68:71], v[44:47]
ds_read_b128 v[84:87], v12 offset:34816
s_waitcnt lgkmcnt(7)
v_mfma_f32_16x16x32_bf16 v[48:51], v[96:99], v[72:75], v[48:51]
ds_read_b128 v[64:67], v12 offset:36864
v_mfma_f32_16x16x32_bf16 v[52:55], v[100:103], v[72:75], v[52:55]
s_waitcnt lgkmcnt(7)
v_mfma_f32_16x16x32_bf16 v[56:59], v[96:99], v[76:79], v[56:59]
ds_read_b128 v[68:71], v12 offset:38912
v_mfma_f32_16x16x32_bf16 v[60:63], v[100:103], v[76:79], v[60:63]
s_waitcnt lgkmcnt(3)
v_mfma_f32_16x16x32_bf16 v[32:35], v[104:107], v[80:83], v[32:35]
ds_read_b64_tr_b16 v[112:113], v18 offset:53248
ds_read_b64_tr_b16 v[114:115], v18 offset:53760
v_mfma_f32_16x16x32_bf16 v[36:39], v[108:111], v[80:83], v[36:39]
ds_read_b64_tr_b16 v[116:117], v19 offset:53248
s_waitcnt lgkmcnt(5)
v_mfma_f32_16x16x32_bf16 v[40:43], v[104:107], v[84:87], v[40:43]
ds_read_b64_tr_b16 v[118:119], v19 offset:53760
ds_read_b128 v[72:75], v13 offset:32768
v_mfma_f32_16x16x32_bf16 v[44:47], v[108:111], v[84:87], v[44:47]
ds_read_b128 v[76:79], v13 offset:34816
s_waitcnt lgkmcnt(7)
v_mfma_f32_16x16x32_bf16 v[48:51], v[104:107], v[64:67], v[48:51]
ds_read_b128 v[80:83], v13 offset:36864
v_mfma_f32_16x16x32_bf16 v[52:55], v[108:111], v[64:67], v[52:55]
s_waitcnt lgkmcnt(7)
v_mfma_f32_16x16x32_bf16 v[56:59], v[104:107], v[68:71], v[56:59]
ds_read_b128 v[84:87], v13 offset:38912
v_mfma_f32_16x16x32_bf16 v[60:63], v[108:111], v[68:71], v[60:63]
s_waitcnt lgkmcnt(3)
v_mfma_f32_16x16x32_bf16 v[32:35], v[112:115], v[72:75], v[32:35]
s_waitcnt lgkmcnt(0)
s_barrier
ds_read_b64_tr_b16 v[96:97], v16 offset:16384
ds_read_b64_tr_b16 v[98:99], v16 offset:16896
v_mfma_f32_16x16x32_bf16 v[36:39], v[116:119], v[72:75], v[36:39]
ds_read_b64_tr_b16 v[100:101], v17 offset:16384
s_waitcnt lgkmcnt(5)
v_mfma_f32_16x16x32_bf16 v[40:43], v[112:115], v[76:79], v[40:43]
ds_read_b64_tr_b16 v[102:103], v17 offset:16896
ds_read_b128 v[64:67], v8 offset:0
v_mfma_f32_16x16x32_bf16 v[44:47], v[116:119], v[76:79], v[44:47]
ds_read_b128 v[68:71], v8 offset:2048
s_waitcnt lgkmcnt(7)
v_mfma_f32_16x16x32_bf16 v[48:51], v[112:115], v[80:83], v[48:51]
ds_read_b128 v[72:75], v8 offset:4096
v_mfma_f32_16x16x32_bf16 v[52:55], v[116:119], v[80:83], v[52:55]
s_waitcnt lgkmcnt(7)
v_mfma_f32_16x16x32_bf16 v[56:59], v[112:115], v[84:87], v[56:59]
ds_read_b128 v[76:79], v8 offset:6144
v_mfma_f32_16x16x32_bf16 v[60:63], v[116:119], v[84:87], v[60:63]
s_waitcnt lgkmcnt(3)
v_mfma_f32_16x16x32_bf16 v[32:35], v[96:99], v[64:67], v[32:35]
ds_read_b64_tr_b16 v[104:105], v16 offset:20480
ds_read_b64_tr_b16 v[106:107], v16 offset:20992
v_mfma_f32_16x16x32_bf16 v[36:39], v[100:103], v[64:67], v[36:39]
ds_read_b64_tr_b16 v[108:109], v17 offset:20480
s_waitcnt lgkmcnt(5)
v_mfma_f32_16x16x32_bf16 v[40:43], v[96:99], v[68:71], v[40:43]
ds_read_b64_tr_b16 v[110:111], v17 offset:20992
ds_read_b128 v[80:83], v9 offset:0
v_mfma_f32_16x16x32_bf16 v[44:47], v[100:103], v[68:71], v[44:47]
ds_read_b128 v[84:87], v9 offset:2048
s_waitcnt lgkmcnt(7)
v_mfma_f32_16x16x32_bf16 v[48:51], v[96:99], v[72:75], v[48:51]
ds_read_b128 v[64:67], v9 offset:4096
v_mfma_f32_16x16x32_bf16 v[52:55], v[100:103], v[72:75], v[52:55]
s_waitcnt lgkmcnt(7)
v_mfma_f32_16x16x32_bf16 v[56:59], v[96:99], v[76:79], v[56:59]
ds_read_b128 v[68:71], v9 offset:6144
v_mfma_f32_16x16x32_bf16 v[60:63], v[100:103], v[76:79], v[60:63]
s_waitcnt lgkmcnt(3)
v_mfma_f32_16x16x32_bf16 v[32:35], v[104:107], v[80:83], v[32:35]
ds_read_b64_tr_b16 v[112:113], v16 offset:24576
ds_read_b64_tr_b16 v[114:115], v16 offset:25088
v_mfma_f32_16x16x32_bf16 v[36:39], v[108:111], v[80:83], v[36:39]
ds_read_b64_tr_b16 v[116:117], v17 offset:24576
s_waitcnt lgkmcnt(5)
v_mfma_f32_16x16x32_bf16 v[40:43], v[104:107], v[84:87], v[40:43]
ds_read_b64_tr_b16 v[118:119], v17 offset:25088
ds_read_b128 v[72:75], v10 offset:0
v_mfma_f32_16x16x32_bf16 v[44:47], v[108:111], v[84:87], v[44:47]
ds_read_b128 v[76:79], v10 offset:2048
s_waitcnt lgkmcnt(7)
v_mfma_f32_16x16x32_bf16 v[48:51], v[104:107], v[64:67], v[48:51]
ds_read_b128 v[80:83], v10 offset:4096
v_mfma_f32_16x16x32_bf16 v[52:55], v[108:111], v[64:67], v[52:55]
s_waitcnt lgkmcnt(7)
v_mfma_f32_16x16x32_bf16 v[56:59], v[104:107], v[68:71], v[56:59]
ds_read_b128 v[84:87], v10 offset:6144
v_mfma_f32_16x16x32_bf16 v[60:63], v[108:111], v[68:71], v[60:63]
s_waitcnt lgkmcnt(3)
v_mfma_f32_16x16x32_bf16 v[32:35], v[112:115], v[72:75], v[32:35]
ds_read_b64_tr_b16 v[96:97], v16 offset:28672
ds_read_b64_tr_b16 v[98:99], v16 offset:29184
v_mfma_f32_16x16x32_bf16 v[36:39], v[116:119], v[72:75], v[36:39]
ds_read_b64_tr_b16 v[100:101], v17 offset:28672
s_waitcnt lgkmcnt(5)
v_mfma_f32_16x16x32_bf16 v[40:43], v[112:115], v[76:79], v[40:43]
ds_read_b64_tr_b16 v[102:103], v17 offset:29184
ds_read_b128 v[64:67], v11 offset:0
v_mfma_f32_16x16x32_bf16 v[44:47], v[116:119], v[76:79], v[44:47]
ds_read_b128 v[68:71], v11 offset:2048
s_waitcnt lgkmcnt(7)
v_mfma_f32_16x16x32_bf16 v[48:51], v[112:115], v[80:83], v[48:51]
ds_read_b128 v[72:75], v11 offset:4096
v_mfma_f32_16x16x32_bf16 v[52:55], v[116:119], v[80:83], v[52:55]
s_waitcnt lgkmcnt(7)
v_mfma_f32_16x16x32_bf16 v[56:59], v[112:115], v[84:87], v[56:59]
ds_read_b128 v[76:79], v11 offset:6144
v_mfma_f32_16x16x32_bf16 v[60:63], v[116:119], v[84:87], v[60:63]
s_waitcnt lgkmcnt(3)
v_mfma_f32_16x16x32_bf16 v[32:35], v[96:99], v[64:67], v[32:35]
s_waitcnt lgkmcnt(0)
s_barrier
ds_read_b64_tr_b16 v[104:105], v16 offset:49152
ds_read_b64_tr_b16 v[106:107], v16 offset:49664
v_mfma_f32_16x16x32_bf16 v[36:39], v[100:103], v[64:67], v[36:39]
ds_read_b64_tr_b16 v[108:109], v17 offset:49152
s_waitcnt lgkmcnt(5)
v_mfma_f32_16x16x32_bf16 v[40:43], v[96:99], v[68:71], v[40:43]
ds_read_b64_tr_b16 v[110:111], v17 offset:49664
ds_read_b128 v[80:83], v8 offset:32768
v_mfma_f32_16x16x32_bf16 v[44:47], v[100:103], v[68:71], v[44:47]
ds_read_b128 v[84:87], v8 offset:34816
s_waitcnt lgkmcnt(7)
v_mfma_f32_16x16x32_bf16 v[48:51], v[96:99], v[72:75], v[48:51]
ds_read_b128 v[64:67], v8 offset:36864
v_mfma_f32_16x16x32_bf16 v[52:55], v[100:103], v[72:75], v[52:55]
s_waitcnt lgkmcnt(7)
v_mfma_f32_16x16x32_bf16 v[56:59], v[96:99], v[76:79], v[56:59]
ds_read_b128 v[68:71], v8 offset:38912
v_mfma_f32_16x16x32_bf16 v[60:63], v[100:103], v[76:79], v[60:63]
s_waitcnt lgkmcnt(3)
v_mfma_f32_16x16x32_bf16 v[32:35], v[104:107], v[80:83], v[32:35]
ds_read_b64_tr_b16 v[112:113], v16 offset:53248
ds_read_b64_tr_b16 v[114:115], v16 offset:53760
v_mfma_f32_16x16x32_bf16 v[36:39], v[108:111], v[80:83], v[36:39]
ds_read_b64_tr_b16 v[116:117], v17 offset:53248
s_waitcnt lgkmcnt(5)
v_mfma_f32_16x16x32_bf16 v[40:43], v[104:107], v[84:87], v[40:43]
ds_read_b64_tr_b16 v[118:119], v17 offset:53760
ds_read_b128 v[72:75], v9 offset:32768
v_mfma_f32_16x16x32_bf16 v[44:47], v[108:111], v[84:87], v[44:47]
ds_read_b128 v[76:79], v9 offset:34816
s_waitcnt lgkmcnt(7)
v_mfma_f32_16x16x32_bf16 v[48:51], v[104:107], v[64:67], v[48:51]
ds_read_b128 v[80:83], v9 offset:36864
v_mfma_f32_16x16x32_bf16 v[52:55], v[108:111], v[64:67], v[52:55]
s_waitcnt lgkmcnt(7)
v_mfma_f32_16x16x32_bf16 v[56:59], v[104:107], v[68:71], v[56:59]
ds_read_b128 v[84:87], v9 offset:38912
v_mfma_f32_16x16x32_bf16 v[60:63], v[108:111], v[68:71], v[60:63]
s_waitcnt lgkmcnt(3)
v_mfma_f32_16x16x32_bf16 v[32:35], v[112:115], v[72:75], v[32:35]
s_waitcnt lgkmcnt(0)
s_barrier
ds_read_b64_tr_b16 v[96:97], v18 offset:16384
ds_read_b64_tr_b16 v[98:99], v18 offset:16896
v_mfma_f32_16x16x32_bf16 v[36:39], v[116:119], v[72:75], v[36:39]
ds_read_b64_tr_b16 v[100:101], v19 offset:16384
s_waitcnt lgkmcnt(5)
v_mfma_f32_16x16x32_bf16 v[40:43], v[112:115], v[76:79], v[40:43]
ds_read_b64_tr_b16 v[102:103], v19 offset:16896
ds_read_b128 v[64:67], v12 offset:0
v_mfma_f32_16x16x32_bf16 v[44:47], v[116:119], v[76:79], v[44:47]
ds_read_b128 v[68:71], v12 offset:2048
s_waitcnt lgkmcnt(7)
v_mfma_f32_16x16x32_bf16 v[48:51], v[112:115], v[80:83], v[48:51]
ds_read_b128 v[72:75], v12 offset:4096
v_mfma_f32_16x16x32_bf16 v[52:55], v[116:119], v[80:83], v[52:55]
s_waitcnt lgkmcnt(7)
v_mfma_f32_16x16x32_bf16 v[56:59], v[112:115], v[84:87], v[56:59]
ds_read_b128 v[76:79], v12 offset:6144
v_mfma_f32_16x16x32_bf16 v[60:63], v[116:119], v[84:87], v[60:63]
s_waitcnt lgkmcnt(3)
v_mfma_f32_16x16x32_bf16 v[32:35], v[96:99], v[64:67], v[32:35]
ds_read_b64_tr_b16 v[104:105], v18 offset:20480
ds_read_b64_tr_b16 v[106:107], v18 offset:20992
v_mfma_f32_16x16x32_bf16 v[36:39], v[100:103], v[64:67], v[36:39]
ds_read_b64_tr_b16 v[108:109], v19 offset:20480
s_waitcnt lgkmcnt(5)
v_mfma_f32_16x16x32_bf16 v[40:43], v[96:99], v[68:71], v[40:43]
ds_read_b64_tr_b16 v[110:111], v19 offset:20992
ds_read_b128 v[80:83], v13 offset:0
v_mfma_f32_16x16x32_bf16 v[44:47], v[100:103], v[68:71], v[44:47]
ds_read_b128 v[84:87], v13 offset:2048
s_waitcnt lgkmcnt(7)
v_mfma_f32_16x16x32_bf16 v[48:51], v[96:99], v[72:75], v[48:51]
ds_read_b128 v[64:67], v13 offset:4096
v_mfma_f32_16x16x32_bf16 v[52:55], v[100:103], v[72:75], v[52:55]
s_waitcnt lgkmcnt(7)
v_mfma_f32_16x16x32_bf16 v[56:59], v[96:99], v[76:79], v[56:59]
ds_read_b128 v[68:71], v13 offset:6144
v_mfma_f32_16x16x32_bf16 v[60:63], v[100:103], v[76:79], v[60:63]
s_waitcnt lgkmcnt(3)
v_mfma_f32_16x16x32_bf16 v[32:35], v[104:107], v[80:83], v[32:35]
ds_read_b64_tr_b16 v[112:113], v18 offset:24576
ds_read_b64_tr_b16 v[114:115], v18 offset:25088
v_mfma_f32_16x16x32_bf16 v[36:39], v[108:111], v[80:83], v[36:39]
ds_read_b64_tr_b16 v[116:117], v19 offset:24576
s_waitcnt lgkmcnt(5)
v_mfma_f32_16x16x32_bf16 v[40:43], v[104:107], v[84:87], v[40:43]
ds_read_b64_tr_b16 v[118:119], v19 offset:25088
ds_read_b128 v[72:75], v14 offset:0
v_mfma_f32_16x16x32_bf16 v[44:47], v[108:111], v[84:87], v[44:47]
ds_read_b128 v[76:79], v14 offset:2048
s_waitcnt lgkmcnt(7)
v_mfma_f32_16x16x32_bf16 v[48:51], v[104:107], v[64:67], v[48:51]
ds_read_b128 v[80:83], v14 offset:4096
v_mfma_f32_16x16x32_bf16 v[52:55], v[108:111], v[64:67], v[52:55]
s_waitcnt lgkmcnt(7)
v_mfma_f32_16x16x32_bf16 v[56:59], v[104:107], v[68:71], v[56:59]
ds_read_b128 v[84:87], v14 offset:6144
v_mfma_f32_16x16x32_bf16 v[60:63], v[108:111], v[68:71], v[60:63]
s_waitcnt lgkmcnt(3)
v_mfma_f32_16x16x32_bf16 v[32:35], v[112:115], v[72:75], v[32:35]
ds_read_b64_tr_b16 v[96:97], v18 offset:28672
ds_read_b64_tr_b16 v[98:99], v18 offset:29184
v_mfma_f32_16x16x32_bf16 v[36:39], v[116:119], v[72:75], v[36:39]
ds_read_b64_tr_b16 v[100:101], v19 offset:28672
s_waitcnt lgkmcnt(5)
v_mfma_f32_16x16x32_bf16 v[40:43], v[112:115], v[76:79], v[40:43]
ds_read_b64_tr_b16 v[102:103], v19 offset:29184
ds_read_b128 v[64:67], v15 offset:0
v_mfma_f32_16x16x32_bf16 v[44:47], v[116:119], v[76:79], v[44:47]
ds_read_b128 v[68:71], v15 offset:2048
s_waitcnt lgkmcnt(7)
v_mfma_f32_16x16x32_bf16 v[48:51], v[112:115], v[80:83], v[48:51]
ds_read_b128 v[72:75], v15 offset:4096
v_mfma_f32_16x16x32_bf16 v[52:55], v[116:119], v[80:83], v[52:55]
s_waitcnt lgkmcnt(7)
v_mfma_f32_16x16x32_bf16 v[56:59], v[112:115], v[84:87], v[56:59]
ds_read_b128 v[76:79], v15 offset:6144
v_mfma_f32_16x16x32_bf16 v[60:63], v[116:119], v[84:87], v[60:63]
s_waitcnt lgkmcnt(3)
v_mfma_f32_16x16x32_bf16 v[32:35], v[96:99], v[64:67], v[32:35]
s_waitcnt lgkmcnt(0)
s_barrier
ds_read_b64_tr_b16 v[104:105], v18 offset:49152
ds_read_b64_tr_b16 v[106:107], v18 offset:49664
v_mfma_f32_16x16x32_bf16 v[36:39], v[100:103], v[64:67], v[36:39]
ds_read_b64_tr_b16 v[108:109], v19 offset:49152
s_waitcnt lgkmcnt(5)
v_mfma_f32_16x16x32_bf16 v[40:43], v[96:99], v[68:71], v[40:43]
ds_read_b64_tr_b16 v[110:111], v19 offset:49664
ds_read_b128 v[80:83], v12 offset:32768
v_mfma_f32_16x16x32_bf16 v[44:47], v[100:103], v[68:71], v[44:47]
ds_read_b128 v[84:87], v12 offset:34816
s_waitcnt lgkmcnt(7)
v_mfma_f32_16x16x32_bf16 v[48:51], v[96:99], v[72:75], v[48:51]
ds_read_b128 v[64:67], v12 offset:36864
v_mfma_f32_16x16x32_bf16 v[52:55], v[100:103], v[72:75], v[52:55]
s_waitcnt lgkmcnt(7)
v_mfma_f32_16x16x32_bf16 v[56:59], v[96:99], v[76:79], v[56:59]
ds_read_b128 v[68:71], v12 offset:38912
v_mfma_f32_16x16x32_bf16 v[60:63], v[100:103], v[76:79], v[60:63]
s_waitcnt lgkmcnt(3)
v_mfma_f32_16x16x32_bf16 v[32:35], v[104:107], v[80:83], v[32:35]
ds_read_b64_tr_b16 v[112:113], v18 offset:53248
ds_read_b64_tr_b16 v[114:115], v18 offset:53760
v_mfma_f32_16x16x32_bf16 v[36:39], v[108:111], v[80:83], v[36:39]
ds_read_b64_tr_b16 v[116:117], v19 offset:53248
s_waitcnt lgkmcnt(5)
v_mfma_f32_16x16x32_bf16 v[40:43], v[104:107], v[84:87], v[40:43]
ds_read_b64_tr_b16 v[118:119], v19 offset:53760
ds_read_b128 v[72:75], v13 offset:32768
v_mfma_f32_16x16x32_bf16 v[44:47], v[108:111], v[84:87], v[44:47]
ds_read_b128 v[76:79], v13 offset:34816
s_waitcnt lgkmcnt(7)
v_mfma_f32_16x16x32_bf16 v[48:51], v[104:107], v[64:67], v[48:51]
ds_read_b128 v[80:83], v13 offset:36864
v_mfma_f32_16x16x32_bf16 v[52:55], v[108:111], v[64:67], v[52:55]
s_waitcnt lgkmcnt(7)
v_mfma_f32_16x16x32_bf16 v[56:59], v[104:107], v[68:71], v[56:59]
ds_read_b128 v[84:87], v13 offset:38912
v_mfma_f32_16x16x32_bf16 v[60:63], v[108:111], v[68:71], v[60:63]
s_waitcnt lgkmcnt(3)
v_mfma_f32_16x16x32_bf16 v[32:35], v[112:115], v[72:75], v[32:35]
s_waitcnt lgkmcnt(0)
s_barrier
ds_read_b64_tr_b16 v[96:97], v16 offset:16384
ds_read_b64_tr_b16 v[98:99], v16 offset:16896
v_mfma_f32_16x16x32_bf16 v[36:39], v[116:119], v[72:75], v[36:39]
ds_read_b64_tr_b16 v[100:101], v17 offset:16384
s_waitcnt lgkmcnt(5)
v_mfma_f32_16x16x32_bf16 v[40:43], v[112:115], v[76:79], v[40:43]
ds_read_b64_tr_b16 v[102:103], v17 offset:16896
ds_read_b128 v[64:67], v8 offset:0
v_mfma_f32_16x16x32_bf16 v[44:47], v[116:119], v[76:79], v[44:47]
ds_read_b128 v[68:71], v8 offset:2048
s_waitcnt lgkmcnt(7)
v_mfma_f32_16x16x32_bf16 v[48:51], v[112:115], v[80:83], v[48:51]
ds_read_b128 v[72:75], v8 offset:4096
v_mfma_f32_16x16x32_bf16 v[52:55], v[116:119], v[80:83], v[52:55]
s_waitcnt lgkmcnt(7)
v_mfma_f32_16x16x32_bf16 v[56:59], v[112:115], v[84:87], v[56:59]
ds_read_b128 v[76:79], v8 offset:6144
v_mfma_f32_16x16x32_bf16 v[60:63], v[116:119], v[84:87], v[60:63]
s_waitcnt lgkmcnt(3)
v_mfma_f32_16x16x32_bf16 v[32:35], v[96:99], v[64:67], v[32:35]
ds_read_b64_tr_b16 v[104:105], v16 offset:20480
ds_read_b64_tr_b16 v[106:107], v16 offset:20992
v_mfma_f32_16x16x32_bf16 v[36:39], v[100:103], v[64:67], v[36:39]
ds_read_b64_tr_b16 v[108:109], v17 offset:20480
s_waitcnt lgkmcnt(5)
v_mfma_f32_16x16x32_bf16 v[40:43], v[96:99], v[68:71], v[40:43]
ds_read_b64_tr_b16 v[110:111], v17 offset:20992
ds_read_b128 v[80:83], v9 offset:0
v_mfma_f32_16x16x32_bf16 v[44:47], v[100:103], v[68:71], v[44:47]
ds_read_b128 v[84:87], v9 offset:2048
s_waitcnt lgkmcnt(7)
v_mfma_f32_16x16x32_bf16 v[48:51], v[96:99], v[72:75], v[48:51]
ds_read_b128 v[64:67], v9 offset:4096
v_mfma_f32_16x16x32_bf16 v[52:55], v[100:103], v[72:75], v[52:55]
s_waitcnt lgkmcnt(7)
v_mfma_f32_16x16x32_bf16 v[56:59], v[96:99], v[76:79], v[56:59]
ds_read_b128 v[68:71], v9 offset:6144
v_mfma_f32_16x16x32_bf16 v[60:63], v[100:103], v[76:79], v[60:63]
s_waitcnt lgkmcnt(3)
v_mfma_f32_16x16x32_bf16 v[32:35], v[104:107], v[80:83], v[32:35]
ds_read_b64_tr_b16 v[112:113], v16 offset:24576
ds_read_b64_tr_b16 v[114:115], v16 offset:25088
v_mfma_f32_16x16x32_bf16 v[36:39], v[108:111], v[80:83], v[36:39]
ds_read_b64_tr_b16 v[116:117], v17 offset:24576
s_waitcnt lgkmcnt(5)
v_mfma_f32_16x16x32_bf16 v[40:43], v[104:107], v[84:87], v[40:43]
ds_read_b64_tr_b16 v[118:119], v17 offset:25088
ds_read_b128 v[72:75], v10 offset:0
v_mfma_f32_16x16x32_bf16 v[44:47], v[108:111], v[84:87], v[44:47]
ds_read_b128 v[76:79], v10 offset:2048
s_waitcnt lgkmcnt(7)
v_mfma_f32_16x16x32_bf16 v[48:51], v[104:107], v[64:67], v[48:51]
ds_read_b128 v[80:83], v10 offset:4096
v_mfma_f32_16x16x32_bf16 v[52:55], v[108:111], v[64:67], v[52:55]
s_waitcnt lgkmcnt(7)
v_mfma_f32_16x16x32_bf16 v[56:59], v[104:107], v[68:71], v[56:59]
ds_read_b128 v[84:87], v10 offset:6144
v_mfma_f32_16x16x32_bf16 v[60:63], v[108:111], v[68:71], v[60:63]
s_waitcnt lgkmcnt(3)
v_mfma_f32_16x16x32_bf16 v[32:35], v[112:115], v[72:75], v[32:35]
ds_read_b64_tr_b16 v[96:97], v16 offset:28672
ds_read_b64_tr_b16 v[98:99], v16 offset:29184
v_mfma_f32_16x16x32_bf16 v[36:39], v[116:119], v[72:75], v[36:39]
ds_read_b64_tr_b16 v[100:101], v17 offset:28672
s_waitcnt lgkmcnt(5)
v_mfma_f32_16x16x32_bf16 v[40:43], v[112:115], v[76:79], v[40:43]
ds_read_b64_tr_b16 v[102:103], v17 offset:29184
ds_read_b128 v[64:67], v11 offset:0
v_mfma_f32_16x16x32_bf16 v[44:47], v[116:119], v[76:79], v[44:47]
ds_read_b128 v[68:71], v11 offset:2048
s_waitcnt lgkmcnt(7)
v_mfma_f32_16x16x32_bf16 v[48:51], v[112:115], v[80:83], v[48:51]
ds_read_b128 v[72:75], v11 offset:4096
v_mfma_f32_16x16x32_bf16 v[52:55], v[116:119], v[80:83], v[52:55]
s_waitcnt lgkmcnt(7)
v_mfma_f32_16x16x32_bf16 v[56:59], v[112:115], v[84:87], v[56:59]
ds_read_b128 v[76:79], v11 offset:6144
v_mfma_f32_16x16x32_bf16 v[60:63], v[116:119], v[84:87], v[60:63]
s_waitcnt lgkmcnt(3)
v_mfma_f32_16x16x32_bf16 v[32:35], v[96:99], v[64:67], v[32:35]
s_waitcnt lgkmcnt(0)
s_barrier
ds_read_b64_tr_b16 v[104:105], v16 offset:49152
ds_read_b64_tr_b16 v[106:107], v16 offset:49664
v_mfma_f32_16x16x32_bf16 v[36:39], v[100:103], v[64:67], v[36:39]
ds_read_b64_tr_b16 v[108:109], v17 offset:49152
s_waitcnt lgkmcnt(5)
v_mfma_f32_16x16x32_bf16 v[40:43], v[96:99], v[68:71], v[40:43]
ds_read_b64_tr_b16 v[110:111], v17 offset:49664
ds_read_b128 v[80:83], v8 offset:32768
v_mfma_f32_16x16x32_bf16 v[44:47], v[100:103], v[68:71], v[44:47]
ds_read_b128 v[84:87], v8 offset:34816
s_waitcnt lgkmcnt(7)
v_mfma_f32_16x16x32_bf16 v[48:51], v[96:99], v[72:75], v[48:51]
ds_read_b128 v[64:67], v8 offset:36864
v_mfma_f32_16x16x32_bf16 v[52:55], v[100:103], v[72:75], v[52:55]
s_waitcnt lgkmcnt(7)
v_mfma_f32_16x16x32_bf16 v[56:59], v[96:99], v[76:79], v[56:59]
ds_read_b128 v[68:71], v8 offset:38912
v_mfma_f32_16x16x32_bf16 v[60:63], v[100:103], v[76:79], v[60:63]
s_waitcnt lgkmcnt(3)
v_mfma_f32_16x16x32_bf16 v[32:35], v[104:107], v[80:83], v[32:35]
ds_read_b64_tr_b16 v[112:113], v16 offset:53248
ds_read_b64_tr_b16 v[114:115], v16 offset:53760
v_mfma_f32_16x16x32_bf16 v[36:39], v[108:111], v[80:83], v[36:39]
ds_read_b64_tr_b16 v[116:117], v17 offset:53248
s_waitcnt lgkmcnt(5)
v_mfma_f32_16x16x32_bf16 v[40:43], v[104:107], v[84:87], v[40:43]
ds_read_b64_tr_b16 v[118:119], v17 offset:53760
ds_read_b128 v[72:75], v9 offset:32768
v_mfma_f32_16x16x32_bf16 v[44:47], v[108:111], v[84:87], v[44:47]
ds_read_b128 v[76:79], v9 offset:34816
s_waitcnt lgkmcnt(7)
v_mfma_f32_16x16x32_bf16 v[48:51], v[104:107], v[64:67], v[48:51]
ds_read_b128 v[80:83], v9 offset:36864
v_mfma_f32_16x16x32_bf16 v[52:55], v[108:111], v[64:67], v[52:55]
s_waitcnt lgkmcnt(7)
v_mfma_f32_16x16x32_bf16 v[56:59], v[104:107], v[68:71], v[56:59]
ds_read_b128 v[84:87], v9 offset:38912
v_mfma_f32_16x16x32_bf16 v[60:63], v[108:111], v[68:71], v[60:63]
s_waitcnt lgkmcnt(3)
v_mfma_f32_16x16x32_bf16 v[32:35], v[112:115], v[72:75], v[32:35]
s_waitcnt lgkmcnt(0)
s_barrier
ds_read_b64_tr_b16 v[96:97], v18 offset:16384
ds_read_b64_tr_b16 v[98:99], v18 offset:16896
v_mfma_f32_16x16x32_bf16 v[36:39], v[116:119], v[72:75], v[36:39]
ds_read_b64_tr_b16 v[100:101], v19 offset:16384
s_waitcnt lgkmcnt(5)
v_mfma_f32_16x16x32_bf16 v[40:43], v[112:115], v[76:79], v[40:43]
ds_read_b64_tr_b16 v[102:103], v19 offset:16896
ds_read_b128 v[64:67], v12 offset:0
v_mfma_f32_16x16x32_bf16 v[44:47], v[116:119], v[76:79], v[44:47]
ds_read_b128 v[68:71], v12 offset:2048
s_waitcnt lgkmcnt(7)
v_mfma_f32_16x16x32_bf16 v[48:51], v[112:115], v[80:83], v[48:51]
ds_read_b128 v[72:75], v12 offset:4096
v_mfma_f32_16x16x32_bf16 v[52:55], v[116:119], v[80:83], v[52:55]
s_waitcnt lgkmcnt(7)
v_mfma_f32_16x16x32_bf16 v[56:59], v[112:115], v[84:87], v[56:59]
ds_read_b128 v[76:79], v12 offset:6144
v_mfma_f32_16x16x32_bf16 v[60:63], v[116:119], v[84:87], v[60:63]
s_waitcnt lgkmcnt(3)
v_mfma_f32_16x16x32_bf16 v[32:35], v[96:99], v[64:67], v[32:35]
ds_read_b64_tr_b16 v[104:105], v18 offset:20480
ds_read_b64_tr_b16 v[106:107], v18 offset:20992
v_mfma_f32_16x16x32_bf16 v[36:39], v[100:103], v[64:67], v[36:39]
ds_read_b64_tr_b16 v[108:109], v19 offset:20480
s_waitcnt lgkmcnt(5)
v_mfma_f32_16x16x32_bf16 v[40:43], v[96:99], v[68:71], v[40:43]
ds_read_b64_tr_b16 v[110:111], v19 offset:20992
ds_read_b128 v[80:83], v13 offset:0
v_mfma_f32_16x16x32_bf16 v[44:47], v[100:103], v[68:71], v[44:47]
ds_read_b128 v[84:87], v13 offset:2048
s_waitcnt lgkmcnt(7)
v_mfma_f32_16x16x32_bf16 v[48:51], v[96:99], v[72:75], v[48:51]
ds_read_b128 v[64:67], v13 offset:4096
v_mfma_f32_16x16x32_bf16 v[52:55], v[100:103], v[72:75], v[52:55]
s_waitcnt lgkmcnt(7)
v_mfma_f32_16x16x32_bf16 v[56:59], v[96:99], v[76:79], v[56:59]
ds_read_b128 v[68:71], v13 offset:6144
v_mfma_f32_16x16x32_bf16 v[60:63], v[100:103], v[76:79], v[60:63]
s_waitcnt lgkmcnt(3)
v_mfma_f32_16x16x32_bf16 v[32:35], v[104:107], v[80:83], v[32:35]
ds_read_b64_tr_b16 v[112:113], v18 offset:24576
ds_read_b64_tr_b16 v[114:115], v18 offset:25088
v_mfma_f32_16x16x32_bf16 v[36:39], v[108:111], v[80:83], v[36:39]
ds_read_b64_tr_b16 v[116:117], v19 offset:24576
s_waitcnt lgkmcnt(5)
v_mfma_f32_16x16x32_bf16 v[40:43], v[104:107], v[84:87], v[40:43]
ds_read_b64_tr_b16 v[118:119], v19 offset:25088
ds_read_b128 v[72:75], v14 offset:0
v_mfma_f32_16x16x32_bf16 v[44:47], v[108:111], v[84:87], v[44:47]
ds_read_b128 v[76:79], v14 offset:2048
s_waitcnt lgkmcnt(7)
v_mfma_f32_16x16x32_bf16 v[48:51], v[104:107], v[64:67], v[48:51]
ds_read_b128 v[80:83], v14 offset:4096
v_mfma_f32_16x16x32_bf16 v[52:55], v[108:111], v[64:67], v[52:55]
s_waitcnt lgkmcnt(7)
v_mfma_f32_16x16x32_bf16 v[56:59], v[104:107], v[68:71], v[56:59]
ds_read_b128 v[84:87], v14 offset:6144
v_mfma_f32_16x16x32_bf16 v[60:63], v[108:111], v[68:71], v[60:63]
s_waitcnt lgkmcnt(3)
v_mfma_f32_16x16x32_bf16 v[32:35], v[112:115], v[72:75], v[32:35]
ds_read_b64_tr_b16 v[96:97], v18 offset:28672
ds_read_b64_tr_b16 v[98:99], v18 offset:29184
v_mfma_f32_16x16x32_bf16 v[36:39], v[116:119], v[72:75], v[36:39]
ds_read_b64_tr_b16 v[100:101], v19 offset:28672
s_waitcnt lgkmcnt(5)
v_mfma_f32_16x16x32_bf16 v[40:43], v[112:115], v[76:79], v[40:43]
ds_read_b64_tr_b16 v[102:103], v19 offset:29184
ds_read_b128 v[64:67], v15 offset:0
v_mfma_f32_16x16x32_bf16 v[44:47], v[116:119], v[76:79], v[44:47]
ds_read_b128 v[68:71], v15 offset:2048
s_waitcnt lgkmcnt(7)
v_mfma_f32_16x16x32_bf16 v[48:51], v[112:115], v[80:83], v[48:51]
ds_read_b128 v[72:75], v15 offset:4096
v_mfma_f32_16x16x32_bf16 v[52:55], v[116:119], v[80:83], v[52:55]
s_waitcnt lgkmcnt(7)
v_mfma_f32_16x16x32_bf16 v[56:59], v[112:115], v[84:87], v[56:59]
ds_read_b128 v[76:79], v15 offset:6144
v_mfma_f32_16x16x32_bf16 v[60:63], v[116:119], v[84:87], v[60:63]
s_waitcnt lgkmcnt(3)
v_mfma_f32_16x16x32_bf16 v[32:35], v[96:99], v[64:67], v[32:35]
s_waitcnt lgkmcnt(0)
s_barrier
buffer_load_dword v28, v7, s[44:47], 0 offen sc1
ds_read_b64_tr_b16 v[104:105], v18 offset:49152
ds_read_b64_tr_b16 v[106:107], v18 offset:49664
v_mfma_f32_16x16x32_bf16 v[36:39], v[100:103], v[64:67], v[36:39]
ds_read_b64_tr_b16 v[108:109], v19 offset:49152
s_waitcnt lgkmcnt(5)
v_mfma_f32_16x16x32_bf16 v[40:43], v[96:99], v[68:71], v[40:43]
ds_read_b64_tr_b16 v[110:111], v19 offset:49664
ds_read_b128 v[80:83], v12 offset:32768
v_mfma_f32_16x16x32_bf16 v[44:47], v[100:103], v[68:71], v[44:47]
ds_read_b128 v[84:87], v12 offset:34816
s_waitcnt lgkmcnt(7)
v_mfma_f32_16x16x32_bf16 v[48:51], v[96:99], v[72:75], v[48:51]
ds_read_b128 v[64:67], v12 offset:36864
v_mfma_f32_16x16x32_bf16 v[52:55], v[100:103], v[72:75], v[52:55]
s_waitcnt lgkmcnt(7)
v_mfma_f32_16x16x32_bf16 v[56:59], v[96:99], v[76:79], v[56:59]
ds_read_b128 v[68:71], v12 offset:38912
v_mfma_f32_16x16x32_bf16 v[60:63], v[100:103], v[76:79], v[60:63]
s_waitcnt lgkmcnt(3)
v_mfma_f32_16x16x32_bf16 v[32:35], v[104:107], v[80:83], v[32:35]
ds_read_b64_tr_b16 v[112:113], v18 offset:53248
ds_read_b64_tr_b16 v[114:115], v18 offset:53760
v_mfma_f32_16x16x32_bf16 v[36:39], v[108:111], v[80:83], v[36:39]
ds_read_b64_tr_b16 v[116:117], v19 offset:53248
s_waitcnt lgkmcnt(5)
v_mfma_f32_16x16x32_bf16 v[40:43], v[104:107], v[84:87], v[40:43]
ds_read_b64_tr_b16 v[118:119], v19 offset:53760
ds_read_b128 v[72:75], v13 offset:32768
v_mfma_f32_16x16x32_bf16 v[44:47], v[108:111], v[84:87], v[44:47]
ds_read_b128 v[76:79], v13 offset:34816
s_waitcnt lgkmcnt(7)
v_mfma_f32_16x16x32_bf16 v[48:51], v[104:107], v[64:67], v[48:51]
ds_read_b128 v[80:83], v13 offset:36864
v_mfma_f32_16x16x32_bf16 v[52:55], v[108:111], v[64:67], v[52:55]
s_waitcnt lgkmcnt(7)
v_mfma_f32_16x16x32_bf16 v[56:59], v[104:107], v[68:71], v[56:59]
ds_read_b128 v[84:87], v13 offset:38912
v_mfma_f32_16x16x32_bf16 v[60:63], v[108:111], v[68:71], v[60:63]
s_waitcnt lgkmcnt(3)
v_mfma_f32_16x16x32_bf16 v[32:35], v[112:115], v[72:75], v[32:35]
s_waitcnt lgkmcnt(0)
s_barrier
ds_read_b64_tr_b16 v[96:97], v16 offset:16384
ds_read_b64_tr_b16 v[98:99], v16 offset:16896
v_mfma_f32_16x16x32_bf16 v[36:39], v[116:119], v[72:75], v[36:39]
ds_read_b64_tr_b16 v[100:101], v17 offset:16384
s_waitcnt lgkmcnt(5)
v_mfma_f32_16x16x32_bf16 v[40:43], v[112:115], v[76:79], v[40:43]
ds_read_b64_tr_b16 v[102:103], v17 offset:16896
ds_read_b128 v[64:67], v8 offset:0
v_mfma_f32_16x16x32_bf16 v[44:47], v[116:119], v[76:79], v[44:47]
ds_read_b128 v[68:71], v8 offset:2048
s_waitcnt lgkmcnt(7)
v_mfma_f32_16x16x32_bf16 v[48:51], v[112:115], v[80:83], v[48:51]
ds_read_b128 v[72:75], v8 offset:4096
v_mfma_f32_16x16x32_bf16 v[52:55], v[116:119], v[80:83], v[52:55]
s_waitcnt lgkmcnt(7)
v_mfma_f32_16x16x32_bf16 v[56:59], v[112:115], v[84:87], v[56:59]
ds_read_b128 v[76:79], v8 offset:6144
v_mfma_f32_16x16x32_bf16 v[60:63], v[116:119], v[84:87], v[60:63]
s_waitcnt lgkmcnt(3)
v_mfma_f32_16x16x32_bf16 v[32:35], v[96:99], v[64:67], v[32:35]
ds_read_b64_tr_b16 v[104:105], v16 offset:20480
ds_read_b64_tr_b16 v[106:107], v16 offset:20992
v_mfma_f32_16x16x32_bf16 v[36:39], v[100:103], v[64:67], v[36:39]
ds_read_b64_tr_b16 v[108:109], v17 offset:20480
s_waitcnt lgkmcnt(5)
v_mfma_f32_16x16x32_bf16 v[40:43], v[96:99], v[68:71], v[40:43]
ds_read_b64_tr_b16 v[110:111], v17 offset:20992
ds_read_b128 v[80:83], v9 offset:0
v_mfma_f32_16x16x32_bf16 v[44:47], v[100:103], v[68:71], v[44:47]
ds_read_b128 v[84:87], v9 offset:2048
s_waitcnt lgkmcnt(7)
v_mfma_f32_16x16x32_bf16 v[48:51], v[96:99], v[72:75], v[48:51]
ds_read_b128 v[64:67], v9 offset:4096
v_mfma_f32_16x16x32_bf16 v[52:55], v[100:103], v[72:75], v[52:55]
s_waitcnt lgkmcnt(7)
v_mfma_f32_16x16x32_bf16 v[56:59], v[96:99], v[76:79], v[56:59]
ds_read_b128 v[68:71], v9 offset:6144
v_mfma_f32_16x16x32_bf16 v[60:63], v[100:103], v[76:79], v[60:63]
s_waitcnt lgkmcnt(3)
v_mfma_f32_16x16x32_bf16 v[32:35], v[104:107], v[80:83], v[32:35]
ds_read_b64_tr_b16 v[112:113], v16 offset:24576
ds_read_b64_tr_b16 v[114:115], v16 offset:25088
v_mfma_f32_16x16x32_bf16 v[36:39], v[108:111], v[80:83], v[36:39]
ds_read_b64_tr_b16 v[116:117], v17 offset:24576
s_waitcnt lgkmcnt(5)
v_mfma_f32_16x16x32_bf16 v[40:43], v[104:107], v[84:87], v[40:43]
ds_read_b64_tr_b16 v[118:119], v17 offset:25088
ds_read_b128 v[72:75], v10 offset:0
v_mfma_f32_16x16x32_bf16 v[44:47], v[108:111], v[84:87], v[44:47]
ds_read_b128 v[76:79], v10 offset:2048
s_waitcnt lgkmcnt(7)
v_mfma_f32_16x16x32_bf16 v[48:51], v[104:107], v[64:67], v[48:51]
ds_read_b128 v[80:83], v10 offset:4096
v_mfma_f32_16x16x32_bf16 v[52:55], v[108:111], v[64:67], v[52:55]
s_waitcnt lgkmcnt(7)
v_mfma_f32_16x16x32_bf16 v[56:59], v[104:107], v[68:71], v[56:59]
ds_read_b128 v[84:87], v10 offset:6144
v_mfma_f32_16x16x32_bf16 v[60:63], v[108:111], v[68:71], v[60:63]
s_waitcnt lgkmcnt(3)
v_mfma_f32_16x16x32_bf16 v[32:35], v[112:115], v[72:75], v[32:35]
ds_read_b64_tr_b16 v[96:97], v16 offset:28672
ds_read_b64_tr_b16 v[98:99], v16 offset:29184
v_mfma_f32_16x16x32_bf16 v[36:39], v[116:119], v[72:75], v[36:39]
ds_read_b64_tr_b16 v[100:101], v17 offset:28672
s_waitcnt lgkmcnt(5)
v_mfma_f32_16x16x32_bf16 v[40:43], v[112:115], v[76:79], v[40:43]
ds_read_b64_tr_b16 v[102:103], v17 offset:29184
ds_read_b128 v[64:67], v11 offset:0
v_mfma_f32_16x16x32_bf16 v[44:47], v[116:119], v[76:79], v[44:47]
ds_read_b128 v[68:71], v11 offset:2048
s_waitcnt lgkmcnt(7)
v_mfma_f32_16x16x32_bf16 v[48:51], v[112:115], v[80:83], v[48:51]
ds_read_b128 v[72:75], v11 offset:4096
v_mfma_f32_16x16x32_bf16 v[52:55], v[116:119], v[80:83], v[52:55]
s_waitcnt lgkmcnt(7)
v_mfma_f32_16x16x32_bf16 v[56:59], v[112:115], v[84:87], v[56:59]
ds_read_b128 v[76:79], v11 offset:6144
v_mfma_f32_16x16x32_bf16 v[60:63], v[116:119], v[84:87], v[60:63]
s_waitcnt lgkmcnt(3)
v_mfma_f32_16x16x32_bf16 v[32:35], v[96:99], v[64:67], v[32:35]
s_waitcnt lgkmcnt(0)
s_barrier
ds_read_b64_tr_b16 v[104:105], v16 offset:49152
ds_read_b64_tr_b16 v[106:107], v16 offset:49664
v_mfma_f32_16x16x32_bf16 v[36:39], v[100:103], v[64:67], v[36:39]
ds_read_b64_tr_b16 v[108:109], v17 offset:49152
s_waitcnt lgkmcnt(5)
v_mfma_f32_16x16x32_bf16 v[40:43], v[96:99], v[68:71], v[40:43]
ds_read_b64_tr_b16 v[110:111], v17 offset:49664
ds_read_b128 v[80:83], v8 offset:32768
v_mfma_f32_16x16x32_bf16 v[44:47], v[100:103], v[68:71], v[44:47]
ds_read_b128 v[84:87], v8 offset:34816
s_waitcnt lgkmcnt(7)
v_mfma_f32_16x16x32_bf16 v[48:51], v[96:99], v[72:75], v[48:51]
ds_read_b128 v[64:67], v8 offset:36864
v_mfma_f32_16x16x32_bf16 v[52:55], v[100:103], v[72:75], v[52:55]
s_waitcnt lgkmcnt(7)
v_mfma_f32_16x16x32_bf16 v[56:59], v[96:99], v[76:79], v[56:59]
ds_read_b128 v[68:71], v8 offset:38912
v_mfma_f32_16x16x32_bf16 v[60:63], v[100:103], v[76:79], v[60:63]
s_waitcnt lgkmcnt(3)
v_mfma_f32_16x16x32_bf16 v[32:35], v[104:107], v[80:83], v[32:35]
ds_read_b64_tr_b16 v[112:113], v16 offset:53248
ds_read_b64_tr_b16 v[114:115], v16 offset:53760
v_mfma_f32_16x16x32_bf16 v[36:39], v[108:111], v[80:83], v[36:39]
ds_read_b64_tr_b16 v[116:117], v17 offset:53248
s_waitcnt lgkmcnt(5)
v_mfma_f32_16x16x32_bf16 v[40:43], v[104:107], v[84:87], v[40:43]
ds_read_b64_tr_b16 v[118:119], v17 offset:53760
ds_read_b128 v[72:75], v9 offset:32768
v_mfma_f32_16x16x32_bf16 v[44:47], v[108:111], v[84:87], v[44:47]
ds_read_b128 v[76:79], v9 offset:34816
s_waitcnt lgkmcnt(7)
v_mfma_f32_16x16x32_bf16 v[48:51], v[104:107], v[64:67], v[48:51]
ds_read_b128 v[80:83], v9 offset:36864
v_mfma_f32_16x16x32_bf16 v[52:55], v[108:111], v[64:67], v[52:55]
s_waitcnt lgkmcnt(7)
v_mfma_f32_16x16x32_bf16 v[56:59], v[104:107], v[68:71], v[56:59]
ds_read_b128 v[84:87], v9 offset:38912
v_mfma_f32_16x16x32_bf16 v[60:63], v[108:111], v[68:71], v[60:63]
s_waitcnt lgkmcnt(3)
v_mfma_f32_16x16x32_bf16 v[32:35], v[112:115], v[72:75], v[32:35]
s_waitcnt lgkmcnt(0)
s_barrier
s_mov_b32 s57, 0
s_lshl_b32 s53, s7, 1
s_add_u32 s54, s53, 1
L_pub_15:
    s_waitcnt vmcnt(0)
L_pube_17:
    v_and_b32 v4, 0x80808080, v28
    v_cmp_ne_u32 vcc, 0x80808080, v4
    s_cbranch_vccz L_pubd_16
    s_add_u32 s57, s57, 1
    s_cmp_gt_u32 s57, 200000
    s_cbranch_scc1 L_pubd_16
    buffer_load_dword v28, v7, s[44:47], 0 offen sc1
    s_branch L_pub_15
L_pubd_16:
    v_readlane_b32 s3, v28, s53
    v_readlane_b32 s52, v28, s54
    s_and_b32 s53, s3, 0xff
    s_mul_i32 s53, s53, 0x01010101
    s_xor_b32 s3, s3, s53
    s_xor_b32 s52, s52, s53
    s_or_b32 s3, s3, s52
    s_cmp_eq_u32 s3, 0
    s_cselect_b32 s63, 1, 0
    s_cmp_eq_u32 s63, 0
    s_cselect_b32 s99, 327680, 0
ds_read_b64_tr_b16 v[96:97], v18 offset:16384
ds_read_b64_tr_b16 v[98:99], v18 offset:16896
v_mfma_f32_16x16x32_bf16 v[36:39], v[116:119], v[72:75], v[36:39]
ds_read_b64_tr_b16 v[100:101], v19 offset:16384
s_waitcnt lgkmcnt(5)
v_mfma_f32_16x16x32_bf16 v[40:43], v[112:115], v[76:79], v[40:43]
ds_read_b64_tr_b16 v[102:103], v19 offset:16896
ds_read_b128 v[64:67], v12 offset:0
v_mfma_f32_16x16x32_bf16 v[44:47], v[116:119], v[76:79], v[44:47]
ds_read_b128 v[68:71], v12 offset:2048
s_waitcnt lgkmcnt(7)
v_mfma_f32_16x16x32_bf16 v[48:51], v[112:115], v[80:83], v[48:51]
ds_read_b128 v[72:75], v12 offset:4096
v_mfma_f32_16x16x32_bf16 v[52:55], v[116:119], v[80:83], v[52:55]
s_waitcnt lgkmcnt(7)
v_mfma_f32_16x16x32_bf16 v[56:59], v[112:115], v[84:87], v[56:59]
ds_read_b128 v[76:79], v12 offset:6144
v_mfma_f32_16x16x32_bf16 v[60:63], v[116:119], v[84:87], v[60:63]
s_waitcnt lgkmcnt(3)
v_mfma_f32_16x16x32_bf16 v[32:35], v[96:99], v[64:67], v[32:35]
ds_read_b64_tr_b16 v[104:105], v18 offset:20480
ds_read_b64_tr_b16 v[106:107], v18 offset:20992
v_mfma_f32_16x16x32_bf16 v[36:39], v[100:103], v[64:67], v[36:39]
ds_read_b64_tr_b16 v[108:109], v19 offset:20480
s_waitcnt lgkmcnt(5)
v_mfma_f32_16x16x32_bf16 v[40:43], v[96:99], v[68:71], v[40:43]
ds_read_b64_tr_b16 v[110:111], v19 offset:20992
ds_read_b128 v[80:83], v13 offset:0
v_mfma_f32_16x16x32_bf16 v[44:47], v[100:103], v[68:71], v[44:47]
ds_read_b128 v[84:87], v13 offset:2048
s_waitcnt lgkmcnt(7)
v_mfma_f32_16x16x32_bf16 v[48:51], v[96:99], v[72:75], v[48:51]
ds_read_b128 v[64:67], v13 offset:4096
v_mfma_f32_16x16x32_bf16 v[52:55], v[100:103], v[72:75], v[52:55]
s_waitcnt lgkmcnt(7)
v_mfma_f32_16x16x32_bf16 v[56:59], v[96:99], v[76:79], v[56:59]
ds_read_b128 v[68:71], v13 offset:6144
v_mfma_f32_16x16x32_bf16 v[60:63], v[100:103], v[76:79], v[60:63]
s_waitcnt lgkmcnt(3)
v_mfma_f32_16x16x32_bf16 v[32:35], v[104:107], v[80:83], v[32:35]
ds_read_b64_tr_b16 v[112:113], v18 offset:24576
ds_read_b64_tr_b16 v[114:115], v18 offset:25088
v_mfma_f32_16x16x32_bf16 v[36:39], v[108:111], v[80:83], v[36:39]
ds_read_b64_tr_b16 v[116:117], v19 offset:24576
s_waitcnt lgkmcnt(5)
v_mfma_f32_16x16x32_bf16 v[40:43], v[104:107], v[84:87], v[40:43]
ds_read_b64_tr_b16 v[118:119], v19 offset:25088
ds_read_b128 v[72:75], v14 offset:0
v_mfma_f32_16x16x32_bf16 v[44:47], v[108:111], v[84:87], v[44:47]
ds_read_b128 v[76:79], v14 offset:2048
s_waitcnt lgkmcnt(7)
v_mfma_f32_16x16x32_bf16 v[48:51], v[104:107], v[64:67], v[48:51]
ds_read_b128 v[80:83], v14 offset:4096
v_mfma_f32_16x16x32_bf16 v[52:55], v[108:111], v[64:67], v[52:55]
s_waitcnt lgkmcnt(7)
v_mfma_f32_16x16x32_bf16 v[56:59], v[104:107], v[68:71], v[56:59]
ds_read_b128 v[84:87], v14 offset:6144
v_mfma_f32_16x16x32_bf16 v[60:63], v[108:111], v[68:71], v[60:63]
s_waitcnt lgkmcnt(3)
v_mfma_f32_16x16x32_bf16 v[32:35], v[112:115], v[72:75], v[32:35]
ds_read_b64_tr_b16 v[96:97], v18 offset:28672
ds_read_b64_tr_b16 v[98:99], v18 offset:29184
v_mfma_f32_16x16x32_bf16 v[36:39], v[116:119], v[72:75], v[36:39]
ds_read_b64_tr_b16 v[100:101], v19 offset:28672
s_waitcnt lgkmcnt(5)
v_mfma_f32_16x16x32_bf16 v[40:43], v[112:115], v[76:79], v[40:43]
ds_read_b64_tr_b16 v[102:103], v19 offset:29184
ds_read_b128 v[64:67], v15 offset:0
v_mfma_f32_16x16x32_bf16 v[44:47], v[116:119], v[76:79], v[44:47]
ds_read_b128 v[68:71], v15 offset:2048
s_waitcnt lgkmcnt(7)
v_mfma_f32_16x16x32_bf16 v[48:51], v[112:115], v[80:83], v[48:51]
ds_read_b128 v[72:75], v15 offset:4096
v_mfma_f32_16x16x32_bf16 v[52:55], v[116:119], v[80:83], v[52:55]
s_waitcnt lgkmcnt(7)
v_mfma_f32_16x16x32_bf16 v[56:59], v[112:115], v[84:87], v[56:59]
ds_read_b128 v[76:79], v15 offset:6144
v_mfma_f32_16x16x32_bf16 v[60:63], v[116:119], v[84:87], v[60:63]
s_waitcnt lgkmcnt(3)
v_mfma_f32_16x16x32_bf16 v[32:35], v[96:99], v[64:67], v[32:35]
s_waitcnt lgkmcnt(0)
s_barrier
ds_read_b64_tr_b16 v[104:105], v18 offset:49152
ds_read_b64_tr_b16 v[106:107], v18 offset:49664
v_mfma_f32_16x16x32_bf16 v[36:39], v[100:103], v[64:67], v[36:39]
ds_read_b64_tr_b16 v[108:109], v19 offset:49152
s_waitcnt lgkmcnt(5)
v_mfma_f32_16x16x32_bf16 v[40:43], v[96:99], v[68:71], v[40:43]
ds_read_b64_tr_b16 v[110:111], v19 offset:49664
ds_read_b128 v[80:83], v12 offset:32768
v_mfma_f32_16x16x32_bf16 v[44:47], v[100:103], v[68:71], v[44:47]
ds_read_b128 v[84:87], v12 offset:34816
s_waitcnt lgkmcnt(7)
v_mfma_f32_16x16x32_bf16 v[48:51], v[96:99], v[72:75], v[48:51]
ds_read_b128 v[64:67], v12 offset:36864
v_mfma_f32_16x16x32_bf16 v[52:55], v[100:103], v[72:75], v[52:55]
s_waitcnt lgkmcnt(7)
v_mfma_f32_16x16x32_bf16 v[56:59], v[96:99], v[76:79], v[56:59]
ds_read_b128 v[68:71], v12 offset:38912
v_mfma_f32_16x16x32_bf16 v[60:63], v[100:103], v[76:79], v[60:63]
s_waitcnt lgkmcnt(3)
v_mfma_f32_16x16x32_bf16 v[32:35], v[104:107], v[80:83], v[32:35]
ds_read_b64_tr_b16 v[112:113], v18 offset:53248
ds_read_b64_tr_b16 v[114:115], v18 offset:53760
v_mfma_f32_16x16x32_bf16 v[36:39], v[108:111], v[80:83], v[36:39]
ds_read_b64_tr_b16 v[116:117], v19 offset:53248
s_waitcnt lgkmcnt(5)
v_mfma_f32_16x16x32_bf16 v[40:43], v[104:107], v[84:87], v[40:43]
ds_read_b64_tr_b16 v[118:119], v19 offset:53760
ds_read_b128 v[72:75], v13 offset:32768
v_mfma_f32_16x16x32_bf16 v[44:47], v[108:111], v[84:87], v[44:47]
ds_read_b128 v[76:79], v13 offset:34816
s_waitcnt lgkmcnt(7)
v_mfma_f32_16x16x32_bf16 v[48:51], v[104:107], v[64:67], v[48:51]
ds_read_b128 v[80:83], v13 offset:36864
v_mfma_f32_16x16x32_bf16 v[52:55], v[108:111], v[64:67], v[52:55]
s_waitcnt lgkmcnt(7)
v_mfma_f32_16x16x32_bf16 v[56:59], v[104:107], v[68:71], v[56:59]
ds_read_b128 v[84:87], v13 offset:38912
v_mfma_f32_16x16x32_bf16 v[60:63], v[108:111], v[68:71], v[60:63]
s_waitcnt lgkmcnt(3)
v_mfma_f32_16x16x32_bf16 v[32:35], v[112:115], v[72:75], v[32:35]
v_mfma_f32_16x16x32_bf16 v[36:39], v[116:119], v[72:75], v[36:39]
s_waitcnt lgkmcnt(2)
v_mfma_f32_16x16x32_bf16 v[40:43], v[112:115], v[76:79], v[40:43]
v_mfma_f32_16x16x32_bf16 v[44:47], v[116:119], v[76:79], v[44:47]
s_waitcnt lgkmcnt(1)
v_mfma_f32_16x16x32_bf16 v[48:51], v[112:115], v[80:83], v[48:51]
v_mfma_f32_16x16x32_bf16 v[52:55], v[116:119], v[80:83], v[52:55]
s_waitcnt lgkmcnt(0)
v_mfma_f32_16x16x32_bf16 v[56:59], v[112:115], v[84:87], v[56:59]
v_mfma_f32_16x16x32_bf16 v[60:63], v[116:119], v[84:87], v[60:63]
s_nop 7
v_pk_mul_f32 v[96:97], v[32:33], v[32:33]
v_pk_mul_f32 v[98:99], v[34:35], v[34:35]
v_pk_mul_f32 v[100:101], v[36:37], v[36:37]
v_pk_mul_f32 v[102:103], v[38:39], v[38:39]
v_pk_mul_f32 v[104:105], v[40:41], v[40:41]
v_pk_mul_f32 v[106:107], v[42:43], v[42:43]
v_pk_mul_f32 v[108:109], v[44:45], v[44:45]
v_pk_mul_f32 v[110:111], v[46:47], v[46:47]
v_pk_fma_f32 v[96:97], v[96:97], s[60:61], v[24:25]
v_pk_fma_f32 v[98:99], v[98:99], s[60:61], v[24:25]
v_pk_fma_f32 v[100:101], v[100:101], s[60:61], v[24:25]
v_pk_fma_f32 v[102:103], v[102:103], s[60:61], v[24:25]
v_pk_fma_f32 v[104:105], v[104:105], s[60:61], v[24:25]
v_pk_fma_f32 v[106:107], v[106:107], s[60:61], v[24:25]
v_pk_fma_f32 v[108:109], v[108:109], s[60:61], v[24:25]
v_pk_fma_f32 v[110:111], v[110:111], s[60:61], v[24:25]
v_pk_mul_f32 v[96:97], v[96:97], v[32:33]
v_pk_mul_f32 v[98:99], v[98:99], v[34:35]
v_pk_mul_f32 v[100:101], v[100:101], v[36:37]
v_pk_mul_f32 v[102:103], v[102:103], v[38:39]
v_pk_mul_f32 v[104:105], v[104:105], v[40:41]
v_pk_mul_f32 v[106:107], v[106:107], v[42:43]
v_pk_mul_f32 v[108:109], v[108:109], v[44:45]
v_pk_mul_f32 v[110:111], v[110:111], v[46:47]
v_exp_f32 v96, v96
v_exp_f32 v97, v97
v_exp_f32 v98, v98
v_exp_f32 v99, v99
v_exp_f32 v100, v100
v_exp_f32 v101, v101
v_exp_f32 v102, v102
v_exp_f32 v103, v103
v_exp_f32 v104, v104
v_exp_f32 v105, v105
v_exp_f32 v106, v106
v_exp_f32 v107, v107
v_exp_f32 v108, v108
v_exp_f32 v109, v109
v_exp_f32 v110, v110
v_exp_f32 v111, v111
v_pk_add_f32 v[96:97], v[96:97], 1.0 op_sel_hi:[1,0]
v_pk_add_f32 v[98:99], v[98:99], 1.0 op_sel_hi:[1,0]
v_pk_add_f32 v[100:101], v[100:101], 1.0 op_sel_hi:[1,0]
v_pk_add_f32 v[102:103], v[102:103], 1.0 op_sel_hi:[1,0]
v_pk_add_f32 v[104:105], v[104:105], 1.0 op_sel_hi:[1,0]
v_pk_add_f32 v[106:107], v[106:107], 1.0 op_sel_hi:[1,0]
v_pk_add_f32 v[108:109], v[108:109], 1.0 op_sel_hi:[1,0]
v_pk_add_f32 v[110:111], v[110:111], 1.0 op_sel_hi:[1,0]
v_rcp_f32 v96, v96
v_rcp_f32 v97, v97
v_rcp_f32 v98, v98
v_rcp_f32 v99, v99
v_rcp_f32 v100, v100
v_rcp_f32 v101, v101
v_rcp_f32 v102, v102
v_rcp_f32 v103, v103
v_rcp_f32 v104, v104
v_rcp_f32 v105, v105
v_rcp_f32 v106, v106
v_rcp_f32 v107, v107
v_rcp_f32 v108, v108
v_rcp_f32 v109, v109
v_rcp_f32 v110, v110
v_rcp_f32 v111, v111
v_pk_mul_f32 v[96:97], v[96:97], v[32:33]
v_pk_mul_f32 v[98:99], v[98:99], v[34:35]
v_pk_mul_f32 v[100:101], v[100:101], v[36:37]
v_pk_mul_f32 v[102:103], v[102:103], v[38:39]
v_pk_mul_f32 v[104:105], v[104:105], v[40:41]
v_pk_mul_f32 v[106:107], v[106:107], v[42:43]
v_pk_mul_f32 v[108:109], v[108:109], v[44:45]
v_pk_mul_f32 v[110:111], v[110:111], v[46:47]
v_cvt_pk_bf16_f32 v112, v96, v97
v_cvt_pk_bf16_f32 v113, v98, v99
v_cvt_pk_bf16_f32 v114, v100, v101
v_cvt_pk_bf16_f32 v115, v102, v103
v_cvt_pk_bf16_f32 v116, v104, v105
v_cvt_pk_bf16_f32 v117, v106, v107
v_cvt_pk_bf16_f32 v118, v108, v109
v_cvt_pk_bf16_f32 v119, v110, v111
s_nop 1
v_permlane16_swap_b32 v112, v114
v_permlane16_swap_b32 v113, v115
v_permlane16_swap_b32 v116, v118
v_permlane16_swap_b32 v117, v119
s_nop 1
v_cndmask_b32 v112, v112, 0, s[58:59]
v_cndmask_b32 v113, v113, 0, s[58:59]
v_cndmask_b32 v114, v114, 0, s[58:59]
v_cndmask_b32 v115, v115, 0, s[58:59]
s_lshr_b32 s52, s4, 1
s_lshl_b32 s52, s52, 12
s_add_u32 s52, s52, 0
s_cmp_eq_u32 s63, 0
s_cbranch_scc1 L_xs_18
buffer_store_dwordx4 v[112:115], v5, s[40:43], s52 offen offset:0
buffer_store_dwordx4 v[116:119], v5, s[40:43], s52 offen offset:1024
L_xd_19:
v_pk_mul_f32 v[96:97], v[48:49], v[48:49]
v_pk_mul_f32 v[98:99], v[50:51], v[50:51]
v_pk_mul_f32 v[100:101], v[52:53], v[52:53]
v_pk_mul_f32 v[102:103], v[54:55], v[54:55]
v_pk_mul_f32 v[104:105], v[56:57], v[56:57]
v_pk_mul_f32 v[106:107], v[58:59], v[58:59]
v_pk_mul_f32 v[108:109], v[60:61], v[60:61]
v_pk_mul_f32 v[110:111], v[62:63], v[62:63]
v_pk_fma_f32 v[96:97], v[96:97], s[60:61], v[24:25]
v_pk_fma_f32 v[98:99], v[98:99], s[60:61], v[24:25]
v_pk_fma_f32 v[100:101], v[100:101], s[60:61], v[24:25]
v_pk_fma_f32 v[102:103], v[102:103], s[60:61], v[24:25]
v_pk_fma_f32 v[104:105], v[104:105], s[60:61], v[24:25]
v_pk_fma_f32 v[106:107], v[106:107], s[60:61], v[24:25]
v_pk_fma_f32 v[108:109], v[108:109], s[60:61], v[24:25]
v_pk_fma_f32 v[110:111], v[110:111], s[60:61], v[24:25]
v_pk_mul_f32 v[96:97], v[96:97], v[48:49]
v_pk_mul_f32 v[98:99], v[98:99], v[50:51]
v_pk_mul_f32 v[100:101], v[100:101], v[52:53]
v_pk_mul_f32 v[102:103], v[102:103], v[54:55]
v_pk_mul_f32 v[104:105], v[104:105], v[56:57]
v_pk_mul_f32 v[106:107], v[106:107], v[58:59]
v_pk_mul_f32 v[108:109], v[108:109], v[60:61]
v_pk_mul_f32 v[110:111], v[110:111], v[62:63]
v_exp_f32 v96, v96
v_exp_f32 v97, v97
v_exp_f32 v98, v98
v_exp_f32 v99, v99
v_exp_f32 v100, v100
v_exp_f32 v101, v101
v_exp_f32 v102, v102
v_exp_f32 v103, v103
v_exp_f32 v104, v104
v_exp_f32 v105, v105
v_exp_f32 v106, v106
v_exp_f32 v107, v107
v_exp_f32 v108, v108
v_exp_f32 v109, v109
v_exp_f32 v110, v110
v_exp_f32 v111, v111
v_pk_add_f32 v[96:97], v[96:97], 1.0 op_sel_hi:[1,0]
v_pk_add_f32 v[98:99], v[98:99], 1.0 op_sel_hi:[1,0]
v_pk_add_f32 v[100:101], v[100:101], 1.0 op_sel_hi:[1,0]
v_pk_add_f32 v[102:103], v[102:103], 1.0 op_sel_hi:[1,0]
v_pk_add_f32 v[104:105], v[104:105], 1.0 op_sel_hi:[1,0]
v_pk_add_f32 v[106:107], v[106:107], 1.0 op_sel_hi:[1,0]
v_pk_add_f32 v[108:109], v[108:109], 1.0 op_sel_hi:[1,0]
v_pk_add_f32 v[110:111], v[110:111], 1.0 op_sel_hi:[1,0]
v_rcp_f32 v96, v96
v_rcp_f32 v97, v97
v_rcp_f32 v98, v98
v_rcp_f32 v99, v99
v_rcp_f32 v100, v100
v_rcp_f32 v101, v101
v_rcp_f32 v102, v102
v_rcp_f32 v103, v103
v_rcp_f32 v104, v104
v_rcp_f32 v105, v105
v_rcp_f32 v106, v106
v_rcp_f32 v107, v107
v_rcp_f32 v108, v108
v_rcp_f32 v109, v109
v_rcp_f32 v110, v110
v_rcp_f32 v111, v111
v_pk_mul_f32 v[96:97], v[96:97], v[48:49]
v_pk_mul_f32 v[98:99], v[98:99], v[50:51]
v_pk_mul_f32 v[100:101], v[100:101], v[52:53]
v_pk_mul_f32 v[102:103], v[102:103], v[54:55]
v_pk_mul_f32 v[104:105], v[104:105], v[56:57]
v_pk_mul_f32 v[106:107], v[106:107], v[58:59]
v_pk_mul_f32 v[108:109], v[108:109], v[60:61]
v_pk_mul_f32 v[110:111], v[110:111], v[62:63]
v_cvt_pk_bf16_f32 v120, v96, v97
v_cvt_pk_bf16_f32 v121, v98, v99
v_cvt_pk_bf16_f32 v122, v100, v101
v_cvt_pk_bf16_f32 v123, v102, v103
v_cvt_pk_bf16_f32 v124, v104, v105
v_cvt_pk_bf16_f32 v125, v106, v107
v_cvt_pk_bf16_f32 v126, v108, v109
v_cvt_pk_bf16_f32 v127, v110, v111
s_nop 1
v_permlane16_swap_b32 v120, v122
v_permlane16_swap_b32 v121, v123
v_permlane16_swap_b32 v124, v126
v_permlane16_swap_b32 v125, v127
s_lshr_b32 s52, s4, 1
s_lshl_b32 s52, s52, 12
s_add_u32 s52, s52, 2048
s_cmp_eq_u32 s63, 0
s_cbranch_scc1 L_xs_20
buffer_store_dwordx4 v[120:123], v5, s[40:43], s52 offen offset:0
buffer_store_dwordx4 v[124:127], v5, s[40:43], s52 offen offset:1024
L_xd_21:
s_lshr_b32 s52, s4, 1
s_lshl_b32 s52, s52, 12
s_add_u32 s52, s52, 73728
v_and_b32 v26, 0x3fff, v5
v_add_u32 v26, s52, v26
ds_write_b128 v26, v[112:115] offset:0
ds_write_b128 v26, v[116:119] offset:1024
ds_write_b128 v26, v[120:123] offset:2048
ds_write_b128 v26, v[124:127] offset:3072
s_waitcnt vmcnt(0)
s_mov_b64 exec, 1
s_cmp_eq_u32 s63, 0
s_cbranch_scc1 L_xs_22
buffer_store_dword v3, v2, s[40:43], 0 offen offset:0
L_xd_23:
s_mov_b64 exec, -1
s_lshr_b32 s52, s4, 1
s_lshl_b32 s53, s52, 12
v_and_b32 v26, 15, v0
v_and_b32 v27, 6, v26
    v_lshrrev_b32 v30, 4, v0
    v_xor_b32 v27, v27, v30
    v_lshlrev_b32 v27, 4, v27
    v_lshl_add_u32 v27, v26, 7, v27
    v_add_u32 v8, s53, v27
v_add_u32 v8, 49152, v8
v_xor_b32 v9, 64, v8
v_and_b32 v26, 15, v0
v_add_u32 v26, 1, v26
v_and_b32 v27, 6, v26
    v_lshrrev_b32 v30, 4, v0
    v_xor_b32 v27, v27, v30
    v_lshlrev_b32 v27, 4, v27
    v_lshl_add_u32 v27, v26, 7, v27
    v_add_u32 v10, s53, v27
v_add_u32 v10, 49152, v10
v_xor_b32 v11, 64, v10
v_add_u32 v12, 57344, v8
v_add_u32 v13, 57344, v9
v_add_u32 v14, 57344, v10
v_add_u32 v15, 57344, v11
v_add_u32 v18, 49152, v16
v_add_u32 v20, 114688, v16
v_add_u32 v19, 49152, v17
v_add_u32 v21, 114688, v17
s_waitcnt lgkmcnt(0)
s_barrier
ds_read_b64_tr_b16 a[0:1], v20 offset:0
ds_read_b64_tr_b16 a[2:3], v20 offset:512
ds_read_b64_tr_b16 a[4:5], v21 offset:0
ds_read_b64_tr_b16 a[6:7], v21 offset:512
ds_read_b64_tr_b16 a[8:9], v20 offset:4096
ds_read_b64_tr_b16 a[10:11], v20 offset:4608
ds_read_b64_tr_b16 a[12:13], v21 offset:4096
ds_read_b64_tr_b16 a[14:15], v21 offset:4608
s_waitcnt lgkmcnt(4)
ds_read_b64_tr_b16 a[16:17], v20 offset:16384
ds_read_b64_tr_b16 a[18:19], v20 offset:16896
ds_read_b64_tr_b16 a[20:21], v21 offset:16384
ds_read_b64_tr_b16 a[22:23], v21 offset:16896
ds_read_b64_tr_b16 a[24:25], v20 offset:20480
ds_read_b64_tr_b16 a[26:27], v20 offset:20992
ds_read_b64_tr_b16 a[28:29], v21 offset:20480
ds_read_b64_tr_b16 a[30:31], v21 offset:20992
s_waitcnt lgkmcnt(4)
ds_read_b64_tr_b16 a[32:33], v20 offset:8192
ds_read_b64_tr_b16 a[34:35], v20 offset:8704
ds_read_b64_tr_b16 a[36:37], v21 offset:8192
ds_read_b64_tr_b16 a[38:39], v21 offset:8704
ds_read_b64_tr_b16 a[40:41], v20 offset:12288
ds_read_b64_tr_b16 a[42:43], v20 offset:12800
ds_read_b64_tr_b16 a[44:45], v21 offset:12288
ds_read_b64_tr_b16 a[46:47], v21 offset:12800
s_waitcnt lgkmcnt(4)
ds_read_b64_tr_b16 a[48:49], v20 offset:24576
ds_read_b64_tr_b16 a[50:51], v20 offset:25088
ds_read_b64_tr_b16 a[52:53], v21 offset:24576
ds_read_b64_tr_b16 a[54:55], v21 offset:25088
ds_read_b64_tr_b16 a[56:57], v20 offset:28672
ds_read_b64_tr_b16 a[58:59], v20 offset:29184
ds_read_b64_tr_b16 a[60:61], v21 offset:28672
ds_read_b64_tr_b16 a[62:63], v21 offset:29184
s_waitcnt lgkmcnt(4)
ds_read_b64_tr_b16 a[64:65], v20 offset:40960
ds_read_b64_tr_b16 a[66:67], v20 offset:41472
ds_read_b64_tr_b16 a[68:69], v21 offset:40960
ds_read_b64_tr_b16 a[70:71], v21 offset:41472
ds_read_b64_tr_b16 a[72:73], v20 offset:45056
ds_read_b64_tr_b16 a[74:75], v20 offset:45568
ds_read_b64_tr_b16 a[76:77], v21 offset:45056
ds_read_b64_tr_b16 a[78:79], v21 offset:45568
s_waitcnt lgkmcnt(4)
ds_read_b64_tr_b16 a[80:81], v20 offset:32768
ds_read_b64_tr_b16 a[82:83], v20 offset:33280
ds_read_b64_tr_b16 a[84:85], v21 offset:32768
ds_read_b64_tr_b16 a[86:87], v21 offset:33280
ds_read_b64_tr_b16 a[88:89], v20 offset:36864
ds_read_b64_tr_b16 a[90:91], v20 offset:37376
ds_read_b64_tr_b16 a[92:93], v21 offset:36864
ds_read_b64_tr_b16 a[94:95], v21 offset:37376
s_waitcnt lgkmcnt(4)
ds_read_b64_tr_b16 a[96:97], v16 offset:0
ds_read_b64_tr_b16 a[98:99], v16 offset:512
ds_read_b64_tr_b16 a[100:101], v17 offset:0
ds_read_b64_tr_b16 a[102:103], v17 offset:512
ds_read_b64_tr_b16 a[104:105], v16 offset:4096
ds_read_b64_tr_b16 a[106:107], v16 offset:4608
ds_read_b64_tr_b16 a[108:109], v17 offset:4096
ds_read_b64_tr_b16 a[110:111], v17 offset:4608
s_waitcnt lgkmcnt(4)
ds_read_b64_tr_b16 a[112:113], v16 offset:16384
ds_read_b64_tr_b16 a[114:115], v16 offset:16896
ds_read_b64_tr_b16 a[116:117], v17 offset:16384
ds_read_b64_tr_b16 a[118:119], v17 offset:16896
ds_read_b64_tr_b16 a[120:121], v16 offset:20480
ds_read_b64_tr_b16 a[122:123], v16 offset:20992
ds_read_b64_tr_b16 a[124:125], v17 offset:20480
ds_read_b64_tr_b16 a[126:127], v17 offset:20992
s_waitcnt lgkmcnt(4)
ds_read_b64_tr_b16 v[48:49], v16 offset:8192
ds_read_b64_tr_b16 v[50:51], v16 offset:8704
ds_read_b64_tr_b16 v[52:53], v17 offset:8192
ds_read_b64_tr_b16 v[54:55], v17 offset:8704
ds_read_b64_tr_b16 v[56:57], v16 offset:12288
ds_read_b64_tr_b16 v[58:59], v16 offset:12800
ds_read_b64_tr_b16 v[60:61], v17 offset:12288
ds_read_b64_tr_b16 v[62:63], v17 offset:12800
s_waitcnt lgkmcnt(4)
s_waitcnt lgkmcnt(0)
ds_read_b128 v[64:67], v8 offset:24576
ds_read_b128 v[68:71], v8 offset:26624
ds_read_b128 v[72:75], v9 offset:24576
ds_read_b128 v[76:79], v9 offset:26624
s_waitcnt lgkmcnt(3)
v_mfma_f32_16x16x32_bf16 v[32:35], a[0:3], v[64:67], 0
ds_read_b128 v[80:83], v10 offset:24576
v_mfma_f32_16x16x32_bf16 v[36:39], a[4:7], v[64:67], 0
s_waitcnt lgkmcnt(3)
v_mfma_f32_16x16x32_bf16 v[40:43], a[0:3], v[68:71], 0
ds_read_b128 v[84:87], v10 offset:26624
v_mfma_f32_16x16x32_bf16 v[44:47], a[4:7], v[68:71], 0
s_waitcnt lgkmcnt(3)
v_mfma_f32_16x16x32_bf16 v[32:35], a[8:11], v[72:75], v[32:35]
ds_read_b128 v[64:67], v11 offset:24576
v_mfma_f32_16x16x32_bf16 v[36:39], a[12:15], v[72:75], v[36:39]
s_waitcnt lgkmcnt(3)
v_mfma_f32_16x16x32_bf16 v[40:43], a[8:11], v[76:79], v[40:43]
ds_read_b128 v[68:71], v11 offset:26624
v_mfma_f32_16x16x32_bf16 v[44:47], a[12:15], v[76:79], v[44:47]
s_waitcnt lgkmcnt(3)
v_mfma_f32_16x16x32_bf16 v[32:35], a[16:19], v[80:83], v[32:35]
ds_read_b128 v[72:75], v8 offset:32768
v_mfma_f32_16x16x32_bf16 v[36:39], a[20:23], v[80:83], v[36:39]
s_waitcnt lgkmcnt(3)
v_mfma_f32_16x16x32_bf16 v[40:43], a[16:19], v[84:87], v[40:43]
ds_read_b128 v[76:79], v8 offset:34816
v_mfma_f32_16x16x32_bf16 v[44:47], a[20:23], v[84:87], v[44:47]
s_waitcnt lgkmcnt(3)
v_mfma_f32_16x16x32_bf16 v[32:35], a[24:27], v[64:67], v[32:35]
ds_read_b128 v[80:83], v9 offset:32768
v_mfma_f32_16x16x32_bf16 v[36:39], a[28:31], v[64:67], v[36:39]
s_waitcnt lgkmcnt(3)
v_mfma_f32_16x16x32_bf16 v[40:43], a[24:27], v[68:71], v[40:43]
ds_read_b128 v[84:87], v9 offset:34816
v_mfma_f32_16x16x32_bf16 v[44:47], a[28:31], v[68:71], v[44:47]
s_waitcnt lgkmcnt(3)
v_mfma_f32_16x16x32_bf16 v[32:35], a[32:35], v[72:75], v[32:35]
s_barrier
ds_read_b128 v[64:67], v8 offset:40960
v_mfma_f32_16x16x32_bf16 v[36:39], a[36:39], v[72:75], v[36:39]
s_waitcnt lgkmcnt(3)
v_mfma_f32_16x16x32_bf16 v[40:43], a[32:35], v[76:79], v[40:43]
ds_read_b128 v[68:71], v8 offset:43008
v_mfma_f32_16x16x32_bf16 v[44:47], a[36:39], v[76:79], v[44:47]
s_waitcnt lgkmcnt(3)
v_mfma_f32_16x16x32_bf16 v[32:35], a[40:43], v[80:83], v[32:35]
ds_read_b128 v[72:75], v9 offset:40960
v_mfma_f32_16x16x32_bf16 v[36:39], a[44:47], v[80:83], v[36:39]
s_waitcnt lgkmcnt(3)
v_mfma_f32_16x16x32_bf16 v[40:43], a[40:43], v[84:87], v[40:43]
ds_read_b128 v[76:79], v9 offset:43008
v_mfma_f32_16x16x32_bf16 v[44:47], a[44:47], v[84:87], v[44:47]
s_waitcnt lgkmcnt(3)
v_mfma_f32_16x16x32_bf16 v[32:35], a[48:51], v[64:67], v[32:35]
ds_read_b128 v[80:83], v10 offset:40960
v_mfma_f32_16x16x32_bf16 v[36:39], a[52:55], v[64:67], v[36:39]
s_waitcnt lgkmcnt(3)
v_mfma_f32_16x16x32_bf16 v[40:43], a[48:51], v[68:71], v[40:43]
ds_read_b128 v[84:87], v10 offset:43008
v_mfma_f32_16x16x32_bf16 v[44:47], a[52:55], v[68:71], v[44:47]
s_waitcnt lgkmcnt(3)
v_mfma_f32_16x16x32_bf16 v[32:35], a[56:59], v[72:75], v[32:35]
ds_read_b128 v[64:67], v11 offset:40960
v_mfma_f32_16x16x32_bf16 v[36:39], a[60:63], v[72:75], v[36:39]
s_waitcnt lgkmcnt(3)
v_mfma_f32_16x16x32_bf16 v[40:43], a[56:59], v[76:79], v[40:43]
ds_read_b128 v[68:71], v11 offset:43008
v_mfma_f32_16x16x32_bf16 v[44:47], a[60:63], v[76:79], v[44:47]
s_waitcnt lgkmcnt(3)
v_mfma_f32_16x16x32_bf16 v[32:35], a[64:67], v[80:83], v[32:35]
ds_read_b128 v[72:75], v8 offset:49152
v_mfma_f32_16x16x32_bf16 v[36:39], a[68:71], v[80:83], v[36:39]
s_waitcnt lgkmcnt(3)
v_mfma_f32_16x16x32_bf16 v[40:43], a[64:67], v[84:87], v[40:43]
ds_read_b128 v[76:79], v8 offset:51200
v_mfma_f32_16x16x32_bf16 v[44:47], a[68:71], v[84:87], v[44:47]
s_waitcnt lgkmcnt(3)
v_mfma_f32_16x16x32_bf16 v[32:35], a[72:75], v[64:67], v[32:35]
ds_read_b128 v[80:83], v9 offset:49152
v_mfma_f32_16x16x32_bf16 v[36:39], a[76:79], v[64:67], v[36:39]
s_waitcnt lgkmcnt(3)
v_mfma_f32_16x16x32_bf16 v[40:43], a[72:75], v[68:71], v[40:43]
ds_read_b128 v[84:87], v9 offset:51200
v_mfma_f32_16x16x32_bf16 v[44:47], a[76:79], v[68:71], v[44:47]
s_waitcnt lgkmcnt(3)
v_mfma_f32_16x16x32_bf16 v[32:35], a[80:83], v[72:75], v[32:35]
s_barrier
ds_read_b128 v[64:67], v8 offset:0
v_mfma_f32_16x16x32_bf16 v[36:39], a[84:87], v[72:75], v[36:39]
s_waitcnt lgkmcnt(3)
v_mfma_f32_16x16x32_bf16 v[40:43], a[80:83], v[76:79], v[40:43]
ds_read_b128 v[68:71], v8 offset:2048
v_mfma_f32_16x16x32_bf16 v[44:47], a[84:87], v[76:79], v[44:47]
s_waitcnt lgkmcnt(3)
v_mfma_f32_16x16x32_bf16 v[32:35], a[88:91], v[80:83], v[32:35]
ds_read_b128 v[72:75], v9 offset:0
v_mfma_f32_16x16x32_bf16 v[36:39], a[92:95], v[80:83], v[36:39]
s_waitcnt lgkmcnt(3)
v_mfma_f32_16x16x32_bf16 v[40:43], a[88:91], v[84:87], v[40:43]
ds_read_b128 v[76:79], v9 offset:2048
v_mfma_f32_16x16x32_bf16 v[44:47], a[92:95], v[84:87], v[44:47]
s_waitcnt lgkmcnt(3)
v_mfma_f32_16x16x32_bf16 v[32:35], a[96:99], v[64:67], v[32:35]
ds_read_b128 v[80:83], v10 offset:0
v_mfma_f32_16x16x32_bf16 v[36:39], a[100:103], v[64:67], v[36:39]
s_waitcnt lgkmcnt(3)
v_mfma_f32_16x16x32_bf16 v[40:43], a[96:99], v[68:71], v[40:43]
ds_read_b128 v[84:87], v10 offset:2048
v_mfma_f32_16x16x32_bf16 v[44:47], a[100:103], v[68:71], v[44:47]
s_waitcnt lgkmcnt(3)
v_mfma_f32_16x16x32_bf16 v[32:35], a[104:107], v[72:75], v[32:35]
ds_read_b128 v[64:67], v11 offset:0
v_mfma_f32_16x16x32_bf16 v[36:39], a[108:111], v[72:75], v[36:39]
s_waitcnt lgkmcnt(3)
v_mfma_f32_16x16x32_bf16 v[40:43], a[104:107], v[76:79], v[40:43]
ds_read_b128 v[68:71], v11 offset:2048
v_mfma_f32_16x16x32_bf16 v[44:47], a[108:111], v[76:79], v[44:47]
s_waitcnt lgkmcnt(3)
v_mfma_f32_16x16x32_bf16 v[32:35], a[112:115], v[80:83], v[32:35]
ds_read_b128 v[72:75], v8 offset:8192
v_mfma_f32_16x16x32_bf16 v[36:39], a[116:119], v[80:83], v[36:39]
s_waitcnt lgkmcnt(3)
v_mfma_f32_16x16x32_bf16 v[40:43], a[112:115], v[84:87], v[40:43]
ds_read_b128 v[76:79], v8 offset:10240
v_mfma_f32_16x16x32_bf16 v[44:47], a[116:119], v[84:87], v[44:47]
s_waitcnt lgkmcnt(3)
v_mfma_f32_16x16x32_bf16 v[32:35], a[120:123], v[64:67], v[32:35]
ds_read_b128 v[80:83], v9 offset:8192
v_mfma_f32_16x16x32_bf16 v[36:39], a[124:127], v[64:67], v[36:39]
s_waitcnt lgkmcnt(3)
v_mfma_f32_16x16x32_bf16 v[40:43], a[120:123], v[68:71], v[40:43]
ds_read_b128 v[84:87], v9 offset:10240
v_mfma_f32_16x16x32_bf16 v[44:47], a[124:127], v[68:71], v[44:47]
s_waitcnt lgkmcnt(3)
v_mfma_f32_16x16x32_bf16 v[32:35], v[48:51], v[72:75], v[32:35]
s_barrier
ds_read_b64_tr_b16 v[96:97], v16 offset:24576
ds_read_b64_tr_b16 v[98:99], v16 offset:25088
v_mfma_f32_16x16x32_bf16 v[36:39], v[52:55], v[72:75], v[36:39]
ds_read_b64_tr_b16 v[100:101], v17 offset:24576
s_waitcnt lgkmcnt(5)
v_mfma_f32_16x16x32_bf16 v[40:43], v[48:51], v[76:79], v[40:43]
ds_read_b64_tr_b16 v[102:103], v17 offset:25088
ds_read_b128 v[64:67], v12 offset:0
v_mfma_f32_16x16x32_bf16 v[44:47], v[52:55], v[76:79], v[44:47]
ds_read_b128 v[68:71], v12 offset:2048
s_waitcnt lgkmcnt(7)
v_mfma_f32_16x16x32_bf16 v[32:35], v[56:59], v[80:83], v[32:35]
ds_read_b64_tr_b16 v[104:105], v16 offset:28672
ds_read_b64_tr_b16 v[106:107], v16 offset:29184
v_mfma_f32_16x16x32_bf16 v[36:39], v[60:63], v[80:83], v[36:39]
ds_read_b64_tr_b16 v[108:109], v17 offset:28672
s_waitcnt lgkmcnt(9)
v_mfma_f32_16x16x32_bf16 v[40:43], v[56:59], v[84:87], v[40:43]
ds_read_b64_tr_b16 v[110:111], v17 offset:29184
ds_read_b128 v[72:75], v13 offset:0
v_mfma_f32_16x16x32_bf16 v[44:47], v[60:63], v[84:87], v[44:47]
ds_read_b128 v[76:79], v13 offset:2048
s_waitcnt lgkmcnt(7)
v_mfma_f32_16x16x32_bf16 v[32:35], v[96:99], v[64:67], v[32:35]
ds_read_b64_tr_b16 v[112:113], v16 offset:40960
ds_read_b64_tr_b16 v[114:115], v16 offset:41472
v_mfma_f32_16x16x32_bf16 v[36:39], v[100:103], v[64:67], v[36:39]
ds_read_b64_tr_b16 v[116:117], v17 offset:40960
s_waitcnt lgkmcnt(9)
v_mfma_f32_16x16x32_bf16 v[40:43], v[96:99], v[68:71], v[40:43]
ds_read_b64_tr_b16 v[118:119], v17 offset:41472
ds_read_b128 v[80:83], v14 offset:0
v_mfma_f32_16x16x32_bf16 v[44:47], v[100:103], v[68:71], v[44:47]
ds_read_b128 v[84:87], v14 offset:2048
s_waitcnt lgkmcnt(7)
v_mfma_f32_16x16x32_bf16 v[32:35], v[104:107], v[72:75], v[32:35]
ds_read_b64_tr_b16 v[96:97], v16 offset:45056
ds_read_b64_tr_b16 v[98:99], v16 offset:45568
v_mfma_f32_16x16x32_bf16 v[36:39], v[108:111], v[72:75], v[36:39]
ds_read_b64_tr_b16 v[100:101], v17 offset:45056
s_waitcnt lgkmcnt(9)
v_mfma_f32_16x16x32_bf16 v[40:43], v[104:107], v[76:79], v[40:43]
ds_read_b64_tr_b16 v[102:103], v17 offset:45568
ds_read_b128 v[64:67], v15 offset:0
v_mfma_f32_16x16x32_bf16 v[44:47], v[108:111], v[76:79], v[44:47]
ds_read_b128 v[68:71], v15 offset:2048
s_waitcnt lgkmcnt(7)
v_mfma_f32_16x16x32_bf16 v[32:35], v[112:115], v[80:83], v[32:35]
ds_read_b64_tr_b16 v[104:105], v16 offset:32768
ds_read_b64_tr_b16 v[106:107], v16 offset:33280
v_mfma_f32_16x16x32_bf16 v[36:39], v[116:119], v[80:83], v[36:39]
ds_read_b64_tr_b16 v[108:109], v17 offset:32768
s_waitcnt lgkmcnt(9)
v_mfma_f32_16x16x32_bf16 v[40:43], v[112:115], v[84:87], v[40:43]
ds_read_b64_tr_b16 v[110:111], v17 offset:33280
ds_read_b128 v[72:75], v12 offset:8192
v_mfma_f32_16x16x32_bf16 v[44:47], v[116:119], v[84:87], v[44:47]
ds_read_b128 v[76:79], v12 offset:10240
s_waitcnt lgkmcnt(7)
v_mfma_f32_16x16x32_bf16 v[32:35], v[96:99], v[64:67], v[32:35]
ds_read_b64_tr_b16 v[112:113], v16 offset:36864
ds_read_b64_tr_b16 v[114:115], v16 offset:37376
v_mfma_f32_16x16x32_bf16 v[36:39], v[100:103], v[64:67], v[36:39]
ds_read_b64_tr_b16 v[116:117], v17 offset:36864
s_waitcnt lgkmcnt(9)
v_mfma_f32_16x16x32_bf16 v[40:43], v[96:99], v[68:71], v[40:43]
ds_read_b64_tr_b16 v[118:119], v17 offset:37376
ds_read_b128 v[80:83], v13 offset:8192
v_mfma_f32_16x16x32_bf16 v[44:47], v[100:103], v[68:71], v[44:47]
ds_read_b128 v[84:87], v13 offset:10240
s_waitcnt lgkmcnt(7)
v_mfma_f32_16x16x32_bf16 v[32:35], v[104:107], v[72:75], v[32:35]
s_barrier
ds_read_b64_tr_b16 v[96:97], v20 offset:24576
ds_read_b64_tr_b16 v[98:99], v20 offset:25088
v_mfma_f32_16x16x32_bf16 v[36:39], v[108:111], v[72:75], v[36:39]
ds_read_b64_tr_b16 v[100:101], v21 offset:24576
s_waitcnt lgkmcnt(9)
v_mfma_f32_16x16x32_bf16 v[40:43], v[104:107], v[76:79], v[40:43]
ds_read_b64_tr_b16 v[102:103], v21 offset:25088
ds_read_b128 v[64:67], v12 offset:16384
v_mfma_f32_16x16x32_bf16 v[44:47], v[108:111], v[76:79], v[44:47]
ds_read_b128 v[68:71], v12 offset:18432
s_waitcnt lgkmcnt(7)
v_mfma_f32_16x16x32_bf16 v[32:35], v[112:115], v[80:83], v[32:35]
ds_read_b64_tr_b16 v[104:105], v20 offset:28672
ds_read_b64_tr_b16 v[106:107], v20 offset:29184
v_mfma_f32_16x16x32_bf16 v[36:39], v[116:119], v[80:83], v[36:39]
ds_read_b64_tr_b16 v[108:109], v21 offset:28672
s_waitcnt lgkmcnt(9)
v_mfma_f32_16x16x32_bf16 v[40:43], v[112:115], v[84:87], v[40:43]
ds_read_b64_tr_b16 v[110:111], v21 offset:29184
ds_read_b128 v[72:75], v13 offset:16384
v_mfma_f32_16x16x32_bf16 v[44:47], v[116:119], v[84:87], v[44:47]
ds_read_b128 v[76:79], v13 offset:18432
s_waitcnt lgkmcnt(7)
v_mfma_f32_16x16x32_bf16 v[32:35], v[96:99], v[64:67], v[32:35]
ds_read_b64_tr_b16 v[112:113], v20 offset:40960
ds_read_b64_tr_b16 v[114:115], v20 offset:41472
v_mfma_f32_16x16x32_bf16 v[36:39], v[100:103], v[64:67], v[36:39]
ds_read_b64_tr_b16 v[116:117], v21 offset:40960
s_waitcnt lgkmcnt(9)
v_mfma_f32_16x16x32_bf16 v[40:43], v[96:99], v[68:71], v[40:43]
ds_read_b64_tr_b16 v[118:119], v21 offset:41472
ds_read_b128 v[80:83], v14 offset:16384
v_mfma_f32_16x16x32_bf16 v[44:47], v[100:103], v[68:71], v[44:47]
ds_read_b128 v[84:87], v14 offset:18432
s_waitcnt lgkmcnt(7)
v_mfma_f32_16x16x32_bf16 v[32:35], v[104:107], v[72:75], v[32:35]
ds_read_b64_tr_b16 v[96:97], v20 offset:45056
ds_read_b64_tr_b16 v[98:99], v20 offset:45568
v_mfma_f32_16x16x32_bf16 v[36:39], v[108:111], v[72:75], v[36:39]
ds_read_b64_tr_b16 v[100:101], v21 offset:45056
s_waitcnt lgkmcnt(9)
v_mfma_f32_16x16x32_bf16 v[40:43], v[104:107], v[76:79], v[40:43]
ds_read_b64_tr_b16 v[102:103], v21 offset:45568
ds_read_b128 v[64:67], v15 offset:16384
v_mfma_f32_16x16x32_bf16 v[44:47], v[108:111], v[76:79], v[44:47]
ds_read_b128 v[68:71], v15 offset:18432
s_waitcnt lgkmcnt(7)
v_mfma_f32_16x16x32_bf16 v[32:35], v[112:115], v[80:83], v[32:35]
ds_read_b64_tr_b16 v[104:105], v20 offset:32768
ds_read_b64_tr_b16 v[106:107], v20 offset:33280
v_mfma_f32_16x16x32_bf16 v[36:39], v[116:119], v[80:83], v[36:39]
ds_read_b64_tr_b16 v[108:109], v21 offset:32768
s_waitcnt lgkmcnt(9)
v_mfma_f32_16x16x32_bf16 v[40:43], v[112:115], v[84:87], v[40:43]
ds_read_b64_tr_b16 v[110:111], v21 offset:33280
ds_read_b128 v[72:75], v12 offset:24576
v_mfma_f32_16x16x32_bf16 v[44:47], v[116:119], v[84:87], v[44:47]
ds_read_b128 v[76:79], v12 offset:26624
s_waitcnt lgkmcnt(7)
v_mfma_f32_16x16x32_bf16 v[32:35], v[96:99], v[64:67], v[32:35]
ds_read_b64_tr_b16 v[112:113], v20 offset:36864
ds_read_b64_tr_b16 v[114:115], v20 offset:37376
v_mfma_f32_16x16x32_bf16 v[36:39], v[100:103], v[64:67], v[36:39]
ds_read_b64_tr_b16 v[116:117], v21 offset:36864
s_waitcnt lgkmcnt(9)
v_mfma_f32_16x16x32_bf16 v[40:43], v[96:99], v[68:71], v[40:43]
ds_read_b64_tr_b16 v[118:119], v21 offset:37376
ds_read_b128 v[80:83], v13 offset:24576
v_mfma_f32_16x16x32_bf16 v[44:47], v[100:103], v[68:71], v[44:47]
ds_read_b128 v[84:87], v13 offset:26624
s_waitcnt lgkmcnt(7)
v_mfma_f32_16x16x32_bf16 v[32:35], v[104:107], v[72:75], v[32:35]
s_barrier
ds_read_b64_tr_b16 v[96:97], v16 offset:0
ds_read_b64_tr_b16 v[98:99], v16 offset:512
v_mfma_f32_16x16x32_bf16 v[36:39], v[108:111], v[72:75], v[36:39]
ds_read_b64_tr_b16 v[100:101], v17 offset:0
s_waitcnt lgkmcnt(9)
v_mfma_f32_16x16x32_bf16 v[40:43], v[104:107], v[76:79], v[40:43]
ds_read_b64_tr_b16 v[102:103], v17 offset:512
ds_read_b128 v[64:67], v8 offset:24576
v_mfma_f32_16x16x32_bf16 v[44:47], v[108:111], v[76:79], v[44:47]
ds_read_b128 v[68:71], v8 offset:26624
s_waitcnt lgkmcnt(7)
v_mfma_f32_16x16x32_bf16 v[32:35], v[112:115], v[80:83], v[32:35]
ds_read_b64_tr_b16 v[104:105], v16 offset:4096
ds_read_b64_tr_b16 v[106:107], v16 offset:4608
v_mfma_f32_16x16x32_bf16 v[36:39], v[116:119], v[80:83], v[36:39]
ds_read_b64_tr_b16 v[108:109], v17 offset:4096
s_waitcnt lgkmcnt(9)
v_mfma_f32_16x16x32_bf16 v[40:43], v[112:115], v[84:87], v[40:43]
ds_read_b64_tr_b16 v[110:111], v17 offset:4608
ds_read_b128 v[72:75], v9 offset:24576
v_mfma_f32_16x16x32_bf16 v[44:47], v[116:119], v[84:87], v[44:47]
ds_read_b128 v[76:79], v9 offset:26624
s_waitcnt lgkmcnt(7)
v_mfma_f32_16x16x32_bf16 v[32:35], v[96:99], v[64:67], v[32:35]
ds_read_b64_tr_b16 v[112:113], v16 offset:16384
ds_read_b64_tr_b16 v[114:115], v16 offset:16896
v_mfma_f32_16x16x32_bf16 v[36:39], v[100:103], v[64:67], v[36:39]
ds_read_b64_tr_b16 v[116:117], v17 offset:16384
s_waitcnt lgkmcnt(9)
v_mfma_f32_16x16x32_bf16 v[40:43], v[96:99], v[68:71], v[40:43]
ds_read_b64_tr_b16 v[118:119], v17 offset:16896
ds_read_b128 v[80:83], v10 offset:24576
v_mfma_f32_16x16x32_bf16 v[44:47], v[100:103], v[68:71], v[44:47]
ds_read_b128 v[84:87], v10 offset:26624
s_waitcnt lgkmcnt(7)
v_mfma_f32_16x16x32_bf16 v[32:35], v[104:107], v[72:75], v[32:35]
ds_read_b64_tr_b16 v[96:97], v16 offset:20480
ds_read_b64_tr_b16 v[98:99], v16 offset:20992
v_mfma_f32_16x16x32_bf16 v[36:39], v[108:111], v[72:75], v[36:39]
ds_read_b64_tr_b16 v[100:101], v17 offset:20480
s_waitcnt lgkmcnt(9)
v_mfma_f32_16x16x32_bf16 v[40:43], v[104:107], v[76:79], v[40:43]
ds_read_b64_tr_b16 v[102:103], v17 offset:20992
ds_read_b128 v[64:67], v11 offset:24576
v_mfma_f32_16x16x32_bf16 v[44:47], v[108:111], v[76:79], v[44:47]
ds_read_b128 v[68:71], v11 offset:26624
s_waitcnt lgkmcnt(7)
v_mfma_f32_16x16x32_bf16 v[32:35], v[112:115], v[80:83], v[32:35]
ds_read_b64_tr_b16 v[104:105], v16 offset:8192
ds_read_b64_tr_b16 v[106:107], v16 offset:8704
v_mfma_f32_16x16x32_bf16 v[36:39], v[116:119], v[80:83], v[36:39]
ds_read_b64_tr_b16 v[108:109], v17 offset:8192
s_waitcnt lgkmcnt(9)
v_mfma_f32_16x16x32_bf16 v[40:43], v[112:115], v[84:87], v[40:43]
ds_read_b64_tr_b16 v[110:111], v17 offset:8704
ds_read_b128 v[72:75], v8 offset:32768
v_mfma_f32_16x16x32_bf16 v[44:47], v[116:119], v[84:87], v[44:47]
ds_read_b128 v[76:79], v8 offset:34816
s_waitcnt lgkmcnt(7)
v_mfma_f32_16x16x32_bf16 v[32:35], v[96:99], v[64:67], v[32:35]
ds_read_b64_tr_b16 v[112:113], v16 offset:12288
ds_read_b64_tr_b16 v[114:115], v16 offset:12800
v_mfma_f32_16x16x32_bf16 v[36:39], v[100:103], v[64:67], v[36:39]
ds_read_b64_tr_b16 v[116:117], v17 offset:12288
s_waitcnt lgkmcnt(9)
v_mfma_f32_16x16x32_bf16 v[40:43], v[96:99], v[68:71], v[40:43]
ds_read_b64_tr_b16 v[118:119], v17 offset:12800
ds_read_b128 v[80:83], v9 offset:32768
v_mfma_f32_16x16x32_bf16 v[44:47], v[100:103], v[68:71], v[44:47]
ds_read_b128 v[84:87], v9 offset:34816
s_waitcnt lgkmcnt(7)
v_mfma_f32_16x16x32_bf16 v[32:35], v[104:107], v[72:75], v[32:35]
s_barrier
ds_read_b64_tr_b16 v[96:97], v18 offset:0
ds_read_b64_tr_b16 v[98:99], v18 offset:512
v_mfma_f32_16x16x32_bf16 v[36:39], v[108:111], v[72:75], v[36:39]
ds_read_b64_tr_b16 v[100:101], v19 offset:0
s_waitcnt lgkmcnt(9)
v_mfma_f32_16x16x32_bf16 v[40:43], v[104:107], v[76:79], v[40:43]
ds_read_b64_tr_b16 v[102:103], v19 offset:512
ds_read_b128 v[64:67], v8 offset:40960
v_mfma_f32_16x16x32_bf16 v[44:47], v[108:111], v[76:79], v[44:47]
ds_read_b128 v[68:71], v8 offset:43008
s_waitcnt lgkmcnt(7)
v_mfma_f32_16x16x32_bf16 v[32:35], v[112:115], v[80:83], v[32:35]
ds_read_b64_tr_b16 v[104:105], v18 offset:4096
ds_read_b64_tr_b16 v[106:107], v18 offset:4608
v_mfma_f32_16x16x32_bf16 v[36:39], v[116:119], v[80:83], v[36:39]
ds_read_b64_tr_b16 v[108:109], v19 offset:4096
s_waitcnt lgkmcnt(9)
v_mfma_f32_16x16x32_bf16 v[40:43], v[112:115], v[84:87], v[40:43]
ds_read_b64_tr_b16 v[110:111], v19 offset:4608
ds_read_b128 v[72:75], v9 offset:40960
v_mfma_f32_16x16x32_bf16 v[44:47], v[116:119], v[84:87], v[44:47]
ds_read_b128 v[76:79], v9 offset:43008
s_waitcnt lgkmcnt(7)
v_mfma_f32_16x16x32_bf16 v[32:35], v[96:99], v[64:67], v[32:35]
ds_read_b64_tr_b16 v[112:113], v18 offset:16384
ds_read_b64_tr_b16 v[114:115], v18 offset:16896
v_mfma_f32_16x16x32_bf16 v[36:39], v[100:103], v[64:67], v[36:39]
ds_read_b64_tr_b16 v[116:117], v19 offset:16384
s_waitcnt lgkmcnt(9)
v_mfma_f32_16x16x32_bf16 v[40:43], v[96:99], v[68:71], v[40:43]
ds_read_b64_tr_b16 v[118:119], v19 offset:16896
ds_read_b128 v[80:83], v10 offset:40960
v_mfma_f32_16x16x32_bf16 v[44:47], v[100:103], v[68:71], v[44:47]
ds_read_b128 v[84:87], v10 offset:43008
s_waitcnt lgkmcnt(7)
v_mfma_f32_16x16x32_bf16 v[32:35], v[104:107], v[72:75], v[32:35]
ds_read_b64_tr_b16 v[96:97], v18 offset:20480
ds_read_b64_tr_b16 v[98:99], v18 offset:20992
v_mfma_f32_16x16x32_bf16 v[36:39], v[108:111], v[72:75], v[36:39]
ds_read_b64_tr_b16 v[100:101], v19 offset:20480
s_waitcnt lgkmcnt(9)
v_mfma_f32_16x16x32_bf16 v[40:43], v[104:107], v[76:79], v[40:43]
ds_read_b64_tr_b16 v[102:103], v19 offset:20992
ds_read_b128 v[64:67], v11 offset:40960
v_mfma_f32_16x16x32_bf16 v[44:47], v[108:111], v[76:79], v[44:47]
ds_read_b128 v[68:71], v11 offset:43008
s_waitcnt lgkmcnt(7)
v_mfma_f32_16x16x32_bf16 v[32:35], v[112:115], v[80:83], v[32:35]
ds_read_b64_tr_b16 v[104:105], v18 offset:8192
ds_read_b64_tr_b16 v[106:107], v18 offset:8704
v_mfma_f32_16x16x32_bf16 v[36:39], v[116:119], v[80:83], v[36:39]
ds_read_b64_tr_b16 v[108:109], v19 offset:8192
s_waitcnt lgkmcnt(9)
v_mfma_f32_16x16x32_bf16 v[40:43], v[112:115], v[84:87], v[40:43]
ds_read_b64_tr_b16 v[110:111], v19 offset:8704
ds_read_b128 v[72:75], v8 offset:49152
v_mfma_f32_16x16x32_bf16 v[44:47], v[116:119], v[84:87], v[44:47]
ds_read_b128 v[76:79], v8 offset:51200
s_waitcnt lgkmcnt(7)
v_mfma_f32_16x16x32_bf16 v[32:35], v[96:99], v[64:67], v[32:35]
ds_read_b64_tr_b16 v[112:113], v18 offset:12288
ds_read_b64_tr_b16 v[114:115], v18 offset:12800
v_mfma_f32_16x16x32_bf16 v[36:39], v[100:103], v[64:67], v[36:39]
ds_read_b64_tr_b16 v[116:117], v19 offset:12288
s_waitcnt lgkmcnt(9)
v_mfma_f32_16x16x32_bf16 v[40:43], v[96:99], v[68:71], v[40:43]
ds_read_b64_tr_b16 v[118:119], v19 offset:12800
ds_read_b128 v[80:83], v9 offset:49152
v_mfma_f32_16x16x32_bf16 v[44:47], v[100:103], v[68:71], v[44:47]
ds_read_b128 v[84:87], v9 offset:51200
s_waitcnt lgkmcnt(7)
v_mfma_f32_16x16x32_bf16 v[32:35], v[104:107], v[72:75], v[32:35]
s_barrier
ds_read_b64_tr_b16 v[96:97], v16 offset:24576
ds_read_b64_tr_b16 v[98:99], v16 offset:25088
v_mfma_f32_16x16x32_bf16 v[36:39], v[108:111], v[72:75], v[36:39]
ds_read_b64_tr_b16 v[100:101], v17 offset:24576
s_waitcnt lgkmcnt(9)
v_mfma_f32_16x16x32_bf16 v[40:43], v[104:107], v[76:79], v[40:43]
ds_read_b64_tr_b16 v[102:103], v17 offset:25088
ds_read_b128 v[64:67], v12 offset:0
v_mfma_f32_16x16x32_bf16 v[44:47], v[108:111], v[76:79], v[44:47]
ds_read_b128 v[68:71], v12 offset:2048
s_waitcnt lgkmcnt(7)
v_mfma_f32_16x16x32_bf16 v[32:35], v[112:115], v[80:83], v[32:35]
ds_read_b64_tr_b16 v[104:105], v16 offset:28672
ds_read_b64_tr_b16 v[106:107], v16 offset:29184
v_mfma_f32_16x16x32_bf16 v[36:39], v[116:119], v[80:83], v[36:39]
ds_read_b64_tr_b16 v[108:109], v17 offset:28672
s_waitcnt lgkmcnt(9)
v_mfma_f32_16x16x32_bf16 v[40:43], v[112:115], v[84:87], v[40:43]
ds_read_b64_tr_b16 v[110:111], v17 offset:29184
ds_read_b128 v[72:75], v13 offset:0
v_mfma_f32_16x16x32_bf16 v[44:47], v[116:119], v[84:87], v[44:47]
ds_read_b128 v[76:79], v13 offset:2048
s_waitcnt lgkmcnt(7)
v_mfma_f32_16x16x32_bf16 v[32:35], v[96:99], v[64:67], v[32:35]
ds_read_b64_tr_b16 v[112:113], v16 offset:40960
ds_read_b64_tr_b16 v[114:115], v16 offset:41472
v_mfma_f32_16x16x32_bf16 v[36:39], v[100:103], v[64:67], v[36:39]
ds_read_b64_tr_b16 v[116:117], v17 offset:40960
s_waitcnt lgkmcnt(9)
v_mfma_f32_16x16x32_bf16 v[40:43], v[96:99], v[68:71], v[40:43]
ds_read_b64_tr_b16 v[118:119], v17 offset:41472
ds_read_b128 v[80:83], v14 offset:0
v_mfma_f32_16x16x32_bf16 v[44:47], v[100:103], v[68:71], v[44:47]
ds_read_b128 v[84:87], v14 offset:2048
s_waitcnt lgkmcnt(7)
v_mfma_f32_16x16x32_bf16 v[32:35], v[104:107], v[72:75], v[32:35]
ds_read_b64_tr_b16 v[96:97], v16 offset:45056
ds_read_b64_tr_b16 v[98:99], v16 offset:45568
v_mfma_f32_16x16x32_bf16 v[36:39], v[108:111], v[72:75], v[36:39]
ds_read_b64_tr_b16 v[100:101], v17 offset:45056
s_waitcnt lgkmcnt(9)
v_mfma_f32_16x16x32_bf16 v[40:43], v[104:107], v[76:79], v[40:43]
ds_read_b64_tr_b16 v[102:103], v17 offset:45568
ds_read_b128 v[64:67], v15 offset:0
v_mfma_f32_16x16x32_bf16 v[44:47], v[108:111], v[76:79], v[44:47]
ds_read_b128 v[68:71], v15 offset:2048
s_waitcnt lgkmcnt(7)
v_mfma_f32_16x16x32_bf16 v[32:35], v[112:115], v[80:83], v[32:35]
ds_read_b64_tr_b16 v[104:105], v16 offset:32768
ds_read_b64_tr_b16 v[106:107], v16 offset:33280
v_mfma_f32_16x16x32_bf16 v[36:39], v[116:119], v[80:83], v[36:39]
ds_read_b64_tr_b16 v[108:109], v17 offset:32768
s_waitcnt lgkmcnt(9)
v_mfma_f32_16x16x32_bf16 v[40:43], v[112:115], v[84:87], v[40:43]
ds_read_b64_tr_b16 v[110:111], v17 offset:33280
ds_read_b128 v[72:75], v12 offset:8192
v_mfma_f32_16x16x32_bf16 v[44:47], v[116:119], v[84:87], v[44:47]
ds_read_b128 v[76:79], v12 offset:10240
s_waitcnt lgkmcnt(7)
v_mfma_f32_16x16x32_bf16 v[32:35], v[96:99], v[64:67], v[32:35]
ds_read_b64_tr_b16 v[112:113], v16 offset:36864
ds_read_b64_tr_b16 v[114:115], v16 offset:37376
v_mfma_f32_16x16x32_bf16 v[36:39], v[100:103], v[64:67], v[36:39]
ds_read_b64_tr_b16 v[116:117], v17 offset:36864
s_waitcnt lgkmcnt(9)
v_mfma_f32_16x16x32_bf16 v[40:43], v[96:99], v[68:71], v[40:43]
ds_read_b64_tr_b16 v[118:119], v17 offset:37376
ds_read_b128 v[80:83], v13 offset:8192
v_mfma_f32_16x16x32_bf16 v[44:47], v[100:103], v[68:71], v[44:47]
ds_read_b128 v[84:87], v13 offset:10240
s_waitcnt lgkmcnt(7)
v_mfma_f32_16x16x32_bf16 v[32:35], v[104:107], v[72:75], v[32:35]
v_mfma_f32_16x16x32_bf16 v[36:39], v[108:111], v[72:75], v[36:39]
s_waitcnt lgkmcnt(6)
v_mfma_f32_16x16x32_bf16 v[40:43], v[104:107], v[76:79], v[40:43]
v_mfma_f32_16x16x32_bf16 v[44:47], v[108:111], v[76:79], v[44:47]
s_waitcnt lgkmcnt(1)
v_mfma_f32_16x16x32_bf16 v[32:35], v[112:115], v[80:83], v[32:35]
v_mfma_f32_16x16x32_bf16 v[36:39], v[116:119], v[80:83], v[36:39]
s_waitcnt lgkmcnt(0)
v_mfma_f32_16x16x32_bf16 v[40:43], v[112:115], v[84:87], v[40:43]
v_mfma_f32_16x16x32_bf16 v[44:47], v[116:119], v[84:87], v[44:47]
v_and_b32 v26, 15, v0
    v_lshrrev_b32 v27, 4, v0
    v_lshlrev_b32 v13, 8, v26
    v_lshl_add_u32 v13, v27, 4, v13
    s_lshl_b32 s3, s5, 11
    s_lshl_b32 s52, s4, 6
    s_add_u32 s3, s3, s52
    v_add_u32 v13, s3, v13
    v_lshlrev_b32 v28, 4, v26
    v_lshl_add_u32 v28, v27, 8, v28
    s_lshl_b32 s3, s5, 2
    s_add_u32 s3, s3, s4
    s_lshl_b32 s3, s3, 13
    s_lshl_b32 s52, s49, 7
    s_add_u32 s3, s3, s52
    s_add_u32 s3, s3, 524288
    s_add_u32 s52, s3, 4096
    s_mov_b32 exec_lo, 0x00ff00ff
    s_mov_b32 exec_hi, 0x00ff00ff
buffer_load_dwordx4 v[64:67], v28, s[92:95], s3 offen offset:0 sc1
buffer_load_dwordx4 v[68:71], v28, s[92:95], s3 offen offset:1024 sc1
buffer_load_dwordx4 v[72:75], v28, s[92:95], s3 offen offset:2048 sc1
buffer_load_dwordx4 v[76:79], v28, s[92:95], s3 offen offset:3072 sc1
buffer_load_dwordx4 v[80:83], v28, s[92:95], s52 offen offset:0 sc1
buffer_load_dwordx4 v[84:87], v28, s[92:95], s52 offen offset:1024 sc1
buffer_load_dwordx4 v[88:91], v28, s[92:95], s52 offen offset:2048 sc1
buffer_load_dwordx4 v[92:95], v28, s[92:95], s52 offen offset:3072 sc1
s_mov_b64 exec, -1
v_pk_mul_f32 v[96:97], v[32:33], v[32:33]
v_pk_mul_f32 v[98:99], v[34:35], v[34:35]
v_pk_mul_f32 v[100:101], v[36:37], v[36:37]
v_pk_mul_f32 v[102:103], v[38:39], v[38:39]
v_pk_fma_f32 v[96:97], v[96:97], s[60:61], v[24:25]
v_pk_fma_f32 v[98:99], v[98:99], s[60:61], v[24:25]
v_pk_fma_f32 v[100:101], v[100:101], s[60:61], v[24:25]
v_pk_fma_f32 v[102:103], v[102:103], s[60:61], v[24:25]
v_pk_mul_f32 v[96:97], v[96:97], v[32:33]
v_pk_mul_f32 v[98:99], v[98:99], v[34:35]
v_pk_mul_f32 v[100:101], v[100:101], v[36:37]
v_pk_mul_f32 v[102:103], v[102:103], v[38:39]
v_exp_f32 v96, v96
v_exp_f32 v97, v97
v_exp_f32 v98, v98
v_exp_f32 v99, v99
v_exp_f32 v100, v100
v_exp_f32 v101, v101
v_exp_f32 v102, v102
v_exp_f32 v103, v103
v_pk_add_f32 v[96:97], v[96:97], 1.0 op_sel_hi:[1,0]
v_pk_add_f32 v[98:99], v[98:99], 1.0 op_sel_hi:[1,0]
v_pk_add_f32 v[100:101], v[100:101], 1.0 op_sel_hi:[1,0]
v_pk_add_f32 v[102:103], v[102:103], 1.0 op_sel_hi:[1,0]
v_rcp_f32 v96, v96
v_rcp_f32 v97, v97
v_rcp_f32 v98, v98
v_rcp_f32 v99, v99
v_rcp_f32 v100, v100
v_rcp_f32 v101, v101
v_rcp_f32 v102, v102
v_rcp_f32 v103, v103
v_pk_mul_f32 v[96:97], v[96:97], v[32:33]
v_pk_mul_f32 v[98:99], v[98:99], v[34:35]
v_pk_mul_f32 v[100:101], v[100:101], v[36:37]
v_pk_mul_f32 v[102:103], v[102:103], v[38:39]
v_cvt_pk_bf16_f32 v120, v96, v97
v_cvt_pk_bf16_f32 v121, v98, v99
v_cvt_pk_bf16_f32 v122, v100, v101
v_cvt_pk_bf16_f32 v123, v102, v103
s_nop 1
v_permlane16_swap_b32 v120, v122
v_permlane16_swap_b32 v121, v123
s_lshr_b32 s52, s4, 1
s_lshl_b32 s52, s52, 12
s_add_u32 s52, s52, 131072
s_cmp_eq_u32 s63, 0
s_cbranch_scc1 L_xs_24
buffer_store_dwordx4 v[120:123], v22, s[40:43], s52 offen offset:0
L_xd_25:
v_pk_mul_f32 v[96:97], v[40:41], v[40:41]
v_pk_mul_f32 v[98:99], v[42:43], v[42:43]
v_pk_mul_f32 v[100:101], v[44:45], v[44:45]
v_pk_mul_f32 v[102:103], v[46:47], v[46:47]
v_pk_fma_f32 v[96:97], v[96:97], s[60:61], v[24:25]
v_pk_fma_f32 v[98:99], v[98:99], s[60:61], v[24:25]
v_pk_fma_f32 v[100:101], v[100:101], s[60:61], v[24:25]
v_pk_fma_f32 v[102:103], v[102:103], s[60:61], v[24:25]
v_pk_mul_f32 v[96:97], v[96:97], v[40:41]
v_pk_mul_f32 v[98:99], v[98:99], v[42:43]
v_pk_mul_f32 v[100:101], v[100:101], v[44:45]
v_pk_mul_f32 v[102:103], v[102:103], v[46:47]
v_exp_f32 v96, v96
v_exp_f32 v97, v97
v_exp_f32 v98, v98
v_exp_f32 v99, v99
v_exp_f32 v100, v100
v_exp_f32 v101, v101
v_exp_f32 v102, v102
v_exp_f32 v103, v103
v_pk_add_f32 v[96:97], v[96:97], 1.0 op_sel_hi:[1,0]
v_pk_add_f32 v[98:99], v[98:99], 1.0 op_sel_hi:[1,0]
v_pk_add_f32 v[100:101], v[100:101], 1.0 op_sel_hi:[1,0]
v_pk_add_f32 v[102:103], v[102:103], 1.0 op_sel_hi:[1,0]
v_rcp_f32 v96, v96
v_rcp_f32 v97, v97
v_rcp_f32 v98, v98
v_rcp_f32 v99, v99
v_rcp_f32 v100, v100
v_rcp_f32 v101, v101
v_rcp_f32 v102, v102
v_rcp_f32 v103, v103
v_pk_mul_f32 v[96:97], v[96:97], v[40:41]
v_pk_mul_f32 v[98:99], v[98:99], v[42:43]
v_pk_mul_f32 v[100:101], v[100:101], v[44:45]
v_pk_mul_f32 v[102:103], v[102:103], v[46:47]
v_cvt_pk_bf16_f32 v124, v96, v97
v_cvt_pk_bf16_f32 v125, v98, v99
v_cvt_pk_bf16_f32 v126, v100, v101
v_cvt_pk_bf16_f32 v127, v102, v103
s_nop 1
v_permlane16_swap_b32 v124, v126
v_permlane16_swap_b32 v125, v127
s_lshr_b32 s52, s4, 1
s_lshl_b32 s52, s52, 12
s_add_u32 s52, s52, 133120
s_cmp_eq_u32 s63, 0
s_cbranch_scc1 L_xs_26
buffer_store_dwordx4 v[124:127], v22, s[40:43], s52 offen offset:0
L_xd_27:
s_lshr_b32 s52, s4, 1
s_lshl_b32 s52, s52, 12
s_add_u32 s52, s52, 73728
v_and_b32 v30, 0x1fff, v22
v_add_u32 v30, s52, v30
ds_write_b128 v30, v[120:123] offset:0
ds_write_b128 v30, v[124:127] offset:2048
s_waitcnt vmcnt(1)
s_mov_b64 exec, 1
s_cmp_eq_u32 s63, 0
s_cbranch_scc1 L_xs_28
buffer_store_dword v3, v2, s[40:43], 0 offen offset:128
L_xd_29:
s_mov_b64 exec, -1
s_waitcnt lgkmcnt(0)
s_barrier
v_pk_add_f32 v[64:65], v[64:65], v[68:69]
v_pk_add_f32 v[66:67], v[66:67], v[70:71]
v_pk_add_f32 v[72:73], v[72:73], v[76:77]
v_pk_add_f32 v[74:75], v[74:75], v[78:79]
v_pk_add_f32 v[80:81], v[80:81], v[84:85]
v_pk_add_f32 v[82:83], v[82:83], v[86:87]
v_pk_add_f32 v[88:89], v[88:89], v[92:93]
v_pk_add_f32 v[90:91], v[90:91], v[94:95]
v_pk_add_f32 v[64:65], v[64:65], v[72:73]
v_pk_add_f32 v[66:67], v[66:67], v[74:75]
v_pk_add_f32 v[80:81], v[80:81], v[88:89]
v_pk_add_f32 v[82:83], v[82:83], v[90:91]
v_pk_add_f32 v[64:65], v[64:65], v[80:81]
v_pk_add_f32 v[66:67], v[66:67], v[82:83]
s_waitcnt vmcnt(1)
s_mov_b64 exec, 1
s_cmp_eq_u32 s63, 0
s_cbranch_scc1 L_xs_30
buffer_store_dword v3, v2, s[40:43], 0 offen offset:512
L_xd_31:
s_mov_b64 exec, -1
v_cvt_pk_bf16_f32 v36, v64, v65
    v_cvt_pk_bf16_f32 v37, v66, v67
    v_lshlrev_b32 v32, 16, v36
    v_and_b32 v33, 0xffff0000, v36
    v_lshlrev_b32 v34, 16, v37
    v_and_b32 v35, 0xffff0000, v37
    s_mov_b32 exec_lo, 0x00ff00ff
    s_mov_b32 exec_hi, 0x00ff00ff
v_max3_f32 v14, abs(v32), abs(v33), abs(v34)
v_max_f32 v14, abs(v35), v14
v_cmp_lt_f32 vcc, 0x421c0000, v14
s_cmp_lg_u64 vcc, 0
s_cselect_b32 s3, 3, 1
v_mov_b32 v14, s3
v_mul_f32 v32, s62, v32
v_mul_f32 v33, s62, v33
v_mul_f32 v34, s62, v34
v_mul_f32 v35, s62, v35
v_exp_f32 v40, v32
v_exp_f32 v41, v33
v_exp_f32 v42, v34
v_exp_f32 v43, v35
s_mov_b32 s52, 262144
s_mov_b32 s53, 278528
s_cmp_eq_u32 s63, 0
s_cbranch_scc1 L_xs_32
buffer_store_dwordx4 v[40:43], v13, s[40:43], s52 offen
buffer_store_dwordx4 v[32:35], v13, s[40:43], s53 offen
L_xd_33:
s_mov_b64 exec, -1
s_lshr_b32 s52, s4, 1
s_lshl_b32 s53, s52, 12
v_and_b32 v26, 15, v0
v_and_b32 v27, 6, v26
    v_lshrrev_b32 v30, 4, v0
    v_xor_b32 v27, v27, v30
    v_lshlrev_b32 v27, 4, v27
    v_lshl_add_u32 v27, v26, 7, v27
    v_add_u32 v8, s53, v27
v_xor_b32 v9, 64, v8
v_add_u32 v10, 49152, v8
v_add_u32 v11, 49152, v9
ds_read_b64_tr_b16 a[0:1], v20 offset:24576
ds_read_b64_tr_b16 a[2:3], v20 offset:25088
ds_read_b64_tr_b16 a[4:5], v21 offset:24576
ds_read_b64_tr_b16 a[6:7], v21 offset:25088
ds_read_b64_tr_b16 a[8:9], v20 offset:28672
ds_read_b64_tr_b16 a[10:11], v20 offset:29184
ds_read_b64_tr_b16 a[12:13], v21 offset:28672
ds_read_b64_tr_b16 a[14:15], v21 offset:29184
s_waitcnt lgkmcnt(4)
ds_read_b64_tr_b16 a[16:17], v20 offset:32768
ds_read_b64_tr_b16 a[18:19], v20 offset:33280
ds_read_b64_tr_b16 a[20:21], v21 offset:32768
ds_read_b64_tr_b16 a[22:23], v21 offset:33280
ds_read_b64_tr_b16 a[24:25], v20 offset:36864
ds_read_b64_tr_b16 a[26:27], v20 offset:37376
ds_read_b64_tr_b16 a[28:29], v21 offset:36864
ds_read_b64_tr_b16 a[30:31], v21 offset:37376
s_waitcnt lgkmcnt(4)
ds_read_b64_tr_b16 a[32:33], v20 offset:40960
ds_read_b64_tr_b16 a[34:35], v20 offset:41472
ds_read_b64_tr_b16 a[36:37], v21 offset:40960
ds_read_b64_tr_b16 a[38:39], v21 offset:41472
ds_read_b64_tr_b16 a[40:41], v20 offset:45056
ds_read_b64_tr_b16 a[42:43], v20 offset:45568
ds_read_b64_tr_b16 a[44:45], v21 offset:45056
ds_read_b64_tr_b16 a[46:47], v21 offset:45568
s_waitcnt lgkmcnt(4)
ds_read_b64_tr_b16 a[48:49], v20 offset:8192
ds_read_b64_tr_b16 a[50:51], v20 offset:8704
ds_read_b64_tr_b16 a[52:53], v21 offset:8192
ds_read_b64_tr_b16 a[54:55], v21 offset:8704
ds_read_b64_tr_b16 a[56:57], v20 offset:12288
ds_read_b64_tr_b16 a[58:59], v20 offset:12800
ds_read_b64_tr_b16 a[60:61], v21 offset:12288
ds_read_b64_tr_b16 a[62:63], v21 offset:12800
s_waitcnt lgkmcnt(4)
ds_read_b64_tr_b16 a[64:65], v20 offset:16384
ds_read_b64_tr_b16 a[66:67], v20 offset:16896
ds_read_b64_tr_b16 a[68:69], v21 offset:16384
ds_read_b64_tr_b16 a[70:71], v21 offset:16896
ds_read_b64_tr_b16 a[72:73], v20 offset:20480
ds_read_b64_tr_b16 a[74:75], v20 offset:20992
ds_read_b64_tr_b16 a[76:77], v21 offset:20480
ds_read_b64_tr_b16 a[78:79], v21 offset:20992
s_waitcnt lgkmcnt(4)
ds_read_b64_tr_b16 a[80:81], v16 offset:0
ds_read_b64_tr_b16 a[82:83], v16 offset:512
ds_read_b64_tr_b16 a[84:85], v17 offset:0
ds_read_b64_tr_b16 a[86:87], v17 offset:512
ds_read_b64_tr_b16 a[88:89], v16 offset:4096
ds_read_b64_tr_b16 a[90:91], v16 offset:4608
ds_read_b64_tr_b16 a[92:93], v17 offset:4096
ds_read_b64_tr_b16 a[94:95], v17 offset:4608
s_waitcnt lgkmcnt(4)
ds_read_b64_tr_b16 a[96:97], v16 offset:8192
ds_read_b64_tr_b16 a[98:99], v16 offset:8704
ds_read_b64_tr_b16 a[100:101], v17 offset:8192
ds_read_b64_tr_b16 a[102:103], v17 offset:8704
ds_read_b64_tr_b16 a[104:105], v16 offset:12288
ds_read_b64_tr_b16 a[106:107], v16 offset:12800
ds_read_b64_tr_b16 a[108:109], v17 offset:12288
ds_read_b64_tr_b16 a[110:111], v17 offset:12800
s_waitcnt lgkmcnt(4)
ds_read_b64_tr_b16 a[112:113], v16 offset:16384
ds_read_b64_tr_b16 a[114:115], v16 offset:16896
ds_read_b64_tr_b16 a[116:117], v17 offset:16384
ds_read_b64_tr_b16 a[118:119], v17 offset:16896
ds_read_b64_tr_b16 a[120:121], v16 offset:20480
ds_read_b64_tr_b16 a[122:123], v16 offset:20992
ds_read_b64_tr_b16 a[124:125], v17 offset:20480
ds_read_b64_tr_b16 a[126:127], v17 offset:20992
s_waitcnt lgkmcnt(4)
s_waitcnt lgkmcnt(0)
ds_read_b128 v[64:67], v10 offset:24576
ds_read_b128 v[68:71], v11 offset:24576
s_barrier
s_waitcnt vmcnt(0)
s_mov_b64 exec, 1
s_cmp_eq_u32 s63, 0
s_cbranch_scc1 L_xs_34
buffer_store_dword v14, v2, s[40:43], 0 offen offset:384
L_xd_35:
s_mov_b64 exec, -1
ds_read_b128 v[72:75], v8 offset:24576
ds_read_b128 v[76:79], v9 offset:24576
s_waitcnt lgkmcnt(3)
v_mfma_f32_16x16x32_bf16 v[32:35], a[0:3], v[64:67], 0
ds_read_b128 v[80:83], v8 offset:32768
v_mfma_f32_16x16x32_bf16 v[36:39], a[4:7], v[64:67], 0
s_waitcnt lgkmcnt(3)
v_mfma_f32_16x16x32_bf16 v[32:35], a[8:11], v[68:71], v[32:35]
ds_read_b128 v[84:87], v9 offset:32768
v_mfma_f32_16x16x32_bf16 v[36:39], a[12:15], v[68:71], v[36:39]
s_waitcnt lgkmcnt(3)
v_mfma_f32_16x16x32_bf16 v[32:35], a[16:19], v[72:75], v[32:35]
ds_read_b128 v[64:67], v8 offset:40960
v_mfma_f32_16x16x32_bf16 v[36:39], a[20:23], v[72:75], v[36:39]
s_waitcnt lgkmcnt(3)
v_mfma_f32_16x16x32_bf16 v[32:35], a[24:27], v[76:79], v[32:35]
ds_read_b128 v[68:71], v9 offset:40960
v_mfma_f32_16x16x32_bf16 v[36:39], a[28:31], v[76:79], v[36:39]
s_waitcnt lgkmcnt(3)
v_mfma_f32_16x16x32_bf16 v[32:35], a[32:35], v[80:83], v[32:35]
s_barrier
ds_read_b128 v[72:75], v10 offset:0
v_mfma_f32_16x16x32_bf16 v[36:39], a[36:39], v[80:83], v[36:39]
s_waitcnt lgkmcnt(3)
v_mfma_f32_16x16x32_bf16 v[32:35], a[40:43], v[84:87], v[32:35]
ds_read_b128 v[76:79], v11 offset:0
v_mfma_f32_16x16x32_bf16 v[36:39], a[44:47], v[84:87], v[36:39]
s_waitcnt lgkmcnt(3)
v_mfma_f32_16x16x32_bf16 v[32:35], a[48:51], v[64:67], v[32:35]
ds_read_b128 v[80:83], v10 offset:8192
v_mfma_f32_16x16x32_bf16 v[36:39], a[52:55], v[64:67], v[36:39]
s_waitcnt lgkmcnt(3)
v_mfma_f32_16x16x32_bf16 v[32:35], a[56:59], v[68:71], v[32:35]
ds_read_b128 v[84:87], v11 offset:8192
v_mfma_f32_16x16x32_bf16 v[36:39], a[60:63], v[68:71], v[36:39]
s_waitcnt lgkmcnt(3)
v_mfma_f32_16x16x32_bf16 v[32:35], a[64:67], v[72:75], v[32:35]
ds_read_b128 v[64:67], v10 offset:16384
v_mfma_f32_16x16x32_bf16 v[36:39], a[68:71], v[72:75], v[36:39]
s_waitcnt lgkmcnt(3)
v_mfma_f32_16x16x32_bf16 v[32:35], a[72:75], v[76:79], v[32:35]
ds_read_b128 v[68:71], v11 offset:16384
v_mfma_f32_16x16x32_bf16 v[36:39], a[76:79], v[76:79], v[36:39]
s_waitcnt lgkmcnt(3)
v_mfma_f32_16x16x32_bf16 v[32:35], a[80:83], v[80:83], v[32:35]
ds_read_b128 v[72:75], v10 offset:40960
v_mfma_f32_16x16x32_bf16 v[36:39], a[84:87], v[80:83], v[36:39]
s_waitcnt lgkmcnt(3)
v_mfma_f32_16x16x32_bf16 v[32:35], a[88:91], v[84:87], v[32:35]
ds_read_b128 v[76:79], v11 offset:40960
v_mfma_f32_16x16x32_bf16 v[36:39], a[92:95], v[84:87], v[36:39]
s_waitcnt lgkmcnt(3)
v_mfma_f32_16x16x32_bf16 v[32:35], a[96:99], v[64:67], v[32:35]
v_mfma_f32_16x16x32_bf16 v[36:39], a[100:103], v[64:67], v[36:39]
s_waitcnt lgkmcnt(2)
v_mfma_f32_16x16x32_bf16 v[32:35], a[104:107], v[68:71], v[32:35]
v_mfma_f32_16x16x32_bf16 v[36:39], a[108:111], v[68:71], v[36:39]
s_waitcnt lgkmcnt(1)
v_mfma_f32_16x16x32_bf16 v[32:35], a[112:115], v[72:75], v[32:35]
v_mfma_f32_16x16x32_bf16 v[36:39], a[116:119], v[72:75], v[36:39]
s_waitcnt lgkmcnt(0)
v_mfma_f32_16x16x32_bf16 v[32:35], a[120:123], v[76:79], v[32:35]
v_mfma_f32_16x16x32_bf16 v[36:39], a[124:127], v[76:79], v[36:39]
s_nop 7
v_cvt_pk_bf16_f32 v120, v32, v33
v_cvt_pk_bf16_f32 v121, v34, v35
v_cvt_pk_bf16_f32 v122, v36, v37
v_cvt_pk_bf16_f32 v123, v38, v39
s_nop 1
v_permlane16_swap_b32 v120, v122
v_permlane16_swap_b32 v121, v123
s_lshr_b32 s52, s4, 1
s_lshl_b32 s52, s52, 12
s_add_u32 s52, s52, s99
s_cmp_eq_u32 s63, 0
s_cbranch_scc1 L_xs_36
buffer_store_dwordx4 v[120:123], v23, s[40:43], s52 offen offset:0
L_xd_37:
v_max3_f32 v12, abs(v32), abs(v33), abs(v34)
v_max3_f32 v12, abs(v35), abs(v36), v12
v_max3_f32 v12, abs(v37), abs(v38), v12
v_max_f32 v12, abs(v39), v12
v_cmp_lt_f32 vcc, 0x421c0000, v12
s_cmp_lg_u64 vcc, 0
s_cselect_b32 s3, 3, 1
v_mov_b32 v12, s3
ds_read_b128 v[64:67], v10 offset:26624
ds_read_b128 v[68:71], v11 offset:26624
s_barrier
ds_read_b128 v[72:75], v8 offset:26624
ds_read_b128 v[76:79], v9 offset:26624
s_waitcnt lgkmcnt(3)
v_mfma_f32_16x16x32_bf16 v[40:43], a[0:3], v[64:67], 0
ds_read_b128 v[80:83], v8 offset:34816
v_mfma_f32_16x16x32_bf16 v[44:47], a[4:7], v[64:67], 0
s_waitcnt lgkmcnt(3)
v_mfma_f32_16x16x32_bf16 v[40:43], a[8:11], v[68:71], v[40:43]
ds_read_b128 v[84:87], v9 offset:34816
v_mfma_f32_16x16x32_bf16 v[44:47], a[12:15], v[68:71], v[44:47]
s_waitcnt lgkmcnt(3)
v_mfma_f32_16x16x32_bf16 v[40:43], a[16:19], v[72:75], v[40:43]
ds_read_b128 v[64:67], v8 offset:43008
v_mfma_f32_16x16x32_bf16 v[44:47], a[20:23], v[72:75], v[44:47]
s_waitcnt lgkmcnt(3)
v_mfma_f32_16x16x32_bf16 v[40:43], a[24:27], v[76:79], v[40:43]
ds_read_b128 v[68:71], v9 offset:43008
v_mfma_f32_16x16x32_bf16 v[44:47], a[28:31], v[76:79], v[44:47]
s_waitcnt lgkmcnt(3)
v_mfma_f32_16x16x32_bf16 v[40:43], a[32:35], v[80:83], v[40:43]
ds_read_b128 v[72:75], v10 offset:2048
v_mfma_f32_16x16x32_bf16 v[44:47], a[36:39], v[80:83], v[44:47]
s_waitcnt lgkmcnt(3)
v_mfma_f32_16x16x32_bf16 v[40:43], a[40:43], v[84:87], v[40:43]
ds_read_b128 v[76:79], v11 offset:2048
v_mfma_f32_16x16x32_bf16 v[44:47], a[44:47], v[84:87], v[44:47]
s_waitcnt lgkmcnt(3)
v_mfma_f32_16x16x32_bf16 v[40:43], a[48:51], v[64:67], v[40:43]
ds_read_b128 v[80:83], v10 offset:10240
v_mfma_f32_16x16x32_bf16 v[44:47], a[52:55], v[64:67], v[44:47]
s_waitcnt lgkmcnt(3)
v_mfma_f32_16x16x32_bf16 v[40:43], a[56:59], v[68:71], v[40:43]
ds_read_b128 v[84:87], v11 offset:10240
v_mfma_f32_16x16x32_bf16 v[44:47], a[60:63], v[68:71], v[44:47]
s_waitcnt lgkmcnt(3)
v_mfma_f32_16x16x32_bf16 v[40:43], a[64:67], v[72:75], v[40:43]
ds_read_b128 v[64:67], v10 offset:18432
v_mfma_f32_16x16x32_bf16 v[44:47], a[68:71], v[72:75], v[44:47]
s_waitcnt lgkmcnt(3)
v_mfma_f32_16x16x32_bf16 v[40:43], a[72:75], v[76:79], v[40:43]
ds_read_b128 v[68:71], v11 offset:18432
v_mfma_f32_16x16x32_bf16 v[44:47], a[76:79], v[76:79], v[44:47]
s_waitcnt vmcnt(0)
s_mov_b64 exec, 1
s_cmp_eq_u32 s63, 0
s_cbranch_scc1 L_xs_38
buffer_store_dword v12, v2, s[40:43], 0 offen offset:256
L_xd_39:
s_mov_b64 exec, -1
s_waitcnt lgkmcnt(3)
v_mfma_f32_16x16x32_bf16 v[40:43], a[80:83], v[80:83], v[40:43]
ds_read_b128 v[72:75], v10 offset:43008
v_mfma_f32_16x16x32_bf16 v[44:47], a[84:87], v[80:83], v[44:47]
s_waitcnt lgkmcnt(3)
v_mfma_f32_16x16x32_bf16 v[40:43], a[88:91], v[84:87], v[40:43]
ds_read_b128 v[76:79], v11 offset:43008
v_mfma_f32_16x16x32_bf16 v[44:47], a[92:95], v[84:87], v[44:47]
s_waitcnt lgkmcnt(3)
v_mfma_f32_16x16x32_bf16 v[40:43], a[96:99], v[64:67], v[40:43]
v_mfma_f32_16x16x32_bf16 v[44:47], a[100:103], v[64:67], v[44:47]
s_waitcnt lgkmcnt(2)
v_mfma_f32_16x16x32_bf16 v[40:43], a[104:107], v[68:71], v[40:43]
v_mfma_f32_16x16x32_bf16 v[44:47], a[108:111], v[68:71], v[44:47]
s_waitcnt lgkmcnt(1)
v_mfma_f32_16x16x32_bf16 v[40:43], a[112:115], v[72:75], v[40:43]
v_mfma_f32_16x16x32_bf16 v[44:47], a[116:119], v[72:75], v[44:47]
s_waitcnt lgkmcnt(0)
v_mfma_f32_16x16x32_bf16 v[40:43], a[120:123], v[76:79], v[40:43]
v_mfma_f32_16x16x32_bf16 v[44:47], a[124:127], v[76:79], v[44:47]
s_nop 7
v_cvt_pk_bf16_f32 v124, v40, v41
v_cvt_pk_bf16_f32 v125, v42, v43
v_cvt_pk_bf16_f32 v126, v44, v45
v_cvt_pk_bf16_f32 v127, v46, v47
s_nop 1
v_permlane16_swap_b32 v124, v126
v_permlane16_swap_b32 v125, v127
s_lshr_b32 s52, s4, 1
s_lshl_b32 s52, s52, 12
s_add_u32 s52, s52, s99
s_cmp_eq_u32 s63, 0
s_cbranch_scc1 L_xs_40
buffer_store_dwordx4 v[124:127], v23, s[40:43], s52 offen offset:2048
L_xd_41:
v_max3_f32 v29, abs(v40), abs(v41), abs(v42)
v_max3_f32 v29, abs(v43), abs(v44), v29
v_max3_f32 v29, abs(v45), abs(v46), v29
v_max_f32 v29, abs(v47), v29
v_cmp_lt_f32 vcc, 0x421c0000, v29
s_cmp_lg_u64 vcc, 0
s_cselect_b32 s3, 3, 1
v_mov_b32 v29, s3
v_mov_b32 v15, v2
    v_and_b32 v1, 31, v0
    v_mul_u32_u24 v1, 1040, v1
    v_lshrrev_b32 v2, 5, v0
    v_lshl_add_u32 v1, v2, 4, v1
    s_and_b32 s53, s5, 1
    s_lshl_b32 s3, s53, 3
    s_add_u32 s3, s3, s4
    s_lshl_b32 s3, s3, 15
    v_lshlrev_b32 v12, 4, v0
    v_add_u32 v12, s3, v12
    s_lshl_b32 s53, s53, 9
    v_mov_b32 v11, 8320
    v_lshrrev_b32 v8, 4, v0
    v_and_b32 v9, 15, v0
    s_lshl_b32 s3, s4, 7
    v_lshl_add_u32 v10, v9, 3, s3
    s_lshl_b32 s52, s4, 11
    v_lshl_add_u32 v13, v9, 4, s52
    s_lshl_b32 s61, s6, 2
    s_lshr_b32 s52, s5, 1
    s_add_u32 s61, s61, s52
    s_and_b32 s61, s61, 14
    s_lshl_b32 s54, s61, 6
    v_subrev_u32 v2, s54, v10
    v_and_b32 v2, 1023, v2
    v_mad_u32_u24 v2, v8, v11, v2
    s_lshl_b32 s54, s52, 9
    s_lshl_b32 s3, s4, 14
    s_add_u32 s54, s54, s3
    v_lshlrev_b32 v3, 3, v9
    v_lshl_add_u32 v3, v8, 7, v3
    v_add_u32 v3, s54, v3
    v_lshlrev_b32 v5, 10, v9
    v_lshl_add_u32 v5, v8, 4, v5
    s_lshl_b32 s52, s52, 15
    s_add_u32 s52, s52, s53
    s_lshl_b32 s53, s4, 6
    s_add_u32 s52, s52, s53
    v_add_u32 v5, s52, v5
    s_lshl_b32 s61, s61, 11
    v_lshlrev_b32 v7, 2, v0
    v_add_u32 v7, 294912, v7
    v_and_b32 v28, 31, v0
    v_lshlrev_b32 v28, 2, v28
    v_add_u32 v28, 294912, v28
L_joint_c:
v_mov_b32 v30, 122880
s_cmp_lg_u32 s4, 0
s_cbranch_scc1 L_np_42
s_mov_b32 s57, 0
L_poll_43:
    buffer_load_dword v4, v7, s[40:43], 0 offen offset:256 sc1
    s_add_u32 s57, s57, 1
    s_cmp_gt_u32 s57, 200000
    s_cbranch_scc1 L_got_44
    s_waitcnt vmcnt(0)
    v_cmp_eq_u32 vcc, 0, v4
    s_cbranch_vccnz L_poll_43
L_got_44:
    s_waitcnt vmcnt(0)
v_cmp_lt_u32 vcc, 1, v4
s_cmp_lg_u64 vcc, 0
s_cselect_b32 s3, 1, 0
v_mov_b32 v4, s3
ds_write_b32 v30, v4
s_waitcnt lgkmcnt(0)
L_np_42:
s_barrier
s_add_u32 s53, s99, 0
buffer_load_dwordx2 v[8:9], v3, s[40:43], s53 offen sc1
ds_read_b32 v4, v30
v_add_u32 v14, 106496, v13
ds_read_b128 v[80:83], v14 offset:0
ds_read_b128 v[84:87], v14 offset:256
ds_read_b128 v[88:91], v14 offset:512
ds_read_b128 v[92:95], v14 offset:768
ds_read_b128 v[96:99], v14 offset:1024
ds_read_b128 v[100:103], v14 offset:1280
ds_read_b128 v[104:107], v14 offset:1536
ds_read_b128 v[108:111], v14 offset:1792
s_waitcnt lgkmcnt(8)
v_readfirstlane_b32 s101, v4
s_waitcnt vmcnt(0)
s_waitcnt vmcnt(0)
s_mov_b64 exec, 1
s_cmp_eq_u32 s63, 0
s_cbranch_scc1 L_xs_45
buffer_store_dword v29, v15, s[40:43], 0 offen offset:640
L_xd_46:
s_mov_b64 exec, -1
s_add_u32 s53, s99, 4096
buffer_load_dwordx2 v[10:11], v3, s[40:43], s53 offen sc1
s_cmp_lg_u32 s101, 0
s_cbranch_scc1 L_jslow_c
s_waitcnt lgkmcnt(0)
v_lshlrev_b32 v112, 16, v8
v_and_b32 v113, 0xffff0000, v8
v_lshlrev_b32 v114, 16, v9
v_and_b32 v115, 0xffff0000, v9
v_mul_f32 v112, s62, v112
v_mul_f32 v113, s62, v113
v_mul_f32 v114, s62, v114
v_mul_f32 v115, s62, v115
buffer_load_dwordx4 a[0:3], v12, s[92:95], s61 offen offset:0 sc1
v_exp_f32 v112, v112
v_exp_f32 v113, v113
v_exp_f32 v114, v114
v_exp_f32 v115, v115
v_pk_fma_f32 v[116:117], v[112:113], v[80:81], 1.0 op_sel_hi:[1,1,0]
v_pk_fma_f32 v[118:119], v[114:115], v[82:83], 1.0 op_sel_hi:[1,1,0]
v_rcp_f32 v116, v116
buffer_load_dwordx4 a[4:7], v12, s[92:95], s61 offen offset:1024 sc1
v_rcp_f32 v117, v117
v_rcp_f32 v118, v118
v_rcp_f32 v119, v119
v_pk_fma_f32 v[116:117], v[116:117], -2.0, 1.0 op_sel_hi:[1,0,0]
v_pk_fma_f32 v[118:119], v[118:119], -2.0, 1.0 op_sel_hi:[1,0,0]
v_cvt_pk_bf16_f32 v16, v116, v117
v_cvt_pk_bf16_f32 v17, v118, v119
buffer_load_dwordx4 a[8:11], v12, s[92:95], s61 offen offset:2048 sc1
ds_write_b64 v2, v[16:17] offset:0
v_pk_fma_f32 v[20:21], v[112:113], v[84:85], 1.0 op_sel_hi:[1,1,0]
v_pk_fma_f32 v[22:23], v[114:115], v[86:87], 1.0 op_sel_hi:[1,1,0]
v_rcp_f32 v20, v20
v_rcp_f32 v21, v21
v_rcp_f32 v22, v22
v_rcp_f32 v23, v23
buffer_load_dwordx4 a[12:15], v12, s[92:95], s61 offen offset:3072 sc1
s_add_u32 s61, s61, 4096
s_and_b32 s61, s61, 0x7fff
v_pk_fma_f32 v[20:21], v[20:21], -2.0, 1.0 op_sel_hi:[1,0,0]
v_pk_fma_f32 v[22:23], v[22:23], -2.0, 1.0 op_sel_hi:[1,0,0]
v_cvt_pk_bf16_f32 v18, v20, v21
v_cvt_pk_bf16_f32 v19, v22, v23
ds_write_b64 v2, v[18:19] offset:1040
v_pk_fma_f32 v[116:117], v[112:113], v[88:89], 1.0 op_sel_hi:[1,1,0]
v_pk_fma_f32 v[118:119], v[114:115], v[90:91], 1.0 op_sel_hi:[1,1,0]
buffer_load_dwordx4 a[16:19], v12, s[92:95], s61 offen offset:0 sc1
v_rcp_f32 v116, v116
v_rcp_f32 v117, v117
v_rcp_f32 v118, v118
v_rcp_f32 v119, v119
v_pk_fma_f32 v[116:117], v[116:117], -2.0, 1.0 op_sel_hi:[1,0,0]
v_pk_fma_f32 v[118:119], v[118:119], -2.0, 1.0 op_sel_hi:[1,0,0]
v_cvt_pk_bf16_f32 v16, v116, v117
buffer_load_dwordx4 a[20:23], v12, s[92:95], s61 offen offset:1024 sc1
v_cvt_pk_bf16_f32 v17, v118, v119
ds_write_b64 v2, v[16:17] offset:2080
v_pk_fma_f32 v[20:21], v[112:113], v[92:93], 1.0 op_sel_hi:[1,1,0]
v_pk_fma_f32 v[22:23], v[114:115], v[94:95], 1.0 op_sel_hi:[1,1,0]
v_rcp_f32 v20, v20
v_rcp_f32 v21, v21
v_rcp_f32 v22, v22
buffer_load_dwordx4 a[24:27], v12, s[92:95], s61 offen offset:2048 sc1
v_rcp_f32 v23, v23
v_pk_fma_f32 v[20:21], v[20:21], -2.0, 1.0 op_sel_hi:[1,0,0]
v_pk_fma_f32 v[22:23], v[22:23], -2.0, 1.0 op_sel_hi:[1,0,0]
v_cvt_pk_bf16_f32 v18, v20, v21
v_cvt_pk_bf16_f32 v19, v22, v23
ds_write_b64 v2, v[18:19] offset:3120
v_pk_fma_f32 v[116:117], v[112:113], v[96:97], 1.0 op_sel_hi:[1,1,0]
v_pk_fma_f32 v[118:119], v[114:115], v[98:99], 1.0 op_sel_hi:[1,1,0]
buffer_load_dwordx4 a[28:31], v12, s[92:95], s61 offen offset:3072 sc1
s_add_u32 s61, s61, 4096
s_and_b32 s61, s61, 0x7fff
v_rcp_f32 v116, v116
v_rcp_f32 v117, v117
v_rcp_f32 v118, v118
v_rcp_f32 v119, v119
v_pk_fma_f32 v[116:117], v[116:117], -2.0, 1.0 op_sel_hi:[1,0,0]
v_pk_fma_f32 v[118:119], v[118:119], -2.0, 1.0 op_sel_hi:[1,0,0]
v_cvt_pk_bf16_f32 v16, v116, v117
buffer_load_dwordx4 a[32:35], v12, s[92:95], s61 offen offset:0 sc1
v_cvt_pk_bf16_f32 v17, v118, v119
ds_write_b64 v2, v[16:17] offset:4160
v_pk_fma_f32 v[20:21], v[112:113], v[100:101], 1.0 op_sel_hi:[1,1,0]
v_pk_fma_f32 v[22:23], v[114:115], v[102:103], 1.0 op_sel_hi:[1,1,0]
v_rcp_f32 v20, v20
v_rcp_f32 v21, v21
v_rcp_f32 v22, v22
buffer_load_dwordx4 a[36:39], v12, s[92:95], s61 offen offset:1024 sc1
v_rcp_f32 v23, v23
v_pk_fma_f32 v[20:21], v[20:21], -2.0, 1.0 op_sel_hi:[1,0,0]
v_pk_fma_f32 v[22:23], v[22:23], -2.0, 1.0 op_sel_hi:[1,0,0]
v_cvt_pk_bf16_f32 v18, v20, v21
v_cvt_pk_bf16_f32 v19, v22, v23
ds_write_b64 v2, v[18:19] offset:5200
v_pk_fma_f32 v[116:117], v[112:113], v[104:105], 1.0 op_sel_hi:[1,1,0]
buffer_load_dwordx4 a[40:43], v12, s[92:95], s61 offen offset:2048 sc1
v_pk_fma_f32 v[118:119], v[114:115], v[106:107], 1.0 op_sel_hi:[1,1,0]
v_rcp_f32 v116, v116
v_rcp_f32 v117, v117
v_rcp_f32 v118, v118
v_rcp_f32 v119, v119
v_pk_fma_f32 v[116:117], v[116:117], -2.0, 1.0 op_sel_hi:[1,0,0]
v_pk_fma_f32 v[118:119], v[118:119], -2.0, 1.0 op_sel_hi:[1,0,0]
buffer_load_dwordx4 a[44:47], v12, s[92:95], s61 offen offset:3072 sc1
s_add_u32 s61, s61, 4096
s_and_b32 s61, s61, 0x7fff
v_cvt_pk_bf16_f32 v16, v116, v117
v_cvt_pk_bf16_f32 v17, v118, v119
ds_write_b64 v2, v[16:17] offset:6240
v_pk_fma_f32 v[20:21], v[112:113], v[108:109], 1.0 op_sel_hi:[1,1,0]
v_pk_fma_f32 v[22:23], v[114:115], v[110:111], 1.0 op_sel_hi:[1,1,0]
v_rcp_f32 v20, v20
v_rcp_f32 v21, v21
buffer_load_dwordx4 a[48:51], v12, s[92:95], s61 offen offset:0 sc1
v_rcp_f32 v22, v22
v_rcp_f32 v23, v23
v_pk_fma_f32 v[20:21], v[20:21], -2.0, 1.0 op_sel_hi:[1,0,0]
v_pk_fma_f32 v[22:23], v[22:23], -2.0, 1.0 op_sel_hi:[1,0,0]
v_cvt_pk_bf16_f32 v18, v20, v21
v_cvt_pk_bf16_f32 v19, v22, v23
ds_write_b64 v2, v[18:19] offset:7280
buffer_load_dwordx4 a[52:55], v12, s[92:95], s61 offen offset:1024 sc1
s_waitcnt vmcnt(14) lgkmcnt(0)
s_barrier
ds_read_b128 v[64:67], v1 offset:0
ds_read_b128 v[68:71], v1 offset:32
ds_read_b128 v[72:75], v1 offset:64
s_waitcnt vmcnt(12) lgkmcnt(2)
v_mfma_f32_32x32x16_bf16 v[32:47], a[0:3], v[64:67], 0
ds_read_b128 v[76:79], v1 offset:96
v_lshlrev_b32 v112, 16, v10
v_and_b32 v113, 0xffff0000, v10
v_lshlrev_b32 v114, 16, v11
v_and_b32 v115, 0xffff0000, v11
v_mul_f32 v112, s62, v112
v_mul_f32 v113, s62, v113
buffer_load_dwordx4 a[56:59], v12, s[92:95], s61 offen offset:2048 sc1
s_waitcnt lgkmcnt(2)
v_mfma_f32_32x32x16_bf16 v[32:47], a[4:7], v[68:71], v[32:47]
ds_read_b128 v[64:67], v1 offset:128
v_mul_f32 v114, s62, v114
v_mul_f32 v115, s62, v115
v_exp_f32 v112, v112
v_exp_f32 v113, v113
buffer_load_dwordx4 a[60:63], v12, s[92:95], s61 offen offset:3072 sc1
s_add_u32 s61, s61, 4096
s_and_b32 s61, s61, 0x7fff
s_waitcnt vmcnt(12) lgkmcnt(2)
v_mfma_f32_32x32x16_bf16 v[32:47], a[8:11], v[72:75], v[32:47]
ds_read_b128 v[68:71], v1 offset:160
v_exp_f32 v114, v114
v_exp_f32 v115, v115
v_fma_f32 v116, v112, v80, 1.0
v_fma_f32 v117, v113, v81, 1.0
buffer_load_dwordx4 a[64:67], v12, s[92:95], s61 offen offset:0 sc1
s_waitcnt lgkmcnt(2)
v_mfma_f32_32x32x16_bf16 v[32:47], a[12:15], v[76:79], v[32:47]
ds_read_b128 v[72:75], v1 offset:192
v_fma_f32 v118, v114, v82, 1.0
v_fma_f32 v119, v115, v83, 1.0
v_rcp_f32 v116, v116
v_rcp_f32 v117, v117
buffer_load_dwordx4 a[68:71], v12, s[92:95], s61 offen offset:1024 sc1
s_waitcnt vmcnt(12) lgkmcnt(2)
v_mfma_f32_32x32x16_bf16 v[32:47], a[16:19], v[64:67], v[32:47]
ds_read_b128 v[76:79], v1 offset:224
v_rcp_f32 v118, v118
v_rcp_f32 v119, v119
v_fma_f32 v116, v116, -2.0, 1.0
v_fma_f32 v117, v117, -2.0, 1.0
buffer_load_dwordx4 a[72:75], v12, s[92:95], s61 offen offset:2048 sc1
s_waitcnt lgkmcnt(2)
v_mfma_f32_32x32x16_bf16 v[32:47], a[20:23], v[68:71], v[32:47]
ds_read_b128 v[64:67], v1 offset:256
v_fma_f32 v118, v118, -2.0, 1.0
v_fma_f32 v119, v119, -2.0, 1.0
v_cvt_pk_bf16_f32 v16, v116, v117
v_cvt_pk_bf16_f32 v17, v118, v119
ds_write_b64 v2, v[16:17] offset:33280
v_fma_f32 v20, v112, v84, 1.0
v_fma_f32 v21, v113, v85, 1.0
s_waitcnt vmcnt(11) lgkmcnt(3)
v_mfma_f32_32x32x16_bf16 v[32:47], a[24:27], v[72:75], v[32:47]
ds_read_b128 v[68:71], v1 offset:288
v_fma_f32 v22, v114, v86, 1.0
v_fma_f32 v23, v115, v87, 1.0
v_rcp_f32 v20, v20
v_rcp_f32 v21, v21
buffer_load_dwordx4 a[76:79], v12, s[92:95], s61 offen offset:3072 sc1
s_add_u32 s61, s61, 4096
s_and_b32 s61, s61, 0x7fff
s_waitcnt lgkmcnt(3)
v_mfma_f32_32x32x16_bf16 v[32:47], a[28:31], v[76:79], v[32:47]
ds_read_b128 v[72:75], v1 offset:320
v_rcp_f32 v22, v22
v_rcp_f32 v23, v23
v_fma_f32 v20, v20, -2.0, 1.0
v_fma_f32 v21, v21, -2.0, 1.0
buffer_load_dwordx4 a[80:83], v12, s[92:95], s61 offen offset:0 sc1
s_waitcnt vmcnt(11) lgkmcnt(3)
v_mfma_f32_32x32x16_bf16 v[32:47], a[32:35], v[64:67], v[32:47]
ds_read_b128 v[76:79], v1 offset:352
v_fma_f32 v22, v22, -2.0, 1.0
v_fma_f32 v23, v23, -2.0, 1.0
v_cvt_pk_bf16_f32 v18, v20, v21
v_cvt_pk_bf16_f32 v19, v22, v23
ds_write_b64 v2, v[18:19] offset:34320
v_fma_f32 v116, v112, v88, 1.0
v_fma_f32 v117, v113, v89, 1.0
buffer_load_dwordx4 a[84:87], v12, s[92:95], s61 offen offset:1024 sc1
s_waitcnt lgkmcnt(3)
v_mfma_f32_32x32x16_bf16 v[32:47], a[36:39], v[68:71], v[32:47]
ds_read_b128 v[64:67], v1 offset:384
v_fma_f32 v118, v114, v90, 1.0
v_fma_f32 v119, v115, v91, 1.0
v_rcp_f32 v116, v116
v_rcp_f32 v117, v117
buffer_load_dwordx4 a[88:91], v12, s[92:95], s61 offen offset:2048 sc1
s_waitcnt vmcnt(11) lgkmcnt(3)
v_mfma_f32_32x32x16_bf16 v[32:47], a[40:43], v[72:75], v[32:47]
ds_read_b128 v[68:71], v1 offset:416
v_rcp_f32 v118, v118
v_rcp_f32 v119, v119
v_fma_f32 v116, v116, -2.0, 1.0
v_fma_f32 v117, v117, -2.0, 1.0
s_waitcnt lgkmcnt(3)
v_mfma_f32_32x32x16_bf16 v[32:47], a[44:47], v[76:79], v[32:47]
ds_read_b128 v[72:75], v1 offset:448
v_fma_f32 v118, v118, -2.0, 1.0
v_fma_f32 v119, v119, -2.0, 1.0
v_cvt_pk_bf16_f32 v16, v116, v117
v_cvt_pk_bf16_f32 v17, v118, v119
ds_write_b64 v2, v[16:17] offset:35360
v_fma_f32 v20, v112, v92, 1.0
v_fma_f32 v21, v113, v93, 1.0
buffer_load_dwordx4 a[92:95], v12, s[92:95], s61 offen offset:3072 sc1
s_add_u32 s61, s61, 4096
s_and_b32 s61, s61, 0x7fff
s_waitcnt vmcnt(10) lgkmcnt(3)
v_mfma_f32_32x32x16_bf16 v[32:47], a[48:51], v[64:67], v[32:47]
ds_read_b128 v[76:79], v1 offset:480
v_fma_f32 v22, v114, v94, 1.0
v_fma_f32 v23, v115, v95, 1.0
v_rcp_f32 v20, v20
v_rcp_f32 v21, v21
buffer_load_dwordx4 a[96:99], v12, s[92:95], s61 offen offset:0 sc1
s_waitcnt lgkmcnt(3)
v_mfma_f32_32x32x16_bf16 v[32:47], a[52:55], v[68:71], v[32:47]
ds_read_b128 v[64:67], v1 offset:512
v_rcp_f32 v22, v22
v_rcp_f32 v23, v23
v_fma_f32 v20, v20, -2.0, 1.0
v_fma_f32 v21, v21, -2.0, 1.0
buffer_load_dwordx4 a[100:103], v12, s[92:95], s61 offen offset:1024 sc1
s_waitcnt vmcnt(10) lgkmcnt(3)
v_mfma_f32_32x32x16_bf16 v[32:47], a[56:59], v[72:75], v[32:47]
ds_read_b128 v[68:71], v1 offset:544
v_fma_f32 v22, v22, -2.0, 1.0
v_fma_f32 v23, v23, -2.0, 1.0
v_cvt_pk_bf16_f32 v18, v20, v21
v_cvt_pk_bf16_f32 v19, v22, v23
ds_write_b64 v2, v[18:19] offset:36400
v_fma_f32 v116, v112, v96, 1.0
v_fma_f32 v117, v113, v97, 1.0
buffer_load_dwordx4 a[104:107], v12, s[92:95], s61 offen offset:2048 sc1
s_waitcnt lgkmcnt(3)
v_mfma_f32_32x32x16_bf16 v[32:47], a[60:63], v[76:79], v[32:47]
ds_read_b128 v[72:75], v1 offset:576
v_fma_f32 v118, v114, v98, 1.0
v_fma_f32 v119, v115, v99, 1.0
v_rcp_f32 v116, v116
v_rcp_f32 v117, v117
buffer_load_dwordx4 a[108:111], v12, s[92:95], s61 offen offset:3072 sc1
s_add_u32 s61, s61, 4096
s_and_b32 s61, s61, 0x7fff
s_waitcnt vmcnt(10) lgkmcnt(3)
v_mfma_f32_32x32x16_bf16 v[32:47], a[64:67], v[64:67], v[32:47]
ds_read_b128 v[76:79], v1 offset:608
v_rcp_f32 v118, v118
v_rcp_f32 v119, v119
v_fma_f32 v116, v116, -2.0, 1.0
v_fma_f32 v117, v117, -2.0, 1.0
s_waitcnt lgkmcnt(3)
v_mfma_f32_32x32x16_bf16 v[32:47], a[68:71], v[68:71], v[32:47]
ds_read_b128 v[64:67], v1 offset:640
v_fma_f32 v118, v118, -2.0, 1.0
v_fma_f32 v119, v119, -2.0, 1.0
v_cvt_pk_bf16_f32 v16, v116, v117
v_cvt_pk_bf16_f32 v17, v118, v119
ds_write_b64 v2, v[16:17] offset:37440
v_fma_f32 v20, v112, v100, 1.0
v_fma_f32 v21, v113, v101, 1.0
buffer_load_dwordx4 a[112:115], v12, s[92:95], s61 offen offset:0 sc1
s_waitcnt vmcnt(9) lgkmcnt(3)
v_mfma_f32_32x32x16_bf16 v[32:47], a[72:75], v[72:75], v[32:47]
ds_read_b128 v[68:71], v1 offset:672
v_fma_f32 v22, v114, v102, 1.0
v_fma_f32 v23, v115, v103, 1.0
v_rcp_f32 v20, v20
v_rcp_f32 v21, v21
buffer_load_dwordx4 a[116:119], v12, s[92:95], s61 offen offset:1024 sc1
s_waitcnt lgkmcnt(3)
v_mfma_f32_32x32x16_bf16 v[32:47], a[76:79], v[76:79], v[32:47]
ds_read_b128 v[72:75], v1 offset:704
v_rcp_f32 v22, v22
v_rcp_f32 v23, v23
v_fma_f32 v20, v20, -2.0, 1.0
v_fma_f32 v21, v21, -2.0, 1.0
buffer_load_dwordx4 a[120:123], v12, s[92:95], s61 offen offset:2048 sc1
s_waitcnt vmcnt(9) lgkmcnt(3)
v_mfma_f32_32x32x16_bf16 v[32:47], a[80:83], v[64:67], v[32:47]
ds_read_b128 v[76:79], v1 offset:736
v_fma_f32 v22, v22, -2.0, 1.0
v_fma_f32 v23, v23, -2.0, 1.0
v_cvt_pk_bf16_f32 v18, v20, v21
v_cvt_pk_bf16_f32 v19, v22, v23
ds_write_b64 v2, v[18:19] offset:38480
v_fma_f32 v116, v112, v104, 1.0
v_fma_f32 v117, v113, v105, 1.0
buffer_load_dwordx4 a[124:127], v12, s[92:95], s61 offen offset:3072 sc1
s_add_u32 s61, s61, 4096
s_and_b32 s61, s61, 0x7fff
s_waitcnt lgkmcnt(3)
v_mfma_f32_32x32x16_bf16 v[32:47], a[84:87], v[68:71], v[32:47]
ds_read_b128 v[64:67], v1 offset:768
v_fma_f32 v118, v114, v106, 1.0
v_fma_f32 v119, v115, v107, 1.0
v_rcp_f32 v116, v116
v_rcp_f32 v117, v117
buffer_load_dword v4, v28, s[40:43], 0 offen offset:640 sc1
s_waitcnt vmcnt(9) lgkmcnt(3)
v_mfma_f32_32x32x16_bf16 v[32:47], a[88:91], v[72:75], v[32:47]
ds_read_b128 v[68:71], v1 offset:800
v_rcp_f32 v118, v118
v_rcp_f32 v119, v119
v_fma_f32 v116, v116, -2.0, 1.0
v_fma_f32 v117, v117, -2.0, 1.0
s_waitcnt lgkmcnt(3)
v_mfma_f32_32x32x16_bf16 v[32:47], a[92:95], v[76:79], v[32:47]
ds_read_b128 v[72:75], v1 offset:832
v_fma_f32 v118, v118, -2.0, 1.0
v_fma_f32 v119, v119, -2.0, 1.0
v_cvt_pk_bf16_f32 v16, v116, v117
v_cvt_pk_bf16_f32 v17, v118, v119
ds_write_b64 v2, v[16:17] offset:39520
v_fma_f32 v20, v112, v108, 1.0
v_fma_f32 v21, v113, v109, 1.0
s_waitcnt vmcnt(7) lgkmcnt(3)
v_mfma_f32_32x32x16_bf16 v[32:47], a[96:99], v[64:67], v[32:47]
ds_read_b128 v[76:79], v1 offset:864
v_fma_f32 v22, v114, v110, 1.0
v_fma_f32 v23, v115, v111, 1.0
v_rcp_f32 v20, v20
v_rcp_f32 v21, v21
s_waitcnt lgkmcnt(3)
v_mfma_f32_32x32x16_bf16 v[32:47], a[100:103], v[68:71], v[32:47]
ds_read_b128 v[64:67], v1 offset:896
v_rcp_f32 v22, v22
v_rcp_f32 v23, v23
v_fma_f32 v20, v20, -2.0, 1.0
v_fma_f32 v21, v21, -2.0, 1.0
s_waitcnt vmcnt(5) lgkmcnt(3)
v_mfma_f32_32x32x16_bf16 v[32:47], a[104:107], v[72:75], v[32:47]
ds_read_b128 v[68:71], v1 offset:928
v_fma_f32 v22, v22, -2.0, 1.0
v_fma_f32 v23, v23, -2.0, 1.0
v_cvt_pk_bf16_f32 v18, v20, v21
v_cvt_pk_bf16_f32 v19, v22, v23
ds_write_b64 v2, v[18:19] offset:40560
s_waitcnt lgkmcnt(3)
v_mfma_f32_32x32x16_bf16 v[32:47], a[108:111], v[76:79], v[32:47]
ds_read_b128 v[72:75], v1 offset:960
s_waitcnt vmcnt(3) lgkmcnt(3)
v_mfma_f32_32x32x16_bf16 v[32:47], a[112:115], v[64:67], v[32:47]
ds_read_b128 v[76:79], v1 offset:992
s_waitcnt vmcnt(0)
v_cmp_eq_u32 vcc, 0, v4
s_cbranch_vccnz L_fl_47
L_fd_48:
v_cmp_lt_u32 vcc, 1, v4
s_cmp_lg_u64 vcc, 0
s_cselect_b32 s101, 1, 0
s_add_u32 s53, s99, 2048
buffer_load_dwordx2 v[24:25], v3, s[40:43], s53 offen sc1
s_add_u32 s53, s99, 6144
buffer_load_dwordx2 v[26:27], v3, s[40:43], s53 offen sc1
s_waitcnt lgkmcnt(3)
v_mfma_f32_32x32x16_bf16 v[32:47], a[116:119], v[68:71], v[32:47]
s_waitcnt lgkmcnt(1)
v_mfma_f32_32x32x16_bf16 v[32:47], a[120:123], v[72:75], v[32:47]
s_waitcnt lgkmcnt(0)
v_mfma_f32_32x32x16_bf16 v[32:47], a[124:127], v[76:79], v[32:47]
s_waitcnt lgkmcnt(0)
s_cmp_lg_u32 s101, 0
s_cbranch_scc1 L_jslow_b
s_barrier
s_branch L_p1
L_joint_l:
v_mov_b32 v30, 122880
s_waitcnt vmcnt(4)
s_barrier
s_add_u32 s53, s99, 0
buffer_load_dwordx2 v[8:9], v3, s[40:43], s53 offen sc1
ds_read_b32 v4, v30
v_add_u32 v14, 106496, v13
ds_read_b128 v[80:83], v14 offset:0
ds_read_b128 v[84:87], v14 offset:256
ds_read_b128 v[88:91], v14 offset:512
ds_read_b128 v[92:95], v14 offset:768
ds_read_b128 v[96:99], v14 offset:1024
ds_read_b128 v[100:103], v14 offset:1280
ds_read_b128 v[104:107], v14 offset:1536
ds_read_b128 v[108:111], v14 offset:1792
s_waitcnt lgkmcnt(8)
v_readfirstlane_b32 s101, v4
s_waitcnt vmcnt(0)
s_add_u32 s53, s99, 4096
buffer_load_dwordx2 v[10:11], v3, s[40:43], s53 offen sc1
s_cmp_lg_u32 s101, 0
s_cbranch_scc1 L_jslow_l
s_waitcnt lgkmcnt(0)
v_lshlrev_b32 v112, 16, v8
v_and_b32 v113, 0xffff0000, v8
v_lshlrev_b32 v114, 16, v9
v_and_b32 v115, 0xffff0000, v9
v_mul_f32 v112, s62, v112
v_mul_f32 v113, s62, v113
v_mul_f32 v114, s62, v114
v_mul_f32 v115, s62, v115
v_exp_f32 v112, v112
v_exp_f32 v113, v113
v_exp_f32 v114, v114
v_exp_f32 v115, v115
v_pk_fma_f32 v[116:117], v[112:113], v[80:81], 1.0 op_sel_hi:[1,1,0]
v_pk_fma_f32 v[118:119], v[114:115], v[82:83], 1.0 op_sel_hi:[1,1,0]
v_rcp_f32 v116, v116
v_rcp_f32 v117, v117
v_rcp_f32 v118, v118
buffer_load_dwordx4 a[56:59], v12, s[92:95], s61 offen offset:2048 sc1
v_rcp_f32 v119, v119
v_pk_fma_f32 v[116:117], v[116:117], -2.0, 1.0 op_sel_hi:[1,0,0]
v_pk_fma_f32 v[118:119], v[118:119], -2.0, 1.0 op_sel_hi:[1,0,0]
v_cvt_pk_bf16_f32 v16, v116, v117
v_cvt_pk_bf16_f32 v17, v118, v119
ds_write_b64 v2, v[16:17] offset:0
v_pk_fma_f32 v[20:21], v[112:113], v[84:85], 1.0 op_sel_hi:[1,1,0]
v_pk_fma_f32 v[22:23], v[114:115], v[86:87], 1.0 op_sel_hi:[1,1,0]
v_rcp_f32 v20, v20
v_rcp_f32 v21, v21
v_rcp_f32 v22, v22
v_rcp_f32 v23, v23
v_pk_fma_f32 v[20:21], v[20:21], -2.0, 1.0 op_sel_hi:[1,0,0]
v_pk_fma_f32 v[22:23], v[22:23], -2.0, 1.0 op_sel_hi:[1,0,0]
v_cvt_pk_bf16_f32 v18, v20, v21
v_cvt_pk_bf16_f32 v19, v22, v23
ds_write_b64 v2, v[18:19] offset:1040
buffer_load_dwordx4 a[60:63], v12, s[92:95], s61 offen offset:3072 sc1
s_add_u32 s61, s61, 4096
s_and_b32 s61, s61, 0x7fff
v_pk_fma_f32 v[116:117], v[112:113], v[88:89], 1.0 op_sel_hi:[1,1,0]
v_pk_fma_f32 v[118:119], v[114:115], v[90:91], 1.0 op_sel_hi:[1,1,0]
v_rcp_f32 v116, v116
v_rcp_f32 v117, v117
v_rcp_f32 v118, v118
v_rcp_f32 v119, v119
v_pk_fma_f32 v[116:117], v[116:117], -2.0, 1.0 op_sel_hi:[1,0,0]
v_pk_fma_f32 v[118:119], v[118:119], -2.0, 1.0 op_sel_hi:[1,0,0]
v_cvt_pk_bf16_f32 v16, v116, v117
v_cvt_pk_bf16_f32 v17, v118, v119
ds_write_b64 v2, v[16:17] offset:2080
v_pk_fma_f32 v[20:21], v[112:113], v[92:93], 1.0 op_sel_hi:[1,1,0]
v_pk_fma_f32 v[22:23], v[114:115], v[94:95], 1.0 op_sel_hi:[1,1,0]
v_rcp_f32 v20, v20
v_rcp_f32 v21, v21
v_rcp_f32 v22, v22
buffer_load_dwordx4 a[64:67], v12, s[92:95], s61 offen offset:0 sc1
v_rcp_f32 v23, v23
v_pk_fma_f32 v[20:21], v[20:21], -2.0, 1.0 op_sel_hi:[1,0,0]
v_pk_fma_f32 v[22:23], v[22:23], -2.0, 1.0 op_sel_hi:[1,0,0]
v_cvt_pk_bf16_f32 v18, v20, v21
v_cvt_pk_bf16_f32 v19, v22, v23
ds_write_b64 v2, v[18:19] offset:3120
v_pk_fma_f32 v[116:117], v[112:113], v[96:97], 1.0 op_sel_hi:[1,1,0]
v_pk_fma_f32 v[118:119], v[114:115], v[98:99], 1.0 op_sel_hi:[1,1,0]
v_rcp_f32 v116, v116
v_rcp_f32 v117, v117
v_rcp_f32 v118, v118
v_rcp_f32 v119, v119
v_pk_fma_f32 v[116:117], v[116:117], -2.0, 1.0 op_sel_hi:[1,0,0]
v_pk_fma_f32 v[118:119], v[118:119], -2.0, 1.0 op_sel_hi:[1,0,0]
v_cvt_pk_bf16_f32 v16, v116, v117
v_cvt_pk_bf16_f32 v17, v118, v119
ds_write_b64 v2, v[16:17] offset:4160
buffer_load_dwordx4 a[68:71], v12, s[92:95], s61 offen offset:1024 sc1
v_pk_fma_f32 v[20:21], v[112:113], v[100:101], 1.0 op_sel_hi:[1,1,0]
v_pk_fma_f32 v[22:23], v[114:115], v[102:103], 1.0 op_sel_hi:[1,1,0]
v_rcp_f32 v20, v20
v_rcp_f32 v21, v21
v_rcp_f32 v22, v22
v_rcp_f32 v23, v23
v_pk_fma_f32 v[20:21], v[20:21], -2.0, 1.0 op_sel_hi:[1,0,0]
v_pk_fma_f32 v[22:23], v[22:23], -2.0, 1.0 op_sel_hi:[1,0,0]
v_cvt_pk_bf16_f32 v18, v20, v21
v_cvt_pk_bf16_f32 v19, v22, v23
ds_write_b64 v2, v[18:19] offset:5200
v_pk_fma_f32 v[116:117], v[112:113], v[104:105], 1.0 op_sel_hi:[1,1,0]
v_pk_fma_f32 v[118:119], v[114:115], v[106:107], 1.0 op_sel_hi:[1,1,0]
v_rcp_f32 v116, v116
v_rcp_f32 v117, v117
v_rcp_f32 v118, v118
v_rcp_f32 v119, v119
buffer_load_dwordx4 a[72:75], v12, s[92:95], s61 offen offset:2048 sc1
v_pk_fma_f32 v[116:117], v[116:117], -2.0, 1.0 op_sel_hi:[1,0,0]
v_pk_fma_f32 v[118:119], v[118:119], -2.0, 1.0 op_sel_hi:[1,0,0]
v_cvt_pk_bf16_f32 v16, v116, v117
v_cvt_pk_bf16_f32 v17, v118, v119
ds_write_b64 v2, v[16:17] offset:6240
v_pk_fma_f32 v[20:21], v[112:113], v[108:109], 1.0 op_sel_hi:[1,1,0]
v_pk_fma_f32 v[22:23], v[114:115], v[110:111], 1.0 op_sel_hi:[1,1,0]
v_rcp_f32 v20, v20
v_rcp_f32 v21, v21
v_rcp_f32 v22, v22
v_rcp_f32 v23, v23
v_pk_fma_f32 v[20:21], v[20:21], -2.0, 1.0 op_sel_hi:[1,0,0]
v_pk_fma_f32 v[22:23], v[22:23], -2.0, 1.0 op_sel_hi:[1,0,0]
v_cvt_pk_bf16_f32 v18, v20, v21
v_cvt_pk_bf16_f32 v19, v22, v23
ds_write_b64 v2, v[18:19] offset:7280
buffer_load_dwordx4 a[76:79], v12, s[92:95], s61 offen offset:3072 sc1
s_add_u32 s61, s61, 4096
s_and_b32 s61, s61, 0x7fff
s_waitcnt vmcnt(6) lgkmcnt(0)
s_barrier
ds_read_b128 v[64:67], v1 offset:0
ds_read_b128 v[68:71], v1 offset:32
ds_read_b128 v[72:75], v1 offset:64
s_waitcnt vmcnt(18) lgkmcnt(2)
v_mfma_f32_32x32x16_bf16 v[32:47], a[0:3], v[64:67], 0
ds_read_b128 v[76:79], v1 offset:96
v_lshlrev_b32 v112, 16, v10
v_and_b32 v113, 0xffff0000, v10
v_lshlrev_b32 v114, 16, v11
v_and_b32 v115, 0xffff0000, v11
v_mul_f32 v112, s62, v112
v_mul_f32 v113, s62, v113
buffer_load_dwordx4 a[80:83], v12, s[92:95], s61 offen offset:0 sc1
s_waitcnt lgkmcnt(2)
v_mfma_f32_32x32x16_bf16 v[32:47], a[4:7], v[68:71], v[32:47]
ds_read_b128 v[64:67], v1 offset:128
v_mul_f32 v114, s62, v114
v_mul_f32 v115, s62, v115
v_exp_f32 v112, v112
v_exp_f32 v113, v113
buffer_load_dwordx4 a[84:87], v12, s[92:95], s61 offen offset:1024 sc1
s_waitcnt vmcnt(18) lgkmcnt(2)
v_mfma_f32_32x32x16_bf16 v[32:47], a[8:11], v[72:75], v[32:47]
ds_read_b128 v[68:71], v1 offset:160
v_exp_f32 v114, v114
v_exp_f32 v115, v115
v_fma_f32 v116, v112, v80, 1.0
v_fma_f32 v117, v113, v81, 1.0
s_waitcnt lgkmcnt(2)
v_mfma_f32_32x32x16_bf16 v[32:47], a[12:15], v[76:79], v[32:47]
ds_read_b128 v[72:75], v1 offset:192
v_fma_f32 v118, v114, v82, 1.0
v_fma_f32 v119, v115, v83, 1.0
v_rcp_f32 v116, v116
v_rcp_f32 v117, v117
buffer_load_dwordx4 a[88:91], v12, s[92:95], s61 offen offset:2048 sc1
s_waitcnt vmcnt(17) lgkmcnt(2)
v_mfma_f32_32x32x16_bf16 v[32:47], a[16:19], v[64:67], v[32:47]
ds_read_b128 v[76:79], v1 offset:224
v_rcp_f32 v118, v118
v_rcp_f32 v119, v119
v_fma_f32 v116, v116, -2.0, 1.0
v_fma_f32 v117, v117, -2.0, 1.0
s_waitcnt lgkmcnt(2)
v_mfma_f32_32x32x16_bf16 v[32:47], a[20:23], v[68:71], v[32:47]
ds_read_b128 v[64:67], v1 offset:256
v_fma_f32 v118, v118, -2.0, 1.0
v_fma_f32 v119, v119, -2.0, 1.0
v_cvt_pk_bf16_f32 v16, v116, v117
v_cvt_pk_bf16_f32 v17, v118, v119
ds_write_b64 v2, v[16:17] offset:33280
v_fma_f32 v20, v112, v84, 1.0
v_fma_f32 v21, v113, v85, 1.0
buffer_load_dwordx4 a[92:95], v12, s[92:95], s61 offen offset:3072 sc1
s_add_u32 s61, s61, 4096
s_and_b32 s61, s61, 0x7fff
s_waitcnt vmcnt(16) lgkmcnt(3)
v_mfma_f32_32x32x16_bf16 v[32:47], a[24:27], v[72:75], v[32:47]
ds_read_b128 v[68:71], v1 offset:288
v_fma_f32 v22, v114, v86, 1.0
v_fma_f32 v23, v115, v87, 1.0
v_rcp_f32 v20, v20
v_rcp_f32 v21, v21
s_waitcnt lgkmcnt(3)
v_mfma_f32_32x32x16_bf16 v[32:47], a[28:31], v[76:79], v[32:47]
ds_read_b128 v[72:75], v1 offset:320
v_rcp_f32 v22, v22
v_rcp_f32 v23, v23
v_fma_f32 v20, v20, -2.0, 1.0
v_fma_f32 v21, v21, -2.0, 1.0
buffer_load_dwordx4 a[96:99], v12, s[92:95], s61 offen offset:0 sc1
s_waitcnt vmcnt(15) lgkmcnt(3)
v_mfma_f32_32x32x16_bf16 v[32:47], a[32:35], v[64:67], v[32:47]
ds_read_b128 v[76:79], v1 offset:352
v_fma_f32 v22, v22, -2.0, 1.0
v_fma_f32 v23, v23, -2.0, 1.0
v_cvt_pk_bf16_f32 v18, v20, v21
v_cvt_pk_bf16_f32 v19, v22, v23
ds_write_b64 v2, v[18:19] offset:34320
v_fma_f32 v116, v112, v88, 1.0
v_fma_f32 v117, v113, v89, 1.0
s_waitcnt lgkmcnt(3)
v_mfma_f32_32x32x16_bf16 v[32:47], a[36:39], v[68:71], v[32:47]
ds_read_b128 v[64:67], v1 offset:384
v_fma_f32 v118, v114, v90, 1.0
v_fma_f32 v119, v115, v91, 1.0
v_rcp_f32 v116, v116
v_rcp_f32 v117, v117
buffer_load_dwordx4 a[100:103], v12, s[92:95], s61 offen offset:1024 sc1
s_waitcnt vmcnt(14) lgkmcnt(3)
v_mfma_f32_32x32x16_bf16 v[32:47], a[40:43], v[72:75], v[32:47]
ds_read_b128 v[68:71], v1 offset:416
v_rcp_f32 v118, v118
v_rcp_f32 v119, v119
v_fma_f32 v116, v116, -2.0, 1.0
v_fma_f32 v117, v117, -2.0, 1.0
s_waitcnt lgkmcnt(3)
v_mfma_f32_32x32x16_bf16 v[32:47], a[44:47], v[76:79], v[32:47]
ds_read_b128 v[72:75], v1 offset:448
v_fma_f32 v118, v118, -2.0, 1.0
v_fma_f32 v119, v119, -2.0, 1.0
v_cvt_pk_bf16_f32 v16, v116, v117
v_cvt_pk_bf16_f32 v17, v118, v119
ds_write_b64 v2, v[16:17] offset:35360
v_fma_f32 v20, v112, v92, 1.0
v_fma_f32 v21, v113, v93, 1.0
buffer_load_dwordx4 a[104:107], v12, s[92:95], s61 offen offset:2048 sc1
s_waitcnt vmcnt(13) lgkmcnt(3)
v_mfma_f32_32x32x16_bf16 v[32:47], a[48:51], v[64:67], v[32:47]
ds_read_b128 v[76:79], v1 offset:480
v_fma_f32 v22, v114, v94, 1.0
v_fma_f32 v23, v115, v95, 1.0
v_rcp_f32 v20, v20
v_rcp_f32 v21, v21
buffer_load_dwordx4 a[108:111], v12, s[92:95], s61 offen offset:3072 sc1
s_add_u32 s61, s61, 4096
s_and_b32 s61, s61, 0x7fff
s_waitcnt lgkmcnt(3)
v_mfma_f32_32x32x16_bf16 v[32:47], a[52:55], v[68:71], v[32:47]
ds_read_b128 v[64:67], v1 offset:512
v_rcp_f32 v22, v22
v_rcp_f32 v23, v23
v_fma_f32 v20, v20, -2.0, 1.0
v_fma_f32 v21, v21, -2.0, 1.0
s_waitcnt vmcnt(12) lgkmcnt(3)
v_mfma_f32_32x32x16_bf16 v[32:47], a[56:59], v[72:75], v[32:47]
ds_read_b128 v[68:71], v1 offset:544
v_fma_f32 v22, v22, -2.0, 1.0
v_fma_f32 v23, v23, -2.0, 1.0
v_cvt_pk_bf16_f32 v18, v20, v21
v_cvt_pk_bf16_f32 v19, v22, v23
ds_write_b64 v2, v[18:19] offset:36400
v_fma_f32 v116, v112, v96, 1.0
v_fma_f32 v117, v113, v97, 1.0
buffer_load_dwordx4 a[112:115], v12, s[92:95], s61 offen offset:0 sc1
s_waitcnt lgkmcnt(3)
v_mfma_f32_32x32x16_bf16 v[32:47], a[60:63], v[76:79], v[32:47]
ds_read_b128 v[72:75], v1 offset:576
v_fma_f32 v118, v114, v98, 1.0
v_fma_f32 v119, v115, v99, 1.0
v_rcp_f32 v116, v116
v_rcp_f32 v117, v117
s_waitcnt vmcnt(11) lgkmcnt(3)
v_mfma_f32_32x32x16_bf16 v[32:47], a[64:67], v[64:67], v[32:47]
ds_read_b128 v[76:79], v1 offset:608
v_rcp_f32 v118, v118
v_rcp_f32 v119, v119
v_fma_f32 v116, v116, -2.0, 1.0
v_fma_f32 v117, v117, -2.0, 1.0
buffer_load_dwordx4 a[116:119], v12, s[92:95], s61 offen offset:1024 sc1
s_waitcnt lgkmcnt(3)
v_mfma_f32_32x32x16_bf16 v[32:47], a[68:71], v[68:71], v[32:47]
ds_read_b128 v[64:67], v1 offset:640
v_fma_f32 v118, v118, -2.0, 1.0
v_fma_f32 v119, v119, -2.0, 1.0
v_cvt_pk_bf16_f32 v16, v116, v117
v_cvt_pk_bf16_f32 v17, v118, v119
ds_write_b64 v2, v[16:17] offset:37440
v_fma_f32 v20, v112, v100, 1.0
v_fma_f32 v21, v113, v101, 1.0
s_waitcnt vmcnt(10) lgkmcnt(3)
v_mfma_f32_32x32x16_bf16 v[32:47], a[72:75], v[72:75], v[32:47]
ds_read_b128 v[68:71], v1 offset:672
v_fma_f32 v22, v114, v102, 1.0
v_fma_f32 v23, v115, v103, 1.0
v_rcp_f32 v20, v20
v_rcp_f32 v21, v21
buffer_load_dwordx4 a[120:123], v12, s[92:95], s61 offen offset:2048 sc1
s_waitcnt lgkmcnt(3)
v_mfma_f32_32x32x16_bf16 v[32:47], a[76:79], v[76:79], v[32:47]
ds_read_b128 v[72:75], v1 offset:704
v_rcp_f32 v22, v22
v_rcp_f32 v23, v23
v_fma_f32 v20, v20, -2.0, 1.0
v_fma_f32 v21, v21, -2.0, 1.0
s_waitcnt vmcnt(9) lgkmcnt(3)
v_mfma_f32_32x32x16_bf16 v[32:47], a[80:83], v[64:67], v[32:47]
ds_read_b128 v[76:79], v1 offset:736
v_fma_f32 v22, v22, -2.0, 1.0
v_fma_f32 v23, v23, -2.0, 1.0
v_cvt_pk_bf16_f32 v18, v20, v21
v_cvt_pk_bf16_f32 v19, v22, v23
ds_write_b64 v2, v[18:19] offset:38480
v_fma_f32 v116, v112, v104, 1.0
v_fma_f32 v117, v113, v105, 1.0
buffer_load_dwordx4 a[124:127], v12, s[92:95], s61 offen offset:3072 sc1
s_add_u32 s61, s61, 4096
s_and_b32 s61, s61, 0x7fff
s_waitcnt lgkmcnt(3)
v_mfma_f32_32x32x16_bf16 v[32:47], a[84:87], v[68:71], v[32:47]
ds_read_b128 v[64:67], v1 offset:768
v_fma_f32 v118, v114, v106, 1.0
v_fma_f32 v119, v115, v107, 1.0
v_rcp_f32 v116, v116
v_rcp_f32 v117, v117
buffer_load_dword v4, v28, s[40:43], 0 offen offset:640 sc1
s_waitcnt vmcnt(9) lgkmcnt(3)
v_mfma_f32_32x32x16_bf16 v[32:47], a[88:91], v[72:75], v[32:47]
ds_read_b128 v[68:71], v1 offset:800
v_rcp_f32 v118, v118
v_rcp_f32 v119, v119
v_fma_f32 v116, v116, -2.0, 1.0
v_fma_f32 v117, v117, -2.0, 1.0
s_waitcnt lgkmcnt(3)
v_mfma_f32_32x32x16_bf16 v[32:47], a[92:95], v[76:79], v[32:47]
ds_read_b128 v[72:75], v1 offset:832
v_fma_f32 v118, v118, -2.0, 1.0
v_fma_f32 v119, v119, -2.0, 1.0
v_cvt_pk_bf16_f32 v16, v116, v117
v_cvt_pk_bf16_f32 v17, v118, v119
ds_write_b64 v2, v[16:17] offset:39520
v_fma_f32 v20, v112, v108, 1.0
v_fma_f32 v21, v113, v109, 1.0
s_waitcnt vmcnt(7) lgkmcnt(3)
v_mfma_f32_32x32x16_bf16 v[32:47], a[96:99], v[64:67], v[32:47]
ds_read_b128 v[76:79], v1 offset:864
v_fma_f32 v22, v114, v110, 1.0
v_fma_f32 v23, v115, v111, 1.0
v_rcp_f32 v20, v20
v_rcp_f32 v21, v21
s_waitcnt lgkmcnt(3)
v_mfma_f32_32x32x16_bf16 v[32:47], a[100:103], v[68:71], v[32:47]
ds_read_b128 v[64:67], v1 offset:896
v_rcp_f32 v22, v22
v_rcp_f32 v23, v23
v_fma_f32 v20, v20, -2.0, 1.0
v_fma_f32 v21, v21, -2.0, 1.0
s_waitcnt vmcnt(5) lgkmcnt(3)
v_mfma_f32_32x32x16_bf16 v[32:47], a[104:107], v[72:75], v[32:47]
ds_read_b128 v[68:71], v1 offset:928
v_fma_f32 v22, v22, -2.0, 1.0
v_fma_f32 v23, v23, -2.0, 1.0
v_cvt_pk_bf16_f32 v18, v20, v21
v_cvt_pk_bf16_f32 v19, v22, v23
ds_write_b64 v2, v[18:19] offset:40560
s_waitcnt lgkmcnt(3)
v_mfma_f32_32x32x16_bf16 v[32:47], a[108:111], v[76:79], v[32:47]
ds_read_b128 v[72:75], v1 offset:960
s_waitcnt vmcnt(3) lgkmcnt(3)
v_mfma_f32_32x32x16_bf16 v[32:47], a[112:115], v[64:67], v[32:47]
ds_read_b128 v[76:79], v1 offset:992
s_waitcnt vmcnt(0)
v_cmp_eq_u32 vcc, 0, v4
s_cbranch_vccnz L_fl_49
L_fd_50:
v_cmp_lt_u32 vcc, 1, v4
s_cmp_lg_u64 vcc, 0
s_cselect_b32 s101, 1, 0
s_add_u32 s53, s99, 2048
buffer_load_dwordx2 v[24:25], v3, s[40:43], s53 offen sc1
s_add_u32 s53, s99, 6144
buffer_load_dwordx2 v[26:27], v3, s[40:43], s53 offen sc1
s_waitcnt lgkmcnt(3)
v_mfma_f32_32x32x16_bf16 v[32:47], a[116:119], v[68:71], v[32:47]
s_waitcnt lgkmcnt(1)
v_mfma_f32_32x32x16_bf16 v[32:47], a[120:123], v[72:75], v[32:47]
s_waitcnt lgkmcnt(0)
v_mfma_f32_32x32x16_bf16 v[32:47], a[124:127], v[76:79], v[32:47]
s_waitcnt lgkmcnt(0)
s_cmp_lg_u32 s101, 0
s_cbranch_scc1 L_jslow_b
s_barrier
L_p1:
ds_read_b128 v[64:67], v1 offset:33280
ds_read_b128 v[68:71], v1 offset:33312
ds_read_b128 v[72:75], v1 offset:33344
s_waitcnt lgkmcnt(2)
v_mfma_f32_32x32x16_bf16 v[48:63], a[0:3], v[64:67], 0
ds_read_b128 v[76:79], v1 offset:33376
s_mov_b32 s3, 0
s_mov_b32 s52, 16384
s_waitcnt lgkmcnt(2)
v_mfma_f32_32x32x16_bf16 v[48:63], a[4:7], v[68:71], v[48:63]
ds_read_b128 v[64:67], v1 offset:33408
s_waitcnt lgkmcnt(2)
v_mfma_f32_32x32x16_bf16 v[48:63], a[8:11], v[72:75], v[48:63]
ds_read_b128 v[68:71], v1 offset:33440
v_cvt_pk_bf16_f32 v120, v32, v33
v_cvt_pk_bf16_f32 v121, v34, v35
v_cvt_pk_bf16_f32 v122, v36, v37
v_cvt_pk_bf16_f32 v123, v38, v39
v_cvt_pk_bf16_f32 v124, v40, v41
s_waitcnt lgkmcnt(2)
v_mfma_f32_32x32x16_bf16 v[48:63], a[12:15], v[76:79], v[48:63]
ds_read_b128 v[72:75], v1 offset:33472
v_cvt_pk_bf16_f32 v125, v42, v43
v_cvt_pk_bf16_f32 v126, v44, v45
v_cvt_pk_bf16_f32 v127, v46, v47
v_permlane16_swap_b32 v120, v124
v_permlane16_swap_b32 v121, v125
s_waitcnt lgkmcnt(2)
v_mfma_f32_32x32x16_bf16 v[48:63], a[16:19], v[64:67], v[48:63]
ds_read_b128 v[76:79], v1 offset:33504
v_permlane16_swap_b32 v122, v126
v_permlane16_swap_b32 v123, v127
buffer_store_dwordx4 v[120:123], v5, s[36:39], s3 offen sc1
buffer_store_dwordx4 v[124:127], v5, s[36:39], s52 offen sc1
s_waitcnt vmcnt(2)
v_lshlrev_b32 v112, 16, v24
v_and_b32 v113, 0xffff0000, v24
v_lshlrev_b32 v114, 16, v25
v_and_b32 v115, 0xffff0000, v25
s_waitcnt lgkmcnt(2)
v_mfma_f32_32x32x16_bf16 v[48:63], a[20:23], v[68:71], v[48:63]
ds_read_b128 v[64:67], v1 offset:33536
v_mul_f32 v112, s62, v112
v_mul_f32 v113, s62, v113
v_mul_f32 v114, s62, v114
v_mul_f32 v115, s62, v115
v_exp_f32 v112, v112
s_waitcnt lgkmcnt(2)
v_mfma_f32_32x32x16_bf16 v[48:63], a[24:27], v[72:75], v[48:63]
ds_read_b128 v[68:71], v1 offset:33568
v_exp_f32 v113, v113
v_exp_f32 v114, v114
v_exp_f32 v115, v115
s_waitcnt lgkmcnt(2)
v_mfma_f32_32x32x16_bf16 v[48:63], a[28:31], v[76:79], v[48:63]
ds_read_b128 v[72:75], v1 offset:33600
v_fma_f32 v116, v112, v80, 1.0
v_fma_f32 v117, v113, v81, 1.0
v_fma_f32 v118, v114, v82, 1.0
v_fma_f32 v119, v115, v83, 1.0
v_rcp_f32 v116, v116
s_waitcnt lgkmcnt(2)
v_mfma_f32_32x32x16_bf16 v[48:63], a[32:35], v[64:67], v[48:63]
ds_read_b128 v[76:79], v1 offset:33632
v_rcp_f32 v117, v117
v_rcp_f32 v118, v118
v_rcp_f32 v119, v119
s_waitcnt lgkmcnt(2)
v_mfma_f32_32x32x16_bf16 v[48:63], a[36:39], v[68:71], v[48:63]
ds_read_b128 v[64:67], v1 offset:33664
v_fma_f32 v116, v116, -2.0, 1.0
v_fma_f32 v117, v117, -2.0, 1.0
v_fma_f32 v118, v118, -2.0, 1.0
v_fma_f32 v119, v119, -2.0, 1.0
v_cvt_pk_bf16_f32 v16, v116, v117
v_cvt_pk_bf16_f32 v17, v118, v119
ds_write_b64 v2, v[16:17] offset:0
s_waitcnt lgkmcnt(3)
v_mfma_f32_32x32x16_bf16 v[48:63], a[40:43], v[72:75], v[48:63]
ds_read_b128 v[68:71], v1 offset:33696
v_fma_f32 v20, v112, v84, 1.0
v_fma_f32 v21, v113, v85, 1.0
v_fma_f32 v22, v114, v86, 1.0
v_fma_f32 v23, v115, v87, 1.0
v_rcp_f32 v20, v20
s_waitcnt lgkmcnt(3)
v_mfma_f32_32x32x16_bf16 v[48:63], a[44:47], v[76:79], v[48:63]
ds_read_b128 v[72:75], v1 offset:33728
v_rcp_f32 v21, v21
v_rcp_f32 v22, v22
v_rcp_f32 v23, v23
s_waitcnt lgkmcnt(3)
v_mfma_f32_32x32x16_bf16 v[48:63], a[48:51], v[64:67], v[48:63]
ds_read_b128 v[76:79], v1 offset:33760
v_fma_f32 v20, v20, -2.0, 1.0
v_fma_f32 v21, v21, -2.0, 1.0
v_fma_f32 v22, v22, -2.0, 1.0
v_fma_f32 v23, v23, -2.0, 1.0
v_cvt_pk_bf16_f32 v18, v20, v21
v_cvt_pk_bf16_f32 v19, v22, v23
ds_write_b64 v2, v[18:19] offset:1040
s_waitcnt lgkmcnt(3)
v_mfma_f32_32x32x16_bf16 v[48:63], a[52:55], v[68:71], v[48:63]
ds_read_b128 v[64:67], v1 offset:33792
v_fma_f32 v116, v112, v88, 1.0
v_fma_f32 v117, v113, v89, 1.0
v_fma_f32 v118, v114, v90, 1.0
v_fma_f32 v119, v115, v91, 1.0
v_rcp_f32 v116, v116
s_waitcnt lgkmcnt(3)
v_mfma_f32_32x32x16_bf16 v[48:63], a[56:59], v[72:75], v[48:63]
ds_read_b128 v[68:71], v1 offset:33824
v_rcp_f32 v117, v117
v_rcp_f32 v118, v118
v_rcp_f32 v119, v119
s_waitcnt lgkmcnt(3)
v_mfma_f32_32x32x16_bf16 v[48:63], a[60:63], v[76:79], v[48:63]
ds_read_b128 v[72:75], v1 offset:33856
v_fma_f32 v116, v116, -2.0, 1.0
v_fma_f32 v117, v117, -2.0, 1.0
v_fma_f32 v118, v118, -2.0, 1.0
v_fma_f32 v119, v119, -2.0, 1.0
v_cvt_pk_bf16_f32 v16, v116, v117
v_cvt_pk_bf16_f32 v17, v118, v119
ds_write_b64 v2, v[16:17] offset:2080
s_waitcnt lgkmcnt(3)
v_mfma_f32_32x32x16_bf16 v[48:63], a[64:67], v[64:67], v[48:63]
ds_read_b128 v[76:79], v1 offset:33888
v_fma_f32 v20, v112, v92, 1.0
v_fma_f32 v21, v113, v93, 1.0
v_fma_f32 v22, v114, v94, 1.0
v_fma_f32 v23, v115, v95, 1.0
v_rcp_f32 v20, v20
s_waitcnt lgkmcnt(3)
v_mfma_f32_32x32x16_bf16 v[48:63], a[68:71], v[68:71], v[48:63]
ds_read_b128 v[64:67], v1 offset:33920
v_rcp_f32 v21, v21
v_rcp_f32 v22, v22
v_rcp_f32 v23, v23
s_waitcnt lgkmcnt(3)
v_mfma_f32_32x32x16_bf16 v[48:63], a[72:75], v[72:75], v[48:63]
ds_read_b128 v[68:71], v1 offset:33952
v_fma_f32 v20, v20, -2.0, 1.0
v_fma_f32 v21, v21, -2.0, 1.0
v_fma_f32 v22, v22, -2.0, 1.0
v_fma_f32 v23, v23, -2.0, 1.0
v_cvt_pk_bf16_f32 v18, v20, v21
v_cvt_pk_bf16_f32 v19, v22, v23
ds_write_b64 v2, v[18:19] offset:3120
s_waitcnt lgkmcnt(3)
v_mfma_f32_32x32x16_bf16 v[48:63], a[76:79], v[76:79], v[48:63]
ds_read_b128 v[72:75], v1 offset:33984
v_fma_f32 v116, v112, v96, 1.0
v_fma_f32 v117, v113, v97, 1.0
v_fma_f32 v118, v114, v98, 1.0
v_fma_f32 v119, v115, v99, 1.0
v_rcp_f32 v116, v116
s_waitcnt lgkmcnt(3)
v_mfma_f32_32x32x16_bf16 v[48:63], a[80:83], v[64:67], v[48:63]
ds_read_b128 v[76:79], v1 offset:34016
v_rcp_f32 v117, v117
v_rcp_f32 v118, v118
v_rcp_f32 v119, v119
s_waitcnt lgkmcnt(3)
v_mfma_f32_32x32x16_bf16 v[48:63], a[84:87], v[68:71], v[48:63]
ds_read_b128 v[64:67], v1 offset:34048
v_fma_f32 v116, v116, -2.0, 1.0
v_fma_f32 v117, v117, -2.0, 1.0
v_fma_f32 v118, v118, -2.0, 1.0
v_fma_f32 v119, v119, -2.0, 1.0
v_cvt_pk_bf16_f32 v16, v116, v117
v_cvt_pk_bf16_f32 v17, v118, v119
ds_write_b64 v2, v[16:17] offset:4160
s_waitcnt lgkmcnt(3)
v_mfma_f32_32x32x16_bf16 v[48:63], a[88:91], v[72:75], v[48:63]
ds_read_b128 v[68:71], v1 offset:34080
v_fma_f32 v20, v112, v100, 1.0
v_fma_f32 v21, v113, v101, 1.0
v_fma_f32 v22, v114, v102, 1.0
v_fma_f32 v23, v115, v103, 1.0
v_rcp_f32 v20, v20
s_waitcnt lgkmcnt(3)
v_mfma_f32_32x32x16_bf16 v[48:63], a[92:95], v[76:79], v[48:63]
ds_read_b128 v[72:75], v1 offset:34112
v_rcp_f32 v21, v21
v_rcp_f32 v22, v22
v_rcp_f32 v23, v23
s_waitcnt lgkmcnt(3)
v_mfma_f32_32x32x16_bf16 v[48:63], a[96:99], v[64:67], v[48:63]
ds_read_b128 v[76:79], v1 offset:34144
v_fma_f32 v20, v20, -2.0, 1.0
v_fma_f32 v21, v21, -2.0, 1.0
v_fma_f32 v22, v22, -2.0, 1.0
v_fma_f32 v23, v23, -2.0, 1.0
v_cvt_pk_bf16_f32 v18, v20, v21
v_cvt_pk_bf16_f32 v19, v22, v23
ds_write_b64 v2, v[18:19] offset:5200
s_waitcnt lgkmcnt(3)
v_mfma_f32_32x32x16_bf16 v[48:63], a[100:103], v[68:71], v[48:63]
ds_read_b128 v[64:67], v1 offset:34176
v_fma_f32 v116, v112, v104, 1.0
v_fma_f32 v117, v113, v105, 1.0
v_fma_f32 v118, v114, v106, 1.0
v_fma_f32 v119, v115, v107, 1.0
v_rcp_f32 v116, v116
s_waitcnt lgkmcnt(3)
v_mfma_f32_32x32x16_bf16 v[48:63], a[104:107], v[72:75], v[48:63]
ds_read_b128 v[68:71], v1 offset:34208
v_rcp_f32 v117, v117
v_rcp_f32 v118, v118
v_rcp_f32 v119, v119
s_waitcnt lgkmcnt(3)
v_mfma_f32_32x32x16_bf16 v[48:63], a[108:111], v[76:79], v[48:63]
ds_read_b128 v[72:75], v1 offset:34240
v_fma_f32 v116, v116, -2.0, 1.0
v_fma_f32 v117, v117, -2.0, 1.0
v_fma_f32 v118, v118, -2.0, 1.0
v_fma_f32 v119, v119, -2.0, 1.0
v_cvt_pk_bf16_f32 v16, v116, v117
v_cvt_pk_bf16_f32 v17, v118, v119
ds_write_b64 v2, v[16:17] offset:6240
s_waitcnt lgkmcnt(3)
v_mfma_f32_32x32x16_bf16 v[48:63], a[112:115], v[64:67], v[48:63]
ds_read_b128 v[76:79], v1 offset:34272
v_fma_f32 v20, v112, v108, 1.0
v_fma_f32 v21, v113, v109, 1.0
v_fma_f32 v22, v114, v110, 1.0
v_fma_f32 v23, v115, v111, 1.0
v_rcp_f32 v20, v20
s_waitcnt lgkmcnt(3)
v_mfma_f32_32x32x16_bf16 v[48:63], a[116:119], v[68:71], v[48:63]
v_rcp_f32 v21, v21
v_rcp_f32 v22, v22
v_rcp_f32 v23, v23
s_waitcnt lgkmcnt(2)
v_mfma_f32_32x32x16_bf16 v[48:63], a[120:123], v[72:75], v[48:63]
v_fma_f32 v20, v20, -2.0, 1.0
v_fma_f32 v21, v21, -2.0, 1.0
v_fma_f32 v22, v22, -2.0, 1.0
v_fma_f32 v23, v23, -2.0, 1.0
v_cvt_pk_bf16_f32 v18, v20, v21
v_cvt_pk_bf16_f32 v19, v22, v23
ds_write_b64 v2, v[18:19] offset:7280
s_waitcnt lgkmcnt(1)
v_mfma_f32_32x32x16_bf16 v[48:63], a[124:127], v[76:79], v[48:63]
s_waitcnt lgkmcnt(0)
s_barrier
s_or_b32 s3, s5, s4
s_or_b32 s3, s3, s6
s_cbranch_scc1 L_nwb_51
s_cmp_eq_u32 s63, 0
s_cbranch_scc1 L_nwb_51
buffer_wbl2 sc1
L_nwb_51:
ds_read_b128 v[64:67], v1 offset:0
ds_read_b128 v[68:71], v1 offset:32
ds_read_b128 v[72:75], v1 offset:64
s_waitcnt lgkmcnt(2)
v_mfma_f32_32x32x16_bf16 v[32:47], a[0:3], v[64:67], 0
ds_read_b128 v[76:79], v1 offset:96
s_mov_b32 s3, 262144
s_mov_b32 s52, 278528
v_lshlrev_b32 v112, 16, v26
v_and_b32 v113, 0xffff0000, v26
v_lshlrev_b32 v114, 16, v27
v_and_b32 v115, 0xffff0000, v27
v_mul_f32 v112, s62, v112
v_mul_f32 v113, s62, v113
s_waitcnt lgkmcnt(2)
v_mfma_f32_32x32x16_bf16 v[32:47], a[4:7], v[68:71], v[32:47]
ds_read_b128 v[64:67], v1 offset:128
v_mul_f32 v114, s62, v114
v_mul_f32 v115, s62, v115
v_exp_f32 v112, v112
v_exp_f32 v113, v113
s_waitcnt lgkmcnt(2)
v_mfma_f32_32x32x16_bf16 v[32:47], a[8:11], v[72:75], v[32:47]
ds_read_b128 v[68:71], v1 offset:160
v_cvt_pk_bf16_f32 v120, v48, v49
v_cvt_pk_bf16_f32 v121, v50, v51
v_cvt_pk_bf16_f32 v122, v52, v53
v_cvt_pk_bf16_f32 v123, v54, v55
v_cvt_pk_bf16_f32 v124, v56, v57
s_waitcnt lgkmcnt(2)
v_mfma_f32_32x32x16_bf16 v[32:47], a[12:15], v[76:79], v[32:47]
ds_read_b128 v[72:75], v1 offset:192
v_cvt_pk_bf16_f32 v125, v58, v59
v_cvt_pk_bf16_f32 v126, v60, v61
v_cvt_pk_bf16_f32 v127, v62, v63
v_permlane16_swap_b32 v120, v124
v_permlane16_swap_b32 v121, v125
s_waitcnt lgkmcnt(2)
v_mfma_f32_32x32x16_bf16 v[32:47], a[16:19], v[64:67], v[32:47]
ds_read_b128 v[76:79], v1 offset:224
v_permlane16_swap_b32 v122, v126
v_permlane16_swap_b32 v123, v127
buffer_store_dwordx4 v[120:123], v5, s[36:39], s3 offen sc1
buffer_store_dwordx4 v[124:127], v5, s[36:39], s52 offen sc1
v_exp_f32 v114, v114
v_exp_f32 v115, v115
s_waitcnt lgkmcnt(2)
v_mfma_f32_32x32x16_bf16 v[32:47], a[20:23], v[68:71], v[32:47]
ds_read_b128 v[64:67], v1 offset:256
v_fma_f32 v116, v112, v80, 1.0
v_fma_f32 v117, v113, v81, 1.0
v_fma_f32 v118, v114, v82, 1.0
v_fma_f32 v119, v115, v83, 1.0
v_rcp_f32 v116, v116
s_waitcnt lgkmcnt(2)
v_mfma_f32_32x32x16_bf16 v[32:47], a[24:27], v[72:75], v[32:47]
ds_read_b128 v[68:71], v1 offset:288
v_rcp_f32 v117, v117
v_rcp_f32 v118, v118
v_rcp_f32 v119, v119
s_waitcnt lgkmcnt(2)
v_mfma_f32_32x32x16_bf16 v[32:47], a[28:31], v[76:79], v[32:47]
ds_read_b128 v[72:75], v1 offset:320
v_fma_f32 v116, v116, -2.0, 1.0
v_fma_f32 v117, v117, -2.0, 1.0
v_fma_f32 v118, v118, -2.0, 1.0
v_fma_f32 v119, v119, -2.0, 1.0
v_cvt_pk_bf16_f32 v16, v116, v117
v_cvt_pk_bf16_f32 v17, v118, v119
ds_write_b64 v2, v[16:17] offset:33280
s_waitcnt lgkmcnt(3)
v_mfma_f32_32x32x16_bf16 v[32:47], a[32:35], v[64:67], v[32:47]
ds_read_b128 v[76:79], v1 offset:352
v_fma_f32 v20, v112, v84, 1.0
v_fma_f32 v21, v113, v85, 1.0
v_fma_f32 v22, v114, v86, 1.0
v_fma_f32 v23, v115, v87, 1.0
v_rcp_f32 v20, v20
s_waitcnt lgkmcnt(3)
v_mfma_f32_32x32x16_bf16 v[32:47], a[36:39], v[68:71], v[32:47]
ds_read_b128 v[64:67], v1 offset:384
v_rcp_f32 v21, v21
v_rcp_f32 v22, v22
v_rcp_f32 v23, v23
s_waitcnt lgkmcnt(3)
v_mfma_f32_32x32x16_bf16 v[32:47], a[40:43], v[72:75], v[32:47]
ds_read_b128 v[68:71], v1 offset:416
v_fma_f32 v20, v20, -2.0, 1.0
v_fma_f32 v21, v21, -2.0, 1.0
v_fma_f32 v22, v22, -2.0, 1.0
v_fma_f32 v23, v23, -2.0, 1.0
v_cvt_pk_bf16_f32 v18, v20, v21
v_cvt_pk_bf16_f32 v19, v22, v23
ds_write_b64 v2, v[18:19] offset:34320
s_waitcnt lgkmcnt(3)
v_mfma_f32_32x32x16_bf16 v[32:47], a[44:47], v[76:79], v[32:47]
ds_read_b128 v[72:75], v1 offset:448
v_fma_f32 v116, v112, v88, 1.0
v_fma_f32 v117, v113, v89, 1.0
v_fma_f32 v118, v114, v90, 1.0
v_fma_f32 v119, v115, v91, 1.0
v_rcp_f32 v116, v116
s_waitcnt lgkmcnt(3)
v_mfma_f32_32x32x16_bf16 v[32:47], a[48:51], v[64:67], v[32:47]
ds_read_b128 v[76:79], v1 offset:480
v_rcp_f32 v117, v117
v_rcp_f32 v118, v118
v_rcp_f32 v119, v119
s_waitcnt lgkmcnt(3)
v_mfma_f32_32x32x16_bf16 v[32:47], a[52:55], v[68:71], v[32:47]
ds_read_b128 v[64:67], v1 offset:512
v_fma_f32 v116, v116, -2.0, 1.0
v_fma_f32 v117, v117, -2.0, 1.0
v_fma_f32 v118, v118, -2.0, 1.0
v_fma_f32 v119, v119, -2.0, 1.0
v_cvt_pk_bf16_f32 v16, v116, v117
v_cvt_pk_bf16_f32 v17, v118, v119
ds_write_b64 v2, v[16:17] offset:35360
s_waitcnt lgkmcnt(3)
v_mfma_f32_32x32x16_bf16 v[32:47], a[56:59], v[72:75], v[32:47]
ds_read_b128 v[68:71], v1 offset:544
v_fma_f32 v20, v112, v92, 1.0
v_fma_f32 v21, v113, v93, 1.0
v_fma_f32 v22, v114, v94, 1.0
v_fma_f32 v23, v115, v95, 1.0
v_rcp_f32 v20, v20
s_waitcnt lgkmcnt(3)
v_mfma_f32_32x32x16_bf16 v[32:47], a[60:63], v[76:79], v[32:47]
ds_read_b128 v[72:75], v1 offset:576
v_rcp_f32 v21, v21
v_rcp_f32 v22, v22
v_rcp_f32 v23, v23
s_waitcnt lgkmcnt(3)
v_mfma_f32_32x32x16_bf16 v[32:47], a[64:67], v[64:67], v[32:47]
ds_read_b128 v[76:79], v1 offset:608
v_fma_f32 v20, v20, -2.0, 1.0
v_fma_f32 v21, v21, -2.0, 1.0
v_fma_f32 v22, v22, -2.0, 1.0
v_fma_f32 v23, v23, -2.0, 1.0
v_cvt_pk_bf16_f32 v18, v20, v21
v_cvt_pk_bf16_f32 v19, v22, v23
ds_write_b64 v2, v[18:19] offset:36400
s_waitcnt lgkmcnt(3)
v_mfma_f32_32x32x16_bf16 v[32:47], a[68:71], v[68:71], v[32:47]
ds_read_b128 v[64:67], v1 offset:640
v_fma_f32 v116, v112, v96, 1.0
v_fma_f32 v117, v113, v97, 1.0
v_fma_f32 v118, v114, v98, 1.0
v_fma_f32 v119, v115, v99, 1.0
v_rcp_f32 v116, v116
s_waitcnt lgkmcnt(3)
v_mfma_f32_32x32x16_bf16 v[32:47], a[72:75], v[72:75], v[32:47]
ds_read_b128 v[68:71], v1 offset:672
v_rcp_f32 v117, v117
v_rcp_f32 v118, v118
v_rcp_f32 v119, v119
s_waitcnt lgkmcnt(3)
v_mfma_f32_32x32x16_bf16 v[32:47], a[76:79], v[76:79], v[32:47]
ds_read_b128 v[72:75], v1 offset:704
v_fma_f32 v116, v116, -2.0, 1.0
v_fma_f32 v117, v117, -2.0, 1.0
v_fma_f32 v118, v118, -2.0, 1.0
v_fma_f32 v119, v119, -2.0, 1.0
v_cvt_pk_bf16_f32 v16, v116, v117
v_cvt_pk_bf16_f32 v17, v118, v119
ds_write_b64 v2, v[16:17] offset:37440
s_waitcnt lgkmcnt(3)
v_mfma_f32_32x32x16_bf16 v[32:47], a[80:83], v[64:67], v[32:47]
ds_read_b128 v[76:79], v1 offset:736
v_fma_f32 v20, v112, v100, 1.0
v_fma_f32 v21, v113, v101, 1.0
v_fma_f32 v22, v114, v102, 1.0
v_fma_f32 v23, v115, v103, 1.0
v_rcp_f32 v20, v20
s_waitcnt lgkmcnt(3)
v_mfma_f32_32x32x16_bf16 v[32:47], a[84:87], v[68:71], v[32:47]
ds_read_b128 v[64:67], v1 offset:768
v_rcp_f32 v21, v21
v_rcp_f32 v22, v22
v_rcp_f32 v23, v23
s_waitcnt lgkmcnt(3)
v_mfma_f32_32x32x16_bf16 v[32:47], a[88:91], v[72:75], v[32:47]
ds_read_b128 v[68:71], v1 offset:800
v_fma_f32 v20, v20, -2.0, 1.0
v_fma_f32 v21, v21, -2.0, 1.0
v_fma_f32 v22, v22, -2.0, 1.0
v_fma_f32 v23, v23, -2.0, 1.0
v_cvt_pk_bf16_f32 v18, v20, v21
v_cvt_pk_bf16_f32 v19, v22, v23
ds_write_b64 v2, v[18:19] offset:38480
s_waitcnt lgkmcnt(3)
v_mfma_f32_32x32x16_bf16 v[32:47], a[92:95], v[76:79], v[32:47]
ds_read_b128 v[72:75], v1 offset:832
v_fma_f32 v116, v112, v104, 1.0
v_fma_f32 v117, v113, v105, 1.0
v_fma_f32 v118, v114, v106, 1.0
v_fma_f32 v119, v115, v107, 1.0
v_rcp_f32 v116, v116
s_waitcnt lgkmcnt(3)
v_mfma_f32_32x32x16_bf16 v[32:47], a[96:99], v[64:67], v[32:47]
ds_read_b128 v[76:79], v1 offset:864
v_rcp_f32 v117, v117
v_rcp_f32 v118, v118
v_rcp_f32 v119, v119
s_waitcnt lgkmcnt(3)
v_mfma_f32_32x32x16_bf16 v[32:47], a[100:103], v[68:71], v[32:47]
ds_read_b128 v[64:67], v1 offset:896
v_fma_f32 v116, v116, -2.0, 1.0
v_fma_f32 v117, v117, -2.0, 1.0
v_fma_f32 v118, v118, -2.0, 1.0
v_fma_f32 v119, v119, -2.0, 1.0
v_cvt_pk_bf16_f32 v16, v116, v117
v_cvt_pk_bf16_f32 v17, v118, v119
ds_write_b64 v2, v[16:17] offset:39520
s_waitcnt lgkmcnt(3)
v_mfma_f32_32x32x16_bf16 v[32:47], a[104:107], v[72:75], v[32:47]
ds_read_b128 v[68:71], v1 offset:928
v_fma_f32 v20, v112, v108, 1.0
v_fma_f32 v21, v113, v109, 1.0
v_fma_f32 v22, v114, v110, 1.0
v_fma_f32 v23, v115, v111, 1.0
v_rcp_f32 v20, v20
s_waitcnt lgkmcnt(3)
v_mfma_f32_32x32x16_bf16 v[32:47], a[108:111], v[76:79], v[32:47]
ds_read_b128 v[72:75], v1 offset:960
v_rcp_f32 v21, v21
v_rcp_f32 v22, v22
v_rcp_f32 v23, v23
s_waitcnt lgkmcnt(3)
v_mfma_f32_32x32x16_bf16 v[32:47], a[112:115], v[64:67], v[32:47]
ds_read_b128 v[76:79], v1 offset:992
v_fma_f32 v20, v20, -2.0, 1.0
v_fma_f32 v21, v21, -2.0, 1.0
v_fma_f32 v22, v22, -2.0, 1.0
v_fma_f32 v23, v23, -2.0, 1.0
v_cvt_pk_bf16_f32 v18, v20, v21
v_cvt_pk_bf16_f32 v19, v22, v23
ds_write_b64 v2, v[18:19] offset:40560
s_waitcnt lgkmcnt(3)
v_mfma_f32_32x32x16_bf16 v[32:47], a[116:119], v[68:71], v[32:47]
s_waitcnt lgkmcnt(2)
v_mfma_f32_32x32x16_bf16 v[32:47], a[120:123], v[72:75], v[32:47]
s_waitcnt lgkmcnt(1)
v_mfma_f32_32x32x16_bf16 v[32:47], a[124:127], v[76:79], v[32:47]
s_waitcnt lgkmcnt(0)
s_barrier
ds_read_b128 v[64:67], v1 offset:33280
ds_read_b128 v[68:71], v1 offset:33312
ds_read_b128 v[72:75], v1 offset:33344
s_waitcnt lgkmcnt(2)
v_mfma_f32_32x32x16_bf16 v[48:63], a[0:3], v[64:67], 0
ds_read_b128 v[76:79], v1 offset:33376
s_mov_b32 s3, 131072
s_mov_b32 s52, 147456
s_waitcnt lgkmcnt(2)
v_mfma_f32_32x32x16_bf16 v[48:63], a[4:7], v[68:71], v[48:63]
ds_read_b128 v[64:67], v1 offset:33408
s_waitcnt lgkmcnt(2)
v_mfma_f32_32x32x16_bf16 v[48:63], a[8:11], v[72:75], v[48:63]
ds_read_b128 v[68:71], v1 offset:33440
v_cvt_pk_bf16_f32 v120, v32, v33
v_cvt_pk_bf16_f32 v121, v34, v35
v_cvt_pk_bf16_f32 v122, v36, v37
v_cvt_pk_bf16_f32 v123, v38, v39
v_cvt_pk_bf16_f32 v124, v40, v41
s_waitcnt lgkmcnt(2)
v_mfma_f32_32x32x16_bf16 v[48:63], a[12:15], v[76:79], v[48:63]
ds_read_b128 v[72:75], v1 offset:33472
v_cvt_pk_bf16_f32 v125, v42, v43
v_cvt_pk_bf16_f32 v126, v44, v45
v_cvt_pk_bf16_f32 v127, v46, v47
v_permlane16_swap_b32 v120, v124
v_permlane16_swap_b32 v121, v125
s_waitcnt lgkmcnt(2)
v_mfma_f32_32x32x16_bf16 v[48:63], a[16:19], v[64:67], v[48:63]
ds_read_b128 v[76:79], v1 offset:33504
v_permlane16_swap_b32 v122, v126
v_permlane16_swap_b32 v123, v127
buffer_store_dwordx4 v[120:123], v5, s[36:39], s3 offen sc1
buffer_store_dwordx4 v[124:127], v5, s[36:39], s52 offen sc1
s_waitcnt lgkmcnt(2)
v_mfma_f32_32x32x16_bf16 v[48:63], a[20:23], v[68:71], v[48:63]
ds_read_b128 v[64:67], v1 offset:33536
s_waitcnt lgkmcnt(2)
v_mfma_f32_32x32x16_bf16 v[48:63], a[24:27], v[72:75], v[48:63]
ds_read_b128 v[68:71], v1 offset:33568
s_waitcnt lgkmcnt(2)
v_mfma_f32_32x32x16_bf16 v[48:63], a[28:31], v[76:79], v[48:63]
ds_read_b128 v[72:75], v1 offset:33600
s_waitcnt lgkmcnt(2)
v_mfma_f32_32x32x16_bf16 v[48:63], a[32:35], v[64:67], v[48:63]
ds_read_b128 v[76:79], v1 offset:33632
s_waitcnt lgkmcnt(2)
v_mfma_f32_32x32x16_bf16 v[48:63], a[36:39], v[68:71], v[48:63]
ds_read_b128 v[64:67], v1 offset:33664
s_waitcnt lgkmcnt(2)
v_mfma_f32_32x32x16_bf16 v[48:63], a[40:43], v[72:75], v[48:63]
ds_read_b128 v[68:71], v1 offset:33696
s_waitcnt lgkmcnt(2)
v_mfma_f32_32x32x16_bf16 v[48:63], a[44:47], v[76:79], v[48:63]
ds_read_b128 v[72:75], v1 offset:33728
s_waitcnt lgkmcnt(2)
v_mfma_f32_32x32x16_bf16 v[48:63], a[48:51], v[64:67], v[48:63]
ds_read_b128 v[76:79], v1 offset:33760
s_waitcnt lgkmcnt(2)
v_mfma_f32_32x32x16_bf16 v[48:63], a[52:55], v[68:71], v[48:63]
ds_read_b128 v[64:67], v1 offset:33792
s_waitcnt lgkmcnt(2)
v_mfma_f32_32x32x16_bf16 v[48:63], a[56:59], v[72:75], v[48:63]
ds_read_b128 v[68:71], v1 offset:33824
s_waitcnt lgkmcnt(2)
v_mfma_f32_32x32x16_bf16 v[48:63], a[60:63], v[76:79], v[48:63]
ds_read_b128 v[72:75], v1 offset:33856
s_waitcnt lgkmcnt(2)
v_mfma_f32_32x32x16_bf16 v[48:63], a[64:67], v[64:67], v[48:63]
ds_read_b128 v[76:79], v1 offset:33888
s_waitcnt lgkmcnt(2)
v_mfma_f32_32x32x16_bf16 v[48:63], a[68:71], v[68:71], v[48:63]
ds_read_b128 v[64:67], v1 offset:33920
s_waitcnt lgkmcnt(2)
v_mfma_f32_32x32x16_bf16 v[48:63], a[72:75], v[72:75], v[48:63]
ds_read_b128 v[68:71], v1 offset:33952
s_waitcnt lgkmcnt(2)
v_mfma_f32_32x32x16_bf16 v[48:63], a[76:79], v[76:79], v[48:63]
ds_read_b128 v[72:75], v1 offset:33984
s_waitcnt lgkmcnt(2)
v_mfma_f32_32x32x16_bf16 v[48:63], a[80:83], v[64:67], v[48:63]
ds_read_b128 v[76:79], v1 offset:34016
s_waitcnt lgkmcnt(2)
v_mfma_f32_32x32x16_bf16 v[48:63], a[84:87], v[68:71], v[48:63]
ds_read_b128 v[64:67], v1 offset:34048
s_waitcnt lgkmcnt(2)
v_mfma_f32_32x32x16_bf16 v[48:63], a[88:91], v[72:75], v[48:63]
ds_read_b128 v[68:71], v1 offset:34080
s_waitcnt lgkmcnt(2)
v_mfma_f32_32x32x16_bf16 v[48:63], a[92:95], v[76:79], v[48:63]
ds_read_b128 v[72:75], v1 offset:34112
s_waitcnt lgkmcnt(2)
v_mfma_f32_32x32x16_bf16 v[48:63], a[96:99], v[64:67], v[48:63]
ds_read_b128 v[76:79], v1 offset:34144
s_waitcnt lgkmcnt(2)
v_mfma_f32_32x32x16_bf16 v[48:63], a[100:103], v[68:71], v[48:63]
ds_read_b128 v[64:67], v1 offset:34176
s_waitcnt lgkmcnt(2)
v_mfma_f32_32x32x16_bf16 v[48:63], a[104:107], v[72:75], v[48:63]
ds_read_b128 v[68:71], v1 offset:34208
s_waitcnt lgkmcnt(2)
v_mfma_f32_32x32x16_bf16 v[48:63], a[108:111], v[76:79], v[48:63]
ds_read_b128 v[72:75], v1 offset:34240
s_waitcnt lgkmcnt(2)
v_mfma_f32_32x32x16_bf16 v[48:63], a[112:115], v[64:67], v[48:63]
ds_read_b128 v[76:79], v1 offset:34272
s_waitcnt lgkmcnt(2)
v_mfma_f32_32x32x16_bf16 v[48:63], a[116:119], v[68:71], v[48:63]
s_waitcnt lgkmcnt(1)
v_mfma_f32_32x32x16_bf16 v[48:63], a[120:123], v[72:75], v[48:63]
s_waitcnt lgkmcnt(0)
v_mfma_f32_32x32x16_bf16 v[48:63], a[124:127], v[76:79], v[48:63]
s_waitcnt lgkmcnt(0)
s_nop 7
s_nop 3
v_cvt_pk_bf16_f32 v120, v48, v49
v_cvt_pk_bf16_f32 v121, v50, v51
v_cvt_pk_bf16_f32 v122, v52, v53
v_cvt_pk_bf16_f32 v123, v54, v55
v_cvt_pk_bf16_f32 v124, v56, v57
v_cvt_pk_bf16_f32 v125, v58, v59
v_cvt_pk_bf16_f32 v126, v60, v61
v_cvt_pk_bf16_f32 v127, v62, v63
v_permlane16_swap_b32 v120, v124
v_permlane16_swap_b32 v121, v125
v_permlane16_swap_b32 v122, v126
v_permlane16_swap_b32 v123, v127
s_mov_b32 s3, 393216
buffer_store_dwordx4 v[120:123], v5, s[36:39], s3 offen sc1
s_mov_b32 s52, 409600
buffer_store_dwordx4 v[124:127], v5, s[36:39], s52 offen sc1
s_endpgm
L_jslow_b:
s_waitcnt lgkmcnt(0)
s_mov_b32 s3, 278528
buffer_load_dwordx4 v[80:83], v13, s[40:43], s3 offen sc1
s_mov_b32 s3, 278784
buffer_load_dwordx4 v[84:87], v13, s[40:43], s3 offen sc1
s_mov_b32 s3, 279040
buffer_load_dwordx4 v[88:91], v13, s[40:43], s3 offen sc1
s_mov_b32 s3, 279296
buffer_load_dwordx4 v[92:95], v13, s[40:43], s3 offen sc1
s_mov_b32 s3, 279552
buffer_load_dwordx4 v[96:99], v13, s[40:43], s3 offen sc1
s_mov_b32 s3, 279808
buffer_load_dwordx4 v[100:103], v13, s[40:43], s3 offen sc1
s_mov_b32 s3, 280064
buffer_load_dwordx4 v[104:107], v13, s[40:43], s3 offen sc1
s_mov_b32 s3, 280320
buffer_load_dwordx4 v[108:111], v13, s[40:43], s3 offen sc1
s_waitcnt vmcnt(0)
s_barrier
s_branch L_jslow_p1
L_jslow_c:
buffer_load_dwordx4 a[0:3], v12, s[92:95], s61 offen offset:0 sc1
buffer_load_dwordx4 a[4:7], v12, s[92:95], s61 offen offset:1024 sc1
buffer_load_dwordx4 a[8:11], v12, s[92:95], s61 offen offset:2048 sc1
buffer_load_dwordx4 a[12:15], v12, s[92:95], s61 offen offset:3072 sc1
s_add_u32 s61, s61, 4096
s_and_b32 s61, s61, 0x7fff
buffer_load_dwordx4 a[16:19], v12, s[92:95], s61 offen offset:0 sc1
buffer_load_dwordx4 a[20:23], v12, s[92:95], s61 offen offset:1024 sc1
buffer_load_dwordx4 a[24:27], v12, s[92:95], s61 offen offset:2048 sc1
buffer_load_dwordx4 a[28:31], v12, s[92:95], s61 offen offset:3072 sc1
s_add_u32 s61, s61, 4096
s_and_b32 s61, s61, 0x7fff
buffer_load_dwordx4 a[32:35], v12, s[92:95], s61 offen offset:0 sc1
buffer_load_dwordx4 a[36:39], v12, s[92:95], s61 offen offset:1024 sc1
buffer_load_dwordx4 a[40:43], v12, s[92:95], s61 offen offset:2048 sc1
buffer_load_dwordx4 a[44:47], v12, s[92:95], s61 offen offset:3072 sc1
s_add_u32 s61, s61, 4096
s_and_b32 s61, s61, 0x7fff
buffer_load_dwordx4 a[48:51], v12, s[92:95], s61 offen offset:0 sc1
buffer_load_dwordx4 a[52:55], v12, s[92:95], s61 offen offset:1024 sc1
L_jslow_l:
buffer_load_dwordx4 a[56:59], v12, s[92:95], s61 offen offset:2048 sc1
buffer_load_dwordx4 a[60:63], v12, s[92:95], s61 offen offset:3072 sc1
s_add_u32 s61, s61, 4096
s_and_b32 s61, s61, 0x7fff
buffer_load_dwordx4 a[64:67], v12, s[92:95], s61 offen offset:0 sc1
buffer_load_dwordx4 a[68:71], v12, s[92:95], s61 offen offset:1024 sc1
buffer_load_dwordx4 a[72:75], v12, s[92:95], s61 offen offset:2048 sc1
buffer_load_dwordx4 a[76:79], v12, s[92:95], s61 offen offset:3072 sc1
s_add_u32 s61, s61, 4096
s_and_b32 s61, s61, 0x7fff
buffer_load_dwordx4 a[80:83], v12, s[92:95], s61 offen offset:0 sc1
buffer_load_dwordx4 a[84:87], v12, s[92:95], s61 offen offset:1024 sc1
buffer_load_dwordx4 a[88:91], v12, s[92:95], s61 offen offset:2048 sc1
buffer_load_dwordx4 a[92:95], v12, s[92:95], s61 offen offset:3072 sc1
s_add_u32 s61, s61, 4096
s_and_b32 s61, s61, 0x7fff
buffer_load_dwordx4 a[96:99], v12, s[92:95], s61 offen offset:0 sc1
buffer_load_dwordx4 a[100:103], v12, s[92:95], s61 offen offset:1024 sc1
buffer_load_dwordx4 a[104:107], v12, s[92:95], s61 offen offset:2048 sc1
buffer_load_dwordx4 a[108:111], v12, s[92:95], s61 offen offset:3072 sc1
s_add_u32 s61, s61, 4096
s_and_b32 s61, s61, 0x7fff
buffer_load_dwordx4 a[112:115], v12, s[92:95], s61 offen offset:0 sc1
buffer_load_dwordx4 a[116:119], v12, s[92:95], s61 offen offset:1024 sc1
buffer_load_dwordx4 a[120:123], v12, s[92:95], s61 offen offset:2048 sc1
buffer_load_dwordx4 a[124:127], v12, s[92:95], s61 offen offset:3072 sc1
s_add_u32 s61, s61, 4096
s_and_b32 s61, s61, 0x7fff
s_waitcnt lgkmcnt(0)
s_mov_b32 s3, 278528
buffer_load_dwordx4 v[80:83], v13, s[40:43], s3 offen sc1
s_mov_b32 s3, 278784
buffer_load_dwordx4 v[84:87], v13, s[40:43], s3 offen sc1
s_mov_b32 s3, 279040
buffer_load_dwordx4 v[88:91], v13, s[40:43], s3 offen sc1
s_mov_b32 s3, 279296
buffer_load_dwordx4 v[92:95], v13, s[40:43], s3 offen sc1
s_mov_b32 s3, 279552
buffer_load_dwordx4 v[96:99], v13, s[40:43], s3 offen sc1
s_mov_b32 s3, 279808
buffer_load_dwordx4 v[100:103], v13, s[40:43], s3 offen sc1
s_mov_b32 s3, 280064
buffer_load_dwordx4 v[104:107], v13, s[40:43], s3 offen sc1
s_mov_b32 s3, 280320
buffer_load_dwordx4 v[108:111], v13, s[40:43], s3 offen sc1
s_waitcnt vmcnt(0)
v_lshlrev_b32 v112, 16, v8
v_and_b32 v113, 0xffff0000, v8
v_lshlrev_b32 v114, 16, v9
v_and_b32 v115, 0xffff0000, v9
v_mul_f32 v112, s62, v112
v_mul_f32 v113, s62, v113
v_mul_f32 v114, s62, v114
v_mul_f32 v115, s62, v115
v_add_f32 v116, v112, v80
v_add_f32 v117, v113, v81
v_add_f32 v118, v114, v82
v_add_f32 v119, v115, v83
v_exp_f32 v116, v116
v_exp_f32 v117, v117
v_exp_f32 v118, v118
v_exp_f32 v119, v119
v_add_f32 v116, 1.0, v116
v_add_f32 v117, 1.0, v117
v_add_f32 v118, 1.0, v118
v_add_f32 v119, 1.0, v119
v_rcp_f32 v116, v116
v_rcp_f32 v117, v117
v_rcp_f32 v118, v118
v_rcp_f32 v119, v119
v_fma_f32 v116, v116, -2.0, 1.0
v_fma_f32 v117, v117, -2.0, 1.0
v_fma_f32 v118, v118, -2.0, 1.0
v_fma_f32 v119, v119, -2.0, 1.0
v_cvt_pk_bf16_f32 v16, v116, v117
v_cvt_pk_bf16_f32 v17, v118, v119
ds_write_b64 v2, v[16:17] offset:0
v_add_f32 v20, v112, v84
v_add_f32 v21, v113, v85
v_add_f32 v22, v114, v86
v_add_f32 v23, v115, v87
v_exp_f32 v20, v20
v_exp_f32 v21, v21
v_exp_f32 v22, v22
v_exp_f32 v23, v23
v_add_f32 v20, 1.0, v20
v_add_f32 v21, 1.0, v21
v_add_f32 v22, 1.0, v22
v_add_f32 v23, 1.0, v23
v_rcp_f32 v20, v20
v_rcp_f32 v21, v21
v_rcp_f32 v22, v22
v_rcp_f32 v23, v23
v_fma_f32 v20, v20, -2.0, 1.0
v_fma_f32 v21, v21, -2.0, 1.0
v_fma_f32 v22, v22, -2.0, 1.0
v_fma_f32 v23, v23, -2.0, 1.0
v_cvt_pk_bf16_f32 v18, v20, v21
v_cvt_pk_bf16_f32 v19, v22, v23
ds_write_b64 v2, v[18:19] offset:1040
v_add_f32 v116, v112, v88
v_add_f32 v117, v113, v89
v_add_f32 v118, v114, v90
v_add_f32 v119, v115, v91
v_exp_f32 v116, v116
v_exp_f32 v117, v117
v_exp_f32 v118, v118
v_exp_f32 v119, v119
v_add_f32 v116, 1.0, v116
v_add_f32 v117, 1.0, v117
v_add_f32 v118, 1.0, v118
v_add_f32 v119, 1.0, v119
v_rcp_f32 v116, v116
v_rcp_f32 v117, v117
v_rcp_f32 v118, v118
v_rcp_f32 v119, v119
v_fma_f32 v116, v116, -2.0, 1.0
v_fma_f32 v117, v117, -2.0, 1.0
v_fma_f32 v118, v118, -2.0, 1.0
v_fma_f32 v119, v119, -2.0, 1.0
v_cvt_pk_bf16_f32 v16, v116, v117
v_cvt_pk_bf16_f32 v17, v118, v119
ds_write_b64 v2, v[16:17] offset:2080
v_add_f32 v20, v112, v92
v_add_f32 v21, v113, v93
v_add_f32 v22, v114, v94
v_add_f32 v23, v115, v95
v_exp_f32 v20, v20
v_exp_f32 v21, v21
v_exp_f32 v22, v22
v_exp_f32 v23, v23
v_add_f32 v20, 1.0, v20
v_add_f32 v21, 1.0, v21
v_add_f32 v22, 1.0, v22
v_add_f32 v23, 1.0, v23
v_rcp_f32 v20, v20
v_rcp_f32 v21, v21
v_rcp_f32 v22, v22
v_rcp_f32 v23, v23
v_fma_f32 v20, v20, -2.0, 1.0
v_fma_f32 v21, v21, -2.0, 1.0
v_fma_f32 v22, v22, -2.0, 1.0
v_fma_f32 v23, v23, -2.0, 1.0
v_cvt_pk_bf16_f32 v18, v20, v21
v_cvt_pk_bf16_f32 v19, v22, v23
ds_write_b64 v2, v[18:19] offset:3120
v_add_f32 v116, v112, v96
v_add_f32 v117, v113, v97
v_add_f32 v118, v114, v98
v_add_f32 v119, v115, v99
v_exp_f32 v116, v116
v_exp_f32 v117, v117
v_exp_f32 v118, v118
v_exp_f32 v119, v119
v_add_f32 v116, 1.0, v116
v_add_f32 v117, 1.0, v117
v_add_f32 v118, 1.0, v118
v_add_f32 v119, 1.0, v119
v_rcp_f32 v116, v116
v_rcp_f32 v117, v117
v_rcp_f32 v118, v118
v_rcp_f32 v119, v119
v_fma_f32 v116, v116, -2.0, 1.0
v_fma_f32 v117, v117, -2.0, 1.0
v_fma_f32 v118, v118, -2.0, 1.0
v_fma_f32 v119, v119, -2.0, 1.0
v_cvt_pk_bf16_f32 v16, v116, v117
v_cvt_pk_bf16_f32 v17, v118, v119
ds_write_b64 v2, v[16:17] offset:4160
v_add_f32 v20, v112, v100
v_add_f32 v21, v113, v101
v_add_f32 v22, v114, v102
v_add_f32 v23, v115, v103
v_exp_f32 v20, v20
v_exp_f32 v21, v21
v_exp_f32 v22, v22
v_exp_f32 v23, v23
v_add_f32 v20, 1.0, v20
v_add_f32 v21, 1.0, v21
v_add_f32 v22, 1.0, v22
v_add_f32 v23, 1.0, v23
v_rcp_f32 v20, v20
v_rcp_f32 v21, v21
v_rcp_f32 v22, v22
v_rcp_f32 v23, v23
v_fma_f32 v20, v20, -2.0, 1.0
v_fma_f32 v21, v21, -2.0, 1.0
v_fma_f32 v22, v22, -2.0, 1.0
v_fma_f32 v23, v23, -2.0, 1.0
v_cvt_pk_bf16_f32 v18, v20, v21
v_cvt_pk_bf16_f32 v19, v22, v23
ds_write_b64 v2, v[18:19] offset:5200
v_add_f32 v116, v112, v104
v_add_f32 v117, v113, v105
v_add_f32 v118, v114, v106
v_add_f32 v119, v115, v107
v_exp_f32 v116, v116
v_exp_f32 v117, v117
v_exp_f32 v118, v118
v_exp_f32 v119, v119
v_add_f32 v116, 1.0, v116
v_add_f32 v117, 1.0, v117
v_add_f32 v118, 1.0, v118
v_add_f32 v119, 1.0, v119
v_rcp_f32 v116, v116
v_rcp_f32 v117, v117
v_rcp_f32 v118, v118
v_rcp_f32 v119, v119
v_fma_f32 v116, v116, -2.0, 1.0
v_fma_f32 v117, v117, -2.0, 1.0
v_fma_f32 v118, v118, -2.0, 1.0
v_fma_f32 v119, v119, -2.0, 1.0
v_cvt_pk_bf16_f32 v16, v116, v117
v_cvt_pk_bf16_f32 v17, v118, v119
ds_write_b64 v2, v[16:17] offset:6240
v_add_f32 v20, v112, v108
v_add_f32 v21, v113, v109
v_add_f32 v22, v114, v110
v_add_f32 v23, v115, v111
v_exp_f32 v20, v20
v_exp_f32 v21, v21
v_exp_f32 v22, v22
v_exp_f32 v23, v23
v_add_f32 v20, 1.0, v20
v_add_f32 v21, 1.0, v21
v_add_f32 v22, 1.0, v22
v_add_f32 v23, 1.0, v23
v_rcp_f32 v20, v20
v_rcp_f32 v21, v21
v_rcp_f32 v22, v22
v_rcp_f32 v23, v23
v_fma_f32 v20, v20, -2.0, 1.0
v_fma_f32 v21, v21, -2.0, 1.0
v_fma_f32 v22, v22, -2.0, 1.0
v_fma_f32 v23, v23, -2.0, 1.0
v_cvt_pk_bf16_f32 v18, v20, v21
v_cvt_pk_bf16_f32 v19, v22, v23
ds_write_b64 v2, v[18:19] offset:7280
s_waitcnt lgkmcnt(0)
s_barrier
ds_read_b128 v[64:67], v1 offset:0
ds_read_b128 v[68:71], v1 offset:32
ds_read_b128 v[72:75], v1 offset:64
s_waitcnt lgkmcnt(2)
v_mfma_f32_32x32x16_bf16 v[32:47], a[0:3], v[64:67], 0
ds_read_b128 v[76:79], v1 offset:96
v_lshlrev_b32 v112, 16, v10
v_and_b32 v113, 0xffff0000, v10
v_lshlrev_b32 v114, 16, v11
v_and_b32 v115, 0xffff0000, v11
v_mul_f32 v112, s62, v112
v_mul_f32 v113, s62, v113
v_mul_f32 v114, s62, v114
v_mul_f32 v115, s62, v115
v_add_f32 v116, v112, v80
s_waitcnt lgkmcnt(2)
v_mfma_f32_32x32x16_bf16 v[32:47], a[4:7], v[68:71], v[32:47]
ds_read_b128 v[64:67], v1 offset:128
v_add_f32 v117, v113, v81
v_add_f32 v118, v114, v82
v_add_f32 v119, v115, v83
v_exp_f32 v116, v116
v_exp_f32 v117, v117
v_exp_f32 v118, v118
s_waitcnt lgkmcnt(2)
v_mfma_f32_32x32x16_bf16 v[32:47], a[8:11], v[72:75], v[32:47]
ds_read_b128 v[68:71], v1 offset:160
v_exp_f32 v119, v119
v_add_f32 v116, 1.0, v116
v_add_f32 v117, 1.0, v117
v_add_f32 v118, 1.0, v118
v_add_f32 v119, 1.0, v119
v_rcp_f32 v116, v116
v_add_f32 v20, v112, v84
s_waitcnt lgkmcnt(2)
v_mfma_f32_32x32x16_bf16 v[32:47], a[12:15], v[76:79], v[32:47]
ds_read_b128 v[72:75], v1 offset:192
v_rcp_f32 v117, v117
v_rcp_f32 v118, v118
v_rcp_f32 v119, v119
v_fma_f32 v116, v116, -2.0, 1.0
v_fma_f32 v117, v117, -2.0, 1.0
v_fma_f32 v118, v118, -2.0, 1.0
s_waitcnt lgkmcnt(2)
v_mfma_f32_32x32x16_bf16 v[32:47], a[16:19], v[64:67], v[32:47]
ds_read_b128 v[76:79], v1 offset:224
v_fma_f32 v119, v119, -2.0, 1.0
v_cvt_pk_bf16_f32 v16, v116, v117
v_cvt_pk_bf16_f32 v17, v118, v119
ds_write_b64 v2, v[16:17] offset:33280
v_add_f32 v21, v113, v85
v_add_f32 v22, v114, v86
v_add_f32 v23, v115, v87
v_exp_f32 v20, v20
v_add_f32 v116, v112, v88
s_waitcnt lgkmcnt(3)
v_mfma_f32_32x32x16_bf16 v[32:47], a[20:23], v[68:71], v[32:47]
ds_read_b128 v[64:67], v1 offset:256
v_exp_f32 v21, v21
v_exp_f32 v22, v22
v_exp_f32 v23, v23
v_add_f32 v20, 1.0, v20
v_add_f32 v21, 1.0, v21
v_add_f32 v22, 1.0, v22
s_waitcnt lgkmcnt(3)
v_mfma_f32_32x32x16_bf16 v[32:47], a[24:27], v[72:75], v[32:47]
ds_read_b128 v[68:71], v1 offset:288
v_add_f32 v23, 1.0, v23
v_rcp_f32 v20, v20
v_rcp_f32 v21, v21
v_rcp_f32 v22, v22
v_rcp_f32 v23, v23
s_waitcnt lgkmcnt(3)
v_mfma_f32_32x32x16_bf16 v[32:47], a[28:31], v[76:79], v[32:47]
ds_read_b128 v[72:75], v1 offset:320
v_fma_f32 v20, v20, -2.0, 1.0
v_fma_f32 v21, v21, -2.0, 1.0
v_fma_f32 v22, v22, -2.0, 1.0
v_fma_f32 v23, v23, -2.0, 1.0
v_cvt_pk_bf16_f32 v18, v20, v21
v_cvt_pk_bf16_f32 v19, v22, v23
ds_write_b64 v2, v[18:19] offset:34320
v_add_f32 v117, v113, v89
v_add_f32 v118, v114, v90
v_add_f32 v119, v115, v91
s_waitcnt lgkmcnt(3)
v_mfma_f32_32x32x16_bf16 v[32:47], a[32:35], v[64:67], v[32:47]
ds_read_b128 v[76:79], v1 offset:352
v_exp_f32 v116, v116
v_exp_f32 v117, v117
v_exp_f32 v118, v118
v_exp_f32 v119, v119
v_add_f32 v116, 1.0, v116
s_waitcnt lgkmcnt(3)
v_mfma_f32_32x32x16_bf16 v[32:47], a[36:39], v[68:71], v[32:47]
ds_read_b128 v[64:67], v1 offset:384
v_add_f32 v117, 1.0, v117
v_add_f32 v118, 1.0, v118
v_add_f32 v119, 1.0, v119
v_rcp_f32 v116, v116
v_rcp_f32 v117, v117
v_rcp_f32 v118, v118
s_waitcnt lgkmcnt(3)
v_mfma_f32_32x32x16_bf16 v[32:47], a[40:43], v[72:75], v[32:47]
ds_read_b128 v[68:71], v1 offset:416
v_rcp_f32 v119, v119
v_fma_f32 v116, v116, -2.0, 1.0
v_fma_f32 v117, v117, -2.0, 1.0
v_fma_f32 v118, v118, -2.0, 1.0
v_fma_f32 v119, v119, -2.0, 1.0
v_cvt_pk_bf16_f32 v16, v116, v117
v_cvt_pk_bf16_f32 v17, v118, v119
ds_write_b64 v2, v[16:17] offset:35360
v_add_f32 v20, v112, v92
s_waitcnt lgkmcnt(3)
v_mfma_f32_32x32x16_bf16 v[32:47], a[44:47], v[76:79], v[32:47]
ds_read_b128 v[72:75], v1 offset:448
v_add_f32 v21, v113, v93
v_add_f32 v22, v114, v94
v_add_f32 v23, v115, v95
v_exp_f32 v20, v20
v_exp_f32 v21, v21
v_exp_f32 v22, v22
s_waitcnt lgkmcnt(3)
v_mfma_f32_32x32x16_bf16 v[32:47], a[48:51], v[64:67], v[32:47]
ds_read_b128 v[76:79], v1 offset:480
v_exp_f32 v23, v23
v_add_f32 v20, 1.0, v20
v_add_f32 v21, 1.0, v21
v_add_f32 v22, 1.0, v22
v_add_f32 v23, 1.0, v23
v_rcp_f32 v20, v20
v_add_f32 v116, v112, v96
s_waitcnt lgkmcnt(3)
v_mfma_f32_32x32x16_bf16 v[32:47], a[52:55], v[68:71], v[32:47]
ds_read_b128 v[64:67], v1 offset:512
v_rcp_f32 v21, v21
v_rcp_f32 v22, v22
v_rcp_f32 v23, v23
v_fma_f32 v20, v20, -2.0, 1.0
v_fma_f32 v21, v21, -2.0, 1.0
v_fma_f32 v22, v22, -2.0, 1.0
s_waitcnt lgkmcnt(2)
v_mfma_f32_32x32x16_bf16 v[32:47], a[56:59], v[72:75], v[32:47]
ds_read_b128 v[68:71], v1 offset:544
v_fma_f32 v23, v23, -2.0, 1.0
v_cvt_pk_bf16_f32 v18, v20, v21
v_cvt_pk_bf16_f32 v19, v22, v23
ds_write_b64 v2, v[18:19] offset:36400
v_add_f32 v117, v113, v97
v_add_f32 v118, v114, v98
v_add_f32 v119, v115, v99
v_exp_f32 v116, v116
v_add_f32 v20, v112, v100
s_waitcnt lgkmcnt(3)
v_mfma_f32_32x32x16_bf16 v[32:47], a[60:63], v[76:79], v[32:47]
ds_read_b128 v[72:75], v1 offset:576
v_exp_f32 v117, v117
v_exp_f32 v118, v118
v_exp_f32 v119, v119
v_add_f32 v116, 1.0, v116
v_add_f32 v117, 1.0, v117
v_add_f32 v118, 1.0, v118
s_waitcnt lgkmcnt(3)
v_mfma_f32_32x32x16_bf16 v[32:47], a[64:67], v[64:67], v[32:47]
ds_read_b128 v[76:79], v1 offset:608
v_add_f32 v119, 1.0, v119
v_rcp_f32 v116, v116
v_rcp_f32 v117, v117
v_rcp_f32 v118, v118
v_rcp_f32 v119, v119
s_waitcnt lgkmcnt(3)
v_mfma_f32_32x32x16_bf16 v[32:47], a[68:71], v[68:71], v[32:47]
ds_read_b128 v[64:67], v1 offset:640
v_fma_f32 v116, v116, -2.0, 1.0
v_fma_f32 v117, v117, -2.0, 1.0
v_fma_f32 v118, v118, -2.0, 1.0
v_fma_f32 v119, v119, -2.0, 1.0
v_cvt_pk_bf16_f32 v16, v116, v117
v_cvt_pk_bf16_f32 v17, v118, v119
ds_write_b64 v2, v[16:17] offset:37440
v_add_f32 v21, v113, v101
v_add_f32 v22, v114, v102
v_add_f32 v23, v115, v103
s_waitcnt lgkmcnt(3)
v_mfma_f32_32x32x16_bf16 v[32:47], a[72:75], v[72:75], v[32:47]
ds_read_b128 v[68:71], v1 offset:672
v_exp_f32 v20, v20
v_exp_f32 v21, v21
v_exp_f32 v22, v22
v_exp_f32 v23, v23
v_add_f32 v20, 1.0, v20
s_waitcnt lgkmcnt(3)
v_mfma_f32_32x32x16_bf16 v[32:47], a[76:79], v[76:79], v[32:47]
ds_read_b128 v[72:75], v1 offset:704
v_add_f32 v21, 1.0, v21
v_add_f32 v22, 1.0, v22
v_add_f32 v23, 1.0, v23
v_rcp_f32 v20, v20
v_rcp_f32 v21, v21
v_rcp_f32 v22, v22
s_waitcnt lgkmcnt(3)
v_mfma_f32_32x32x16_bf16 v[32:47], a[80:83], v[64:67], v[32:47]
ds_read_b128 v[76:79], v1 offset:736
v_rcp_f32 v23, v23
v_fma_f32 v20, v20, -2.0, 1.0
v_fma_f32 v21, v21, -2.0, 1.0
v_fma_f32 v22, v22, -2.0, 1.0
v_fma_f32 v23, v23, -2.0, 1.0
v_cvt_pk_bf16_f32 v18, v20, v21
v_cvt_pk_bf16_f32 v19, v22, v23
ds_write_b64 v2, v[18:19] offset:38480
v_add_f32 v116, v112, v104
s_waitcnt lgkmcnt(3)
v_mfma_f32_32x32x16_bf16 v[32:47], a[84:87], v[68:71], v[32:47]
ds_read_b128 v[64:67], v1 offset:768
v_add_f32 v117, v113, v105
v_add_f32 v118, v114, v106
v_add_f32 v119, v115, v107
v_exp_f32 v116, v116
v_exp_f32 v117, v117
v_exp_f32 v118, v118
buffer_load_dword v4, v28, s[40:43], 0 offen offset:640 sc1
s_waitcnt lgkmcnt(3)
v_mfma_f32_32x32x16_bf16 v[32:47], a[88:91], v[72:75], v[32:47]
ds_read_b128 v[68:71], v1 offset:800
v_exp_f32 v119, v119
v_add_f32 v116, 1.0, v116
v_add_f32 v117, 1.0, v117
v_add_f32 v118, 1.0, v118
v_add_f32 v119, 1.0, v119
v_rcp_f32 v116, v116
v_add_f32 v20, v112, v108
s_waitcnt lgkmcnt(3)
v_mfma_f32_32x32x16_bf16 v[32:47], a[92:95], v[76:79], v[32:47]
ds_read_b128 v[72:75], v1 offset:832
v_rcp_f32 v117, v117
v_rcp_f32 v118, v118
v_rcp_f32 v119, v119
v_fma_f32 v116, v116, -2.0, 1.0
v_fma_f32 v117, v117, -2.0, 1.0
v_fma_f32 v118, v118, -2.0, 1.0
s_waitcnt lgkmcnt(2)
v_mfma_f32_32x32x16_bf16 v[32:47], a[96:99], v[64:67], v[32:47]
ds_read_b128 v[76:79], v1 offset:864
v_fma_f32 v119, v119, -2.0, 1.0
v_cvt_pk_bf16_f32 v16, v116, v117
v_cvt_pk_bf16_f32 v17, v118, v119
ds_write_b64 v2, v[16:17] offset:39520
v_add_f32 v21, v113, v109
v_add_f32 v22, v114, v110
v_add_f32 v23, v115, v111
v_exp_f32 v20, v20
s_waitcnt lgkmcnt(3)
v_mfma_f32_32x32x16_bf16 v[32:47], a[100:103], v[68:71], v[32:47]
ds_read_b128 v[64:67], v1 offset:896
v_exp_f32 v21, v21
v_exp_f32 v22, v22
v_exp_f32 v23, v23
v_add_f32 v20, 1.0, v20
v_add_f32 v21, 1.0, v21
v_add_f32 v22, 1.0, v22
s_waitcnt lgkmcnt(3)
v_mfma_f32_32x32x16_bf16 v[32:47], a[104:107], v[72:75], v[32:47]
ds_read_b128 v[68:71], v1 offset:928
v_add_f32 v23, 1.0, v23
v_rcp_f32 v20, v20
v_rcp_f32 v21, v21
v_rcp_f32 v22, v22
v_rcp_f32 v23, v23
s_waitcnt lgkmcnt(3)
v_mfma_f32_32x32x16_bf16 v[32:47], a[108:111], v[76:79], v[32:47]
ds_read_b128 v[72:75], v1 offset:960
v_fma_f32 v20, v20, -2.0, 1.0
v_fma_f32 v21, v21, -2.0, 1.0
v_fma_f32 v22, v22, -2.0, 1.0
v_fma_f32 v23, v23, -2.0, 1.0
v_cvt_pk_bf16_f32 v18, v20, v21
v_cvt_pk_bf16_f32 v19, v22, v23
ds_write_b64 v2, v[18:19] offset:40560
s_waitcnt lgkmcnt(3)
v_mfma_f32_32x32x16_bf16 v[32:47], a[112:115], v[64:67], v[32:47]
ds_read_b128 v[76:79], v1 offset:992
s_waitcnt vmcnt(0)
v_cmp_eq_u32 vcc, 0, v4
s_cbranch_vccnz L_fl_52
L_fd_53:
v_cmp_lt_u32 vcc, 1, v4
s_cmp_lg_u64 vcc, 0
s_cselect_b32 s101, 1, 0
s_add_u32 s53, s99, 2048
buffer_load_dwordx2 v[24:25], v3, s[40:43], s53 offen sc1
s_add_u32 s53, s99, 6144
buffer_load_dwordx2 v[26:27], v3, s[40:43], s53 offen sc1
s_waitcnt lgkmcnt(3)
v_mfma_f32_32x32x16_bf16 v[32:47], a[116:119], v[68:71], v[32:47]
s_waitcnt lgkmcnt(2)
v_mfma_f32_32x32x16_bf16 v[32:47], a[120:123], v[72:75], v[32:47]
s_waitcnt lgkmcnt(0)
v_mfma_f32_32x32x16_bf16 v[32:47], a[124:127], v[76:79], v[32:47]
s_waitcnt lgkmcnt(0)
s_barrier
L_jslow_p1:
ds_read_b128 v[64:67], v1 offset:33280
ds_read_b128 v[68:71], v1 offset:33312
ds_read_b128 v[72:75], v1 offset:33344
s_waitcnt lgkmcnt(2)
v_mfma_f32_32x32x16_bf16 v[48:63], a[0:3], v[64:67], 0
ds_read_b128 v[76:79], v1 offset:33376
s_mov_b32 s3, 0
s_mov_b32 s52, 16384
s_waitcnt lgkmcnt(2)
v_mfma_f32_32x32x16_bf16 v[48:63], a[4:7], v[68:71], v[48:63]
ds_read_b128 v[64:67], v1 offset:33408
s_waitcnt lgkmcnt(2)
v_mfma_f32_32x32x16_bf16 v[48:63], a[8:11], v[72:75], v[48:63]
ds_read_b128 v[68:71], v1 offset:33440
v_cvt_pk_bf16_f32 v120, v32, v33
v_cvt_pk_bf16_f32 v121, v34, v35
v_cvt_pk_bf16_f32 v122, v36, v37
v_cvt_pk_bf16_f32 v123, v38, v39
v_cvt_pk_bf16_f32 v124, v40, v41
v_cvt_pk_bf16_f32 v125, v42, v43
v_cvt_pk_bf16_f32 v126, v44, v45
s_waitcnt lgkmcnt(2)
v_mfma_f32_32x32x16_bf16 v[48:63], a[12:15], v[76:79], v[48:63]
ds_read_b128 v[72:75], v1 offset:33472
v_cvt_pk_bf16_f32 v127, v46, v47
v_permlane16_swap_b32 v120, v124
v_permlane16_swap_b32 v121, v125
v_permlane16_swap_b32 v122, v126
v_permlane16_swap_b32 v123, v127
buffer_store_dwordx4 v[120:123], v5, s[36:39], s3 offen sc1
buffer_store_dwordx4 v[124:127], v5, s[36:39], s52 offen sc1
s_waitcnt vmcnt(2)
v_lshlrev_b32 v112, 16, v24
v_and_b32 v113, 0xffff0000, v24
v_lshlrev_b32 v114, 16, v25
v_and_b32 v115, 0xffff0000, v25
s_waitcnt lgkmcnt(2)
v_mfma_f32_32x32x16_bf16 v[48:63], a[16:19], v[64:67], v[48:63]
ds_read_b128 v[76:79], v1 offset:33504
v_mul_f32 v112, s62, v112
v_mul_f32 v113, s62, v113
v_mul_f32 v114, s62, v114
v_mul_f32 v115, s62, v115
v_add_f32 v116, v112, v80
v_add_f32 v117, v113, v81
v_add_f32 v118, v114, v82
v_add_f32 v119, v115, v83
v_add_f32 v20, v112, v84
s_waitcnt lgkmcnt(2)
v_mfma_f32_32x32x16_bf16 v[48:63], a[20:23], v[68:71], v[48:63]
ds_read_b128 v[64:67], v1 offset:33536
v_exp_f32 v116, v116
v_exp_f32 v117, v117
v_exp_f32 v118, v118
v_exp_f32 v119, v119
v_add_f32 v116, 1.0, v116
s_waitcnt lgkmcnt(2)
v_mfma_f32_32x32x16_bf16 v[48:63], a[24:27], v[72:75], v[48:63]
ds_read_b128 v[68:71], v1 offset:33568
v_add_f32 v117, 1.0, v117
v_add_f32 v118, 1.0, v118
v_add_f32 v119, 1.0, v119
v_rcp_f32 v116, v116
v_rcp_f32 v117, v117
v_rcp_f32 v118, v118
s_waitcnt lgkmcnt(2)
v_mfma_f32_32x32x16_bf16 v[48:63], a[28:31], v[76:79], v[48:63]
ds_read_b128 v[72:75], v1 offset:33600
v_rcp_f32 v119, v119
v_fma_f32 v116, v116, -2.0, 1.0
v_fma_f32 v117, v117, -2.0, 1.0
v_fma_f32 v118, v118, -2.0, 1.0
v_fma_f32 v119, v119, -2.0, 1.0
v_cvt_pk_bf16_f32 v16, v116, v117
v_cvt_pk_bf16_f32 v17, v118, v119
ds_write_b64 v2, v[16:17] offset:0
v_add_f32 v21, v113, v85
s_waitcnt lgkmcnt(3)
v_mfma_f32_32x32x16_bf16 v[48:63], a[32:35], v[64:67], v[48:63]
ds_read_b128 v[76:79], v1 offset:33632
v_add_f32 v22, v114, v86
v_add_f32 v23, v115, v87
v_exp_f32 v20, v20
v_exp_f32 v21, v21
v_exp_f32 v22, v22
v_add_f32 v20, 1.0, v20
s_waitcnt lgkmcnt(3)
v_mfma_f32_32x32x16_bf16 v[48:63], a[36:39], v[68:71], v[48:63]
ds_read_b128 v[64:67], v1 offset:33664
v_exp_f32 v23, v23
v_add_f32 v21, 1.0, v21
v_add_f32 v22, 1.0, v22
v_add_f32 v23, 1.0, v23
v_rcp_f32 v20, v20
v_rcp_f32 v21, v21
s_waitcnt lgkmcnt(3)
v_mfma_f32_32x32x16_bf16 v[48:63], a[40:43], v[72:75], v[48:63]
ds_read_b128 v[68:71], v1 offset:33696
v_rcp_f32 v22, v22
v_rcp_f32 v23, v23
v_fma_f32 v20, v20, -2.0, 1.0
v_fma_f32 v21, v21, -2.0, 1.0
v_fma_f32 v22, v22, -2.0, 1.0
v_fma_f32 v23, v23, -2.0, 1.0
v_cvt_pk_bf16_f32 v18, v20, v21
s_waitcnt lgkmcnt(2)
v_mfma_f32_32x32x16_bf16 v[48:63], a[44:47], v[76:79], v[48:63]
ds_read_b128 v[72:75], v1 offset:33728
v_cvt_pk_bf16_f32 v19, v22, v23
ds_write_b64 v2, v[18:19] offset:1040
v_add_f32 v116, v112, v88
v_add_f32 v117, v113, v89
v_add_f32 v118, v114, v90
v_add_f32 v119, v115, v91
v_exp_f32 v116, v116
v_exp_f32 v117, v117
s_waitcnt lgkmcnt(3)
v_mfma_f32_32x32x16_bf16 v[48:63], a[48:51], v[64:67], v[48:63]
ds_read_b128 v[76:79], v1 offset:33760
v_exp_f32 v118, v118
v_exp_f32 v119, v119
v_add_f32 v116, 1.0, v116
v_add_f32 v117, 1.0, v117
v_add_f32 v118, 1.0, v118
v_add_f32 v119, 1.0, v119
v_add_f32 v20, v112, v92
s_waitcnt lgkmcnt(3)
v_mfma_f32_32x32x16_bf16 v[48:63], a[52:55], v[68:71], v[48:63]
ds_read_b128 v[64:67], v1 offset:33792
v_rcp_f32 v116, v116
v_rcp_f32 v117, v117
v_rcp_f32 v118, v118
v_rcp_f32 v119, v119
v_fma_f32 v116, v116, -2.0, 1.0
s_waitcnt lgkmcnt(3)
v_mfma_f32_32x32x16_bf16 v[48:63], a[56:59], v[72:75], v[48:63]
ds_read_b128 v[68:71], v1 offset:33824
v_fma_f32 v117, v117, -2.0, 1.0
v_fma_f32 v118, v118, -2.0, 1.0
v_fma_f32 v119, v119, -2.0, 1.0
v_cvt_pk_bf16_f32 v16, v116, v117
v_cvt_pk_bf16_f32 v17, v118, v119
ds_write_b64 v2, v[16:17] offset:2080
v_add_f32 v21, v113, v93
v_add_f32 v22, v114, v94
v_add_f32 v23, v115, v95
v_add_f32 v116, v112, v96
s_waitcnt lgkmcnt(3)
v_mfma_f32_32x32x16_bf16 v[48:63], a[60:63], v[76:79], v[48:63]
ds_read_b128 v[72:75], v1 offset:33856
v_exp_f32 v20, v20
v_exp_f32 v21, v21
v_exp_f32 v22, v22
v_exp_f32 v23, v23
v_add_f32 v20, 1.0, v20
s_waitcnt lgkmcnt(3)
v_mfma_f32_32x32x16_bf16 v[48:63], a[64:67], v[64:67], v[48:63]
ds_read_b128 v[76:79], v1 offset:33888
v_add_f32 v21, 1.0, v21
v_add_f32 v22, 1.0, v22
v_add_f32 v23, 1.0, v23
v_rcp_f32 v20, v20
v_rcp_f32 v21, v21
v_rcp_f32 v22, v22
s_waitcnt lgkmcnt(3)
v_mfma_f32_32x32x16_bf16 v[48:63], a[68:71], v[68:71], v[48:63]
ds_read_b128 v[64:67], v1 offset:33920
v_rcp_f32 v23, v23
v_fma_f32 v20, v20, -2.0, 1.0
v_fma_f32 v21, v21, -2.0, 1.0
v_fma_f32 v22, v22, -2.0, 1.0
v_fma_f32 v23, v23, -2.0, 1.0
v_cvt_pk_bf16_f32 v18, v20, v21
v_cvt_pk_bf16_f32 v19, v22, v23
ds_write_b64 v2, v[18:19] offset:3120
v_add_f32 v117, v113, v97
s_waitcnt lgkmcnt(3)
v_mfma_f32_32x32x16_bf16 v[48:63], a[72:75], v[72:75], v[48:63]
ds_read_b128 v[68:71], v1 offset:33952
v_add_f32 v118, v114, v98
v_add_f32 v119, v115, v99
v_exp_f32 v116, v116
v_exp_f32 v117, v117
v_exp_f32 v118, v118
v_add_f32 v116, 1.0, v116
s_waitcnt lgkmcnt(3)
v_mfma_f32_32x32x16_bf16 v[48:63], a[76:79], v[76:79], v[48:63]
ds_read_b128 v[72:75], v1 offset:33984
v_exp_f32 v119, v119
v_add_f32 v117, 1.0, v117
v_add_f32 v118, 1.0, v118
v_add_f32 v119, 1.0, v119
v_rcp_f32 v116, v116
v_rcp_f32 v117, v117
s_waitcnt lgkmcnt(3)
v_mfma_f32_32x32x16_bf16 v[48:63], a[80:83], v[64:67], v[48:63]
ds_read_b128 v[76:79], v1 offset:34016
v_rcp_f32 v118, v118
v_rcp_f32 v119, v119
v_fma_f32 v116, v116, -2.0, 1.0
v_fma_f32 v117, v117, -2.0, 1.0
v_fma_f32 v118, v118, -2.0, 1.0
v_fma_f32 v119, v119, -2.0, 1.0
v_cvt_pk_bf16_f32 v16, v116, v117
s_waitcnt lgkmcnt(2)
v_mfma_f32_32x32x16_bf16 v[48:63], a[84:87], v[68:71], v[48:63]
ds_read_b128 v[64:67], v1 offset:34048
v_cvt_pk_bf16_f32 v17, v118, v119
ds_write_b64 v2, v[16:17] offset:4160
v_add_f32 v20, v112, v100
v_add_f32 v21, v113, v101
v_add_f32 v22, v114, v102
v_add_f32 v23, v115, v103
v_exp_f32 v20, v20
v_exp_f32 v21, v21
s_waitcnt lgkmcnt(3)
v_mfma_f32_32x32x16_bf16 v[48:63], a[88:91], v[72:75], v[48:63]
ds_read_b128 v[68:71], v1 offset:34080
v_exp_f32 v22, v22
v_exp_f32 v23, v23
v_add_f32 v20, 1.0, v20
v_add_f32 v21, 1.0, v21
v_add_f32 v22, 1.0, v22
v_add_f32 v23, 1.0, v23
v_add_f32 v116, v112, v104
s_waitcnt lgkmcnt(3)
v_mfma_f32_32x32x16_bf16 v[48:63], a[92:95], v[76:79], v[48:63]
ds_read_b128 v[72:75], v1 offset:34112
v_rcp_f32 v20, v20
v_rcp_f32 v21, v21
v_rcp_f32 v22, v22
v_rcp_f32 v23, v23
v_fma_f32 v20, v20, -2.0, 1.0
s_waitcnt lgkmcnt(3)
v_mfma_f32_32x32x16_bf16 v[48:63], a[96:99], v[64:67], v[48:63]
ds_read_b128 v[76:79], v1 offset:34144
v_fma_f32 v21, v21, -2.0, 1.0
v_fma_f32 v22, v22, -2.0, 1.0
v_fma_f32 v23, v23, -2.0, 1.0
v_cvt_pk_bf16_f32 v18, v20, v21
v_cvt_pk_bf16_f32 v19, v22, v23
ds_write_b64 v2, v[18:19] offset:5200
v_add_f32 v117, v113, v105
v_add_f32 v118, v114, v106
v_add_f32 v119, v115, v107
v_add_f32 v20, v112, v108
s_waitcnt lgkmcnt(3)
v_mfma_f32_32x32x16_bf16 v[48:63], a[100:103], v[68:71], v[48:63]
ds_read_b128 v[64:67], v1 offset:34176
v_exp_f32 v116, v116
v_exp_f32 v117, v117
v_exp_f32 v118, v118
v_exp_f32 v119, v119
v_add_f32 v116, 1.0, v116
s_waitcnt lgkmcnt(3)
v_mfma_f32_32x32x16_bf16 v[48:63], a[104:107], v[72:75], v[48:63]
ds_read_b128 v[68:71], v1 offset:34208
v_add_f32 v117, 1.0, v117
v_add_f32 v118, 1.0, v118
v_add_f32 v119, 1.0, v119
v_rcp_f32 v116, v116
v_rcp_f32 v117, v117
v_rcp_f32 v118, v118
s_waitcnt lgkmcnt(3)
v_mfma_f32_32x32x16_bf16 v[48:63], a[108:111], v[76:79], v[48:63]
ds_read_b128 v[72:75], v1 offset:34240
v_rcp_f32 v119, v119
v_fma_f32 v116, v116, -2.0, 1.0
v_fma_f32 v117, v117, -2.0, 1.0
v_fma_f32 v118, v118, -2.0, 1.0
v_fma_f32 v119, v119, -2.0, 1.0
v_cvt_pk_bf16_f32 v16, v116, v117
v_cvt_pk_bf16_f32 v17, v118, v119
ds_write_b64 v2, v[16:17] offset:6240
v_add_f32 v21, v113, v109
s_waitcnt lgkmcnt(3)
v_mfma_f32_32x32x16_bf16 v[48:63], a[112:115], v[64:67], v[48:63]
ds_read_b128 v[76:79], v1 offset:34272
v_add_f32 v22, v114, v110
v_add_f32 v23, v115, v111
v_exp_f32 v20, v20
v_exp_f32 v21, v21
v_exp_f32 v22, v22
v_add_f32 v20, 1.0, v20
s_waitcnt lgkmcnt(3)
v_mfma_f32_32x32x16_bf16 v[48:63], a[116:119], v[68:71], v[48:63]
v_exp_f32 v23, v23
v_add_f32 v21, 1.0, v21
v_add_f32 v22, 1.0, v22
v_add_f32 v23, 1.0, v23
v_rcp_f32 v20, v20
v_rcp_f32 v21, v21
s_waitcnt lgkmcnt(2)
v_mfma_f32_32x32x16_bf16 v[48:63], a[120:123], v[72:75], v[48:63]
v_rcp_f32 v22, v22
v_rcp_f32 v23, v23
v_fma_f32 v20, v20, -2.0, 1.0
v_fma_f32 v21, v21, -2.0, 1.0
v_fma_f32 v22, v22, -2.0, 1.0
v_fma_f32 v23, v23, -2.0, 1.0
v_cvt_pk_bf16_f32 v18, v20, v21
s_waitcnt lgkmcnt(0)
v_mfma_f32_32x32x16_bf16 v[48:63], a[124:127], v[76:79], v[48:63]
v_cvt_pk_bf16_f32 v19, v22, v23
ds_write_b64 v2, v[18:19] offset:7280
s_waitcnt lgkmcnt(0)
s_barrier
ds_read_b128 v[64:67], v1 offset:0
ds_read_b128 v[68:71], v1 offset:32
ds_read_b128 v[72:75], v1 offset:64
s_waitcnt lgkmcnt(2)
v_mfma_f32_32x32x16_bf16 v[32:47], a[0:3], v[64:67], 0
ds_read_b128 v[76:79], v1 offset:96
s_mov_b32 s3, 262144
s_mov_b32 s52, 278528
v_lshlrev_b32 v112, 16, v26
v_and_b32 v113, 0xffff0000, v26
v_lshlrev_b32 v114, 16, v27
v_and_b32 v115, 0xffff0000, v27
v_mul_f32 v112, s62, v112
v_mul_f32 v113, s62, v113
v_mul_f32 v114, s62, v114
v_mul_f32 v115, s62, v115
v_add_f32 v116, v112, v80
s_waitcnt lgkmcnt(2)
v_mfma_f32_32x32x16_bf16 v[32:47], a[4:7], v[68:71], v[32:47]
ds_read_b128 v[64:67], v1 offset:128
v_add_f32 v117, v113, v81
v_add_f32 v118, v114, v82
v_add_f32 v119, v115, v83
v_exp_f32 v116, v116
v_exp_f32 v117, v117
v_exp_f32 v118, v118
s_waitcnt lgkmcnt(2)
v_mfma_f32_32x32x16_bf16 v[32:47], a[8:11], v[72:75], v[32:47]
ds_read_b128 v[68:71], v1 offset:160
v_cvt_pk_bf16_f32 v120, v48, v49
v_cvt_pk_bf16_f32 v121, v50, v51
v_cvt_pk_bf16_f32 v122, v52, v53
v_cvt_pk_bf16_f32 v123, v54, v55
v_cvt_pk_bf16_f32 v124, v56, v57
v_cvt_pk_bf16_f32 v125, v58, v59
v_cvt_pk_bf16_f32 v126, v60, v61
s_waitcnt lgkmcnt(2)
v_mfma_f32_32x32x16_bf16 v[32:47], a[12:15], v[76:79], v[32:47]
ds_read_b128 v[72:75], v1 offset:192
v_cvt_pk_bf16_f32 v127, v62, v63
v_permlane16_swap_b32 v120, v124
v_permlane16_swap_b32 v121, v125
v_permlane16_swap_b32 v122, v126
v_permlane16_swap_b32 v123, v127
buffer_store_dwordx4 v[120:123], v5, s[36:39], s3 offen sc1
buffer_store_dwordx4 v[124:127], v5, s[36:39], s52 offen sc1
v_exp_f32 v119, v119
v_add_f32 v116, 1.0, v116
v_add_f32 v117, 1.0, v117
s_waitcnt lgkmcnt(2)
v_mfma_f32_32x32x16_bf16 v[32:47], a[16:19], v[64:67], v[32:47]
ds_read_b128 v[76:79], v1 offset:224
v_add_f32 v118, 1.0, v118
v_add_f32 v119, 1.0, v119
v_rcp_f32 v116, v116
v_rcp_f32 v117, v117
v_rcp_f32 v118, v118
v_fma_f32 v116, v116, -2.0, 1.0
s_waitcnt lgkmcnt(2)
v_mfma_f32_32x32x16_bf16 v[32:47], a[20:23], v[68:71], v[32:47]
ds_read_b128 v[64:67], v1 offset:256
v_rcp_f32 v119, v119
v_fma_f32 v117, v117, -2.0, 1.0
v_fma_f32 v118, v118, -2.0, 1.0
v_fma_f32 v119, v119, -2.0, 1.0
v_cvt_pk_bf16_f32 v16, v116, v117
v_cvt_pk_bf16_f32 v17, v118, v119
ds_write_b64 v2, v[16:17] offset:33280
v_add_f32 v20, v112, v84
v_add_f32 v21, v113, v85
s_waitcnt lgkmcnt(3)
v_mfma_f32_32x32x16_bf16 v[32:47], a[24:27], v[72:75], v[32:47]
ds_read_b128 v[68:71], v1 offset:288
v_add_f32 v22, v114, v86
v_add_f32 v23, v115, v87
v_exp_f32 v20, v20
v_exp_f32 v21, v21
v_exp_f32 v22, v22
v_add_f32 v20, 1.0, v20
s_waitcnt lgkmcnt(3)
v_mfma_f32_32x32x16_bf16 v[32:47], a[28:31], v[76:79], v[32:47]
ds_read_b128 v[72:75], v1 offset:320
v_exp_f32 v23, v23
v_add_f32 v21, 1.0, v21
v_add_f32 v22, 1.0, v22
v_add_f32 v23, 1.0, v23
v_rcp_f32 v20, v20
v_rcp_f32 v21, v21
s_waitcnt lgkmcnt(3)
v_mfma_f32_32x32x16_bf16 v[32:47], a[32:35], v[64:67], v[32:47]
ds_read_b128 v[76:79], v1 offset:352
v_rcp_f32 v22, v22
v_rcp_f32 v23, v23
v_fma_f32 v20, v20, -2.0, 1.0
v_fma_f32 v21, v21, -2.0, 1.0
v_fma_f32 v22, v22, -2.0, 1.0
v_fma_f32 v23, v23, -2.0, 1.0
v_cvt_pk_bf16_f32 v18, v20, v21
s_waitcnt lgkmcnt(2)
v_mfma_f32_32x32x16_bf16 v[32:47], a[36:39], v[68:71], v[32:47]
ds_read_b128 v[64:67], v1 offset:384
v_cvt_pk_bf16_f32 v19, v22, v23
ds_write_b64 v2, v[18:19] offset:34320
v_add_f32 v116, v112, v88
v_add_f32 v117, v113, v89
v_add_f32 v118, v114, v90
v_add_f32 v119, v115, v91
v_exp_f32 v116, v116
v_exp_f32 v117, v117
s_waitcnt lgkmcnt(3)
v_mfma_f32_32x32x16_bf16 v[32:47], a[40:43], v[72:75], v[32:47]
ds_read_b128 v[68:71], v1 offset:416
v_exp_f32 v118, v118
v_exp_f32 v119, v119
v_add_f32 v116, 1.0, v116
v_add_f32 v117, 1.0, v117
v_add_f32 v118, 1.0, v118
v_add_f32 v119, 1.0, v119
v_add_f32 v20, v112, v92
s_waitcnt lgkmcnt(3)
v_mfma_f32_32x32x16_bf16 v[32:47], a[44:47], v[76:79], v[32:47]
ds_read_b128 v[72:75], v1 offset:448
v_rcp_f32 v116, v116
v_rcp_f32 v117, v117
v_rcp_f32 v118, v118
v_rcp_f32 v119, v119
v_fma_f32 v116, v116, -2.0, 1.0
s_waitcnt lgkmcnt(3)
v_mfma_f32_32x32x16_bf16 v[32:47], a[48:51], v[64:67], v[32:47]
ds_read_b128 v[76:79], v1 offset:480
v_fma_f32 v117, v117, -2.0, 1.0
v_fma_f32 v118, v118, -2.0, 1.0
v_fma_f32 v119, v119, -2.0, 1.0
v_cvt_pk_bf16_f32 v16, v116, v117
v_cvt_pk_bf16_f32 v17, v118, v119
ds_write_b64 v2, v[16:17] offset:35360
v_add_f32 v21, v113, v93
v_add_f32 v22, v114, v94
v_add_f32 v23, v115, v95
v_add_f32 v116, v112, v96
s_waitcnt lgkmcnt(3)
v_mfma_f32_32x32x16_bf16 v[32:47], a[52:55], v[68:71], v[32:47]
ds_read_b128 v[64:67], v1 offset:512
v_exp_f32 v20, v20
v_exp_f32 v21, v21
v_exp_f32 v22, v22
v_exp_f32 v23, v23
v_add_f32 v20, 1.0, v20
s_waitcnt lgkmcnt(3)
v_mfma_f32_32x32x16_bf16 v[32:47], a[56:59], v[72:75], v[32:47]
ds_read_b128 v[68:71], v1 offset:544
v_add_f32 v21, 1.0, v21
v_add_f32 v22, 1.0, v22
v_add_f32 v23, 1.0, v23
v_rcp_f32 v20, v20
v_rcp_f32 v21, v21
v_rcp_f32 v22, v22
s_waitcnt lgkmcnt(3)
v_mfma_f32_32x32x16_bf16 v[32:47], a[60:63], v[76:79], v[32:47]
ds_read_b128 v[72:75], v1 offset:576
v_rcp_f32 v23, v23
v_fma_f32 v20, v20, -2.0, 1.0
v_fma_f32 v21, v21, -2.0, 1.0
v_fma_f32 v22, v22, -2.0, 1.0
v_fma_f32 v23, v23, -2.0, 1.0
v_cvt_pk_bf16_f32 v18, v20, v21
v_cvt_pk_bf16_f32 v19, v22, v23
ds_write_b64 v2, v[18:19] offset:36400
v_add_f32 v117, v113, v97
s_waitcnt lgkmcnt(3)
v_mfma_f32_32x32x16_bf16 v[32:47], a[64:67], v[64:67], v[32:47]
ds_read_b128 v[76:79], v1 offset:608
v_add_f32 v118, v114, v98
v_add_f32 v119, v115, v99
v_exp_f32 v116, v116
v_exp_f32 v117, v117
v_exp_f32 v118, v118
v_add_f32 v116, 1.0, v116
s_waitcnt lgkmcnt(3)
v_mfma_f32_32x32x16_bf16 v[32:47], a[68:71], v[68:71], v[32:47]
ds_read_b128 v[64:67], v1 offset:640
v_exp_f32 v119, v119
v_add_f32 v117, 1.0, v117
v_add_f32 v118, 1.0, v118
v_add_f32 v119, 1.0, v119
v_rcp_f32 v116, v116
v_rcp_f32 v117, v117
s_waitcnt lgkmcnt(3)
v_mfma_f32_32x32x16_bf16 v[32:47], a[72:75], v[72:75], v[32:47]
ds_read_b128 v[68:71], v1 offset:672
v_rcp_f32 v118, v118
v_rcp_f32 v119, v119
v_fma_f32 v116, v116, -2.0, 1.0
v_fma_f32 v117, v117, -2.0, 1.0
v_fma_f32 v118, v118, -2.0, 1.0
v_fma_f32 v119, v119, -2.0, 1.0
v_cvt_pk_bf16_f32 v16, v116, v117
s_waitcnt lgkmcnt(2)
v_mfma_f32_32x32x16_bf16 v[32:47], a[76:79], v[76:79], v[32:47]
ds_read_b128 v[72:75], v1 offset:704
v_cvt_pk_bf16_f32 v17, v118, v119
ds_write_b64 v2, v[16:17] offset:37440
v_add_f32 v20, v112, v100
v_add_f32 v21, v113, v101
v_add_f32 v22, v114, v102
v_add_f32 v23, v115, v103
v_exp_f32 v20, v20
v_exp_f32 v21, v21
s_waitcnt lgkmcnt(3)
v_mfma_f32_32x32x16_bf16 v[32:47], a[80:83], v[64:67], v[32:47]
ds_read_b128 v[76:79], v1 offset:736
v_exp_f32 v22, v22
v_exp_f32 v23, v23
v_add_f32 v20, 1.0, v20
v_add_f32 v21, 1.0, v21
v_add_f32 v22, 1.0, v22
v_add_f32 v23, 1.0, v23
v_add_f32 v116, v112, v104
s_waitcnt lgkmcnt(3)
v_mfma_f32_32x32x16_bf16 v[32:47], a[84:87], v[68:71], v[32:47]
ds_read_b128 v[64:67], v1 offset:768
v_rcp_f32 v20, v20
v_rcp_f32 v21, v21
v_rcp_f32 v22, v22
v_rcp_f32 v23, v23
v_fma_f32 v20, v20, -2.0, 1.0
s_waitcnt lgkmcnt(3)
v_mfma_f32_32x32x16_bf16 v[32:47], a[88:91], v[72:75], v[32:47]
ds_read_b128 v[68:71], v1 offset:800
v_fma_f32 v21, v21, -2.0, 1.0
v_fma_f32 v22, v22, -2.0, 1.0
v_fma_f32 v23, v23, -2.0, 1.0
v_cvt_pk_bf16_f32 v18, v20, v21
v_cvt_pk_bf16_f32 v19, v22, v23
ds_write_b64 v2, v[18:19] offset:38480
v_add_f32 v117, v113, v105
v_add_f32 v118, v114, v106
v_add_f32 v119, v115, v107
v_add_f32 v20, v112, v108
s_waitcnt lgkmcnt(3)
v_mfma_f32_32x32x16_bf16 v[32:47], a[92:95], v[76:79], v[32:47]
ds_read_b128 v[72:75], v1 offset:832
v_exp_f32 v116, v116
v_exp_f32 v117, v117
v_exp_f32 v118, v118
v_exp_f32 v119, v119
v_add_f32 v116, 1.0, v116
s_waitcnt lgkmcnt(3)
v_mfma_f32_32x32x16_bf16 v[32:47], a[96:99], v[64:67], v[32:47]
ds_read_b128 v[76:79], v1 offset:864
v_add_f32 v117, 1.0, v117
v_add_f32 v118, 1.0, v118
v_add_f32 v119, 1.0, v119
v_rcp_f32 v116, v116
v_rcp_f32 v117, v117
v_rcp_f32 v118, v118
s_waitcnt lgkmcnt(3)
v_mfma_f32_32x32x16_bf16 v[32:47], a[100:103], v[68:71], v[32:47]
ds_read_b128 v[64:67], v1 offset:896
v_rcp_f32 v119, v119
v_fma_f32 v116, v116, -2.0, 1.0
v_fma_f32 v117, v117, -2.0, 1.0
v_fma_f32 v118, v118, -2.0, 1.0
v_fma_f32 v119, v119, -2.0, 1.0
v_cvt_pk_bf16_f32 v16, v116, v117
v_cvt_pk_bf16_f32 v17, v118, v119
ds_write_b64 v2, v[16:17] offset:39520
v_add_f32 v21, v113, v109
s_waitcnt lgkmcnt(3)
v_mfma_f32_32x32x16_bf16 v[32:47], a[104:107], v[72:75], v[32:47]
ds_read_b128 v[68:71], v1 offset:928
v_add_f32 v22, v114, v110
v_add_f32 v23, v115, v111
v_exp_f32 v20, v20
v_exp_f32 v21, v21
v_exp_f32 v22, v22
v_add_f32 v20, 1.0, v20
s_waitcnt lgkmcnt(3)
v_mfma_f32_32x32x16_bf16 v[32:47], a[108:111], v[76:79], v[32:47]
ds_read_b128 v[72:75], v1 offset:960
v_exp_f32 v23, v23
v_add_f32 v21, 1.0, v21
v_add_f32 v22, 1.0, v22
v_add_f32 v23, 1.0, v23
v_rcp_f32 v20, v20
v_rcp_f32 v21, v21
s_waitcnt lgkmcnt(3)
v_mfma_f32_32x32x16_bf16 v[32:47], a[112:115], v[64:67], v[32:47]
ds_read_b128 v[76:79], v1 offset:992
v_rcp_f32 v22, v22
v_rcp_f32 v23, v23
v_fma_f32 v20, v20, -2.0, 1.0
v_fma_f32 v21, v21, -2.0, 1.0
v_fma_f32 v22, v22, -2.0, 1.0
v_fma_f32 v23, v23, -2.0, 1.0
v_cvt_pk_bf16_f32 v18, v20, v21
s_waitcnt lgkmcnt(2)
v_mfma_f32_32x32x16_bf16 v[32:47], a[116:119], v[68:71], v[32:47]
v_cvt_pk_bf16_f32 v19, v22, v23
ds_write_b64 v2, v[18:19] offset:40560
s_waitcnt lgkmcnt(2)
v_mfma_f32_32x32x16_bf16 v[32:47], a[120:123], v[72:75], v[32:47]
s_waitcnt lgkmcnt(1)
v_mfma_f32_32x32x16_bf16 v[32:47], a[124:127], v[76:79], v[32:47]
s_waitcnt lgkmcnt(0)
s_barrier
ds_read_b128 v[64:67], v1 offset:33280
ds_read_b128 v[68:71], v1 offset:33312
ds_read_b128 v[72:75], v1 offset:33344
s_waitcnt lgkmcnt(2)
v_mfma_f32_32x32x16_bf16 v[48:63], a[0:3], v[64:67], 0
ds_read_b128 v[76:79], v1 offset:33376
s_mov_b32 s3, 131072
s_mov_b32 s52, 147456
s_waitcnt lgkmcnt(2)
v_mfma_f32_32x32x16_bf16 v[48:63], a[4:7], v[68:71], v[48:63]
ds_read_b128 v[64:67], v1 offset:33408
s_waitcnt lgkmcnt(2)
v_mfma_f32_32x32x16_bf16 v[48:63], a[8:11], v[72:75], v[48:63]
ds_read_b128 v[68:71], v1 offset:33440
v_cvt_pk_bf16_f32 v120, v32, v33
v_cvt_pk_bf16_f32 v121, v34, v35
v_cvt_pk_bf16_f32 v122, v36, v37
v_cvt_pk_bf16_f32 v123, v38, v39
v_cvt_pk_bf16_f32 v124, v40, v41
v_cvt_pk_bf16_f32 v125, v42, v43
v_cvt_pk_bf16_f32 v126, v44, v45
s_waitcnt lgkmcnt(2)
v_mfma_f32_32x32x16_bf16 v[48:63], a[12:15], v[76:79], v[48:63]
ds_read_b128 v[72:75], v1 offset:33472
v_cvt_pk_bf16_f32 v127, v46, v47
v_permlane16_swap_b32 v120, v124
v_permlane16_swap_b32 v121, v125
v_permlane16_swap_b32 v122, v126
v_permlane16_swap_b32 v123, v127
buffer_store_dwordx4 v[120:123], v5, s[36:39], s3 offen sc1
buffer_store_dwordx4 v[124:127], v5, s[36:39], s52 offen sc1
s_waitcnt lgkmcnt(2)
v_mfma_f32_32x32x16_bf16 v[48:63], a[16:19], v[64:67], v[48:63]
ds_read_b128 v[76:79], v1 offset:33504
s_waitcnt lgkmcnt(2)
v_mfma_f32_32x32x16_bf16 v[48:63], a[20:23], v[68:71], v[48:63]
ds_read_b128 v[64:67], v1 offset:33536
s_waitcnt lgkmcnt(2)
v_mfma_f32_32x32x16_bf16 v[48:63], a[24:27], v[72:75], v[48:63]
ds_read_b128 v[68:71], v1 offset:33568
s_waitcnt lgkmcnt(2)
v_mfma_f32_32x32x16_bf16 v[48:63], a[28:31], v[76:79], v[48:63]
ds_read_b128 v[72:75], v1 offset:33600
s_waitcnt lgkmcnt(2)
v_mfma_f32_32x32x16_bf16 v[48:63], a[32:35], v[64:67], v[48:63]
ds_read_b128 v[76:79], v1 offset:33632
s_waitcnt lgkmcnt(2)
v_mfma_f32_32x32x16_bf16 v[48:63], a[36:39], v[68:71], v[48:63]
ds_read_b128 v[64:67], v1 offset:33664
s_waitcnt lgkmcnt(2)
v_mfma_f32_32x32x16_bf16 v[48:63], a[40:43], v[72:75], v[48:63]
ds_read_b128 v[68:71], v1 offset:33696
s_waitcnt lgkmcnt(2)
v_mfma_f32_32x32x16_bf16 v[48:63], a[44:47], v[76:79], v[48:63]
ds_read_b128 v[72:75], v1 offset:33728
s_waitcnt lgkmcnt(2)
v_mfma_f32_32x32x16_bf16 v[48:63], a[48:51], v[64:67], v[48:63]
ds_read_b128 v[76:79], v1 offset:33760
s_waitcnt lgkmcnt(2)
v_mfma_f32_32x32x16_bf16 v[48:63], a[52:55], v[68:71], v[48:63]
ds_read_b128 v[64:67], v1 offset:33792
s_waitcnt lgkmcnt(2)
v_mfma_f32_32x32x16_bf16 v[48:63], a[56:59], v[72:75], v[48:63]
ds_read_b128 v[68:71], v1 offset:33824
s_waitcnt lgkmcnt(2)
v_mfma_f32_32x32x16_bf16 v[48:63], a[60:63], v[76:79], v[48:63]
ds_read_b128 v[72:75], v1 offset:33856
s_waitcnt lgkmcnt(2)
v_mfma_f32_32x32x16_bf16 v[48:63], a[64:67], v[64:67], v[48:63]
ds_read_b128 v[76:79], v1 offset:33888
s_waitcnt lgkmcnt(2)
v_mfma_f32_32x32x16_bf16 v[48:63], a[68:71], v[68:71], v[48:63]
ds_read_b128 v[64:67], v1 offset:33920
s_waitcnt lgkmcnt(2)
v_mfma_f32_32x32x16_bf16 v[48:63], a[72:75], v[72:75], v[48:63]
ds_read_b128 v[68:71], v1 offset:33952
s_waitcnt lgkmcnt(2)
v_mfma_f32_32x32x16_bf16 v[48:63], a[76:79], v[76:79], v[48:63]
ds_read_b128 v[72:75], v1 offset:33984
s_waitcnt lgkmcnt(2)
v_mfma_f32_32x32x16_bf16 v[48:63], a[80:83], v[64:67], v[48:63]
ds_read_b128 v[76:79], v1 offset:34016
s_waitcnt lgkmcnt(2)
v_mfma_f32_32x32x16_bf16 v[48:63], a[84:87], v[68:71], v[48:63]
ds_read_b128 v[64:67], v1 offset:34048
s_waitcnt lgkmcnt(2)
v_mfma_f32_32x32x16_bf16 v[48:63], a[88:91], v[72:75], v[48:63]
ds_read_b128 v[68:71], v1 offset:34080
s_waitcnt lgkmcnt(2)
v_mfma_f32_32x32x16_bf16 v[48:63], a[92:95], v[76:79], v[48:63]
ds_read_b128 v[72:75], v1 offset:34112
s_waitcnt lgkmcnt(2)
v_mfma_f32_32x32x16_bf16 v[48:63], a[96:99], v[64:67], v[48:63]
ds_read_b128 v[76:79], v1 offset:34144
s_waitcnt lgkmcnt(2)
v_mfma_f32_32x32x16_bf16 v[48:63], a[100:103], v[68:71], v[48:63]
ds_read_b128 v[64:67], v1 offset:34176
s_waitcnt lgkmcnt(2)
v_mfma_f32_32x32x16_bf16 v[48:63], a[104:107], v[72:75], v[48:63]
ds_read_b128 v[68:71], v1 offset:34208
s_waitcnt lgkmcnt(2)
v_mfma_f32_32x32x16_bf16 v[48:63], a[108:111], v[76:79], v[48:63]
ds_read_b128 v[72:75], v1 offset:34240
s_waitcnt lgkmcnt(2)
v_mfma_f32_32x32x16_bf16 v[48:63], a[112:115], v[64:67], v[48:63]
ds_read_b128 v[76:79], v1 offset:34272
s_waitcnt lgkmcnt(2)
v_mfma_f32_32x32x16_bf16 v[48:63], a[116:119], v[68:71], v[48:63]
s_waitcnt lgkmcnt(1)
v_mfma_f32_32x32x16_bf16 v[48:63], a[120:123], v[72:75], v[48:63]
s_waitcnt lgkmcnt(0)
v_mfma_f32_32x32x16_bf16 v[48:63], a[124:127], v[76:79], v[48:63]
s_waitcnt lgkmcnt(0)
s_nop 7
s_nop 3
v_cvt_pk_bf16_f32 v120, v48, v49
v_cvt_pk_bf16_f32 v121, v50, v51
v_cvt_pk_bf16_f32 v122, v52, v53
v_cvt_pk_bf16_f32 v123, v54, v55
v_cvt_pk_bf16_f32 v124, v56, v57
v_cvt_pk_bf16_f32 v125, v58, v59
v_cvt_pk_bf16_f32 v126, v60, v61
v_cvt_pk_bf16_f32 v127, v62, v63
v_permlane16_swap_b32 v120, v124
v_permlane16_swap_b32 v121, v125
v_permlane16_swap_b32 v122, v126
v_permlane16_swap_b32 v123, v127
s_mov_b32 s3, 393216
buffer_store_dwordx4 v[120:123], v5, s[36:39], s3 offen sc1
s_mov_b32 s52, 409600
buffer_store_dwordx4 v[124:127], v5, s[36:39], s52 offen sc1
s_endpgm
L_fb_late:
s_waitcnt vmcnt(0)
s_barrier
s_mov_b32 s57, 0
L_poll_9001:
    buffer_load_dword v4, v28, s[40:43], 0 offen offset:512 sc1
    s_add_u32 s57, s57, 1
    s_cmp_gt_u32 s57, 200000
    s_cbranch_scc1 L_got_9002
    s_waitcnt vmcnt(0)
    v_cmp_eq_u32 vcc, 0, v4
    s_cbranch_vccnz L_poll_9001
L_got_9002:
    s_waitcnt vmcnt(0)
s_add_u32 s53, s100, 1
s_and_b32 s53, s53, 7
s_add_u32 m0, s96, 24576
s_lshl_b32 s3, s53, 13
s_add_u32 s3, s3, 131072
buffer_load_dwordx4 v24, s[40:43], s3 offen offset:2048 sc1 lds
s_add_u32 s53, s100, 2
s_and_b32 s53, s53, 7
s_add_u32 m0, s96, 32768
s_lshl_b32 s3, s53, 13
s_add_u32 s3, s3, 131072
buffer_load_dwordx4 v24, s[40:43], s3 offen offset:2048 sc1 lds
s_add_u32 s53, s100, 3
s_and_b32 s53, s53, 7
s_add_u32 m0, s96, 40960
s_lshl_b32 s3, s53, 13
s_add_u32 s3, s3, 131072
buffer_load_dwordx4 v24, s[40:43], s3 offen offset:2048 sc1 lds
s_add_u32 s53, s100, 4
s_and_b32 s53, s53, 7
s_add_u32 m0, s96, 49152
s_lshl_b32 s3, s53, 13
s_add_u32 s3, s3, 131072
buffer_load_dwordx4 v24, s[40:43], s3 offen offset:2048 sc1 lds
s_add_u32 s53, s100, 5
s_and_b32 s53, s53, 7
s_add_u32 m0, s96, 57344
s_lshl_b32 s3, s53, 13
s_add_u32 s3, s3, 131072
buffer_load_dwordx4 v24, s[40:43], s3 offen offset:2048 sc1 lds
s_add_u32 s53, s100, 6
s_and_b32 s53, s53, 7
s_add_u32 m0, s96, 65536
s_lshl_b32 s3, s53, 13
s_add_u32 s3, s3, 131072
buffer_load_dwordx4 v24, s[40:43], s3 offen offset:2048 sc1 lds
s_add_u32 s53, s100, 7
s_and_b32 s53, s53, 7
s_add_u32 m0, s96, 90112
s_lshl_b32 s3, s53, 13
s_add_u32 s3, s3, 131072
buffer_load_dwordx4 v24, s[40:43], s3 offen offset:2048 sc1 lds
s_branch L_fb_join
L_xs_18:
buffer_store_dwordx4 v[112:115], v5, s[40:43], s52 offen offset:0 sc1
buffer_store_dwordx4 v[116:119], v5, s[40:43], s52 offen offset:1024 sc1
s_branch L_xd_19
L_xs_20:
buffer_store_dwordx4 v[120:123], v5, s[40:43], s52 offen offset:0 sc1
buffer_store_dwordx4 v[124:127], v5, s[40:43], s52 offen offset:1024 sc1
s_branch L_xd_21
L_xs_22:
buffer_store_dword v3, v2, s[40:43], 0 offen offset:0 sc1
s_branch L_xd_23
L_xs_24:
buffer_store_dwordx4 v[120:123], v22, s[40:43], s52 offen offset:0 sc1
s_branch L_xd_25
L_xs_26:
buffer_store_dwordx4 v[124:127], v22, s[40:43], s52 offen offset:0 sc1
s_branch L_xd_27
L_xs_28:
buffer_store_dword v3, v2, s[40:43], 0 offen offset:128 sc1
s_branch L_xd_29
L_xs_30:
buffer_store_dword v3, v2, s[40:43], 0 offen offset:512 sc1
s_branch L_xd_31
L_xs_32:
buffer_store_dwordx4 v[40:43], v13, s[40:43], s52 offen sc1
buffer_store_dwordx4 v[32:35], v13, s[40:43], s53 offen sc1
s_branch L_xd_33
L_xs_34:
buffer_store_dword v14, v2, s[40:43], 0 offen offset:384 sc1
s_branch L_xd_35
L_xs_36:
buffer_store_dwordx4 v[120:123], v23, s[40:43], s52 offen offset:0 sc1
s_branch L_xd_37
L_xs_38:
buffer_store_dword v12, v2, s[40:43], 0 offen offset:256 sc1
s_branch L_xd_39
L_xs_40:
buffer_store_dwordx4 v[124:127], v23, s[40:43], s52 offen offset:2048 sc1
s_branch L_xd_41
L_xs_45:
buffer_store_dword v29, v15, s[40:43], 0 offen offset:640 sc1
s_branch L_xd_46
L_fl_47:
s_mov_b32 s57, 0
L_poll_5049:
    buffer_load_dword v4, v28, s[40:43], 0 offen offset:640 sc1
    s_add_u32 s57, s57, 1
    s_cmp_gt_u32 s57, 200000
    s_cbranch_scc1 L_got_5050
    s_waitcnt vmcnt(0)
    v_cmp_eq_u32 vcc, 0, v4
    s_cbranch_vccnz L_poll_5049
L_got_5050:
    s_waitcnt vmcnt(0)
s_branch L_fd_48
L_fl_49:
s_mov_b32 s57, 0
L_poll_5051:
    buffer_load_dword v4, v28, s[40:43], 0 offen offset:640 sc1
    s_add_u32 s57, s57, 1
    s_cmp_gt_u32 s57, 200000
    s_cbranch_scc1 L_got_5052
    s_waitcnt vmcnt(0)
    v_cmp_eq_u32 vcc, 0, v4
    s_cbranch_vccnz L_poll_5051
L_got_5052:
    s_waitcnt vmcnt(0)
s_branch L_fd_50
L_fl_52:
s_mov_b32 s57, 0
L_poll_5054:
    buffer_load_dword v4, v28, s[40:43], 0 offen offset:640 sc1
    s_add_u32 s57, s57, 1
    s_cmp_gt_u32 s57, 200000
    s_cbranch_scc1 L_got_5055
    s_waitcnt vmcnt(0)
    v_cmp_eq_u32 vcc, 0, v4
    s_cbranch_vccnz L_poll_5054
L_got_5055:
    s_waitcnt vmcnt(0)
s_branch L_fd_53
L_fin:
L_end:
s_endpgm
.section .rodata,"a"
.p2align 6
.amdhsa_kernel standalone__seq2seq_rnn_t_joint__speech_kernel
  .amdhsa_next_free_vgpr 256
  .amdhsa_next_free_sgpr 102
  .amdhsa_accum_offset 128
  .amdhsa_group_segment_fixed_size 0
  .amdhsa_kernarg_size 80
  .amdhsa_user_sgpr_count 2
  .amdhsa_user_sgpr_kernarg_segment_ptr 1
  .amdhsa_system_sgpr_workgroup_id_x 1
  .amdhsa_float_denorm_mode_32 3
.end_amdhsa_kernel
.text
```
